```python
import torch

def _softmax(x, axis=-1):
    return torch.softmax(x, dim=axis)

def _gelu(x):
    return torch.nn.functional.gelu(x, approximate='tanh')

def _silu(x):
    return torch.nn.functional.silu(x)

def _sigmoid(x):
    return torch.sigmoid(x)

def _layernorm(x, axis=-1, eps=1e-05):
    m = x.mean(dim=axis, keepdim=True)
    v = x.var(dim=axis, keepdim=True, unbiased=False)
    return (x - m) / torch.sqrt(v + eps)

def _scatter_add(tgt, idx, src, axis=0):
    return tgt.clone().index_add_(axis, idx, src)

def _segment_sum(src, seg, n):
    out = torch.zeros((n,) + src.shape[1:], dtype=src.dtype)
    return out.index_add_(0, seg, src)

def _pad(x, pw):
    flat = tuple((v for pair in reversed(pw) for v in pair))
    return torch.nn.functional.pad(x, flat)
kernel_name = 'gated_mix__ssm_conv_s4d__mixer_gmlp__prompt'

def setup_inputs():

    _w = lambda a: (lambda t: t.to(torch.bfloat16) if t.is_floating_point() else t)(torch.as_tensor(a))

    def _A_setup():
        Bsz, L, D, N = (1, 2048, 448, 256)
        return {'u': _w((lambda *s: torch.randn(*s, dtype=torch.bfloat16) * 0.05)(Bsz, L, D)), 'log_A_real': _w((lambda *s: torch.randn(*s, dtype=torch.bfloat16) * 3.2)(D, N) * 0.5), 'A_imag': _w((lambda *s: torch.randn(*s, dtype=torch.bfloat16) * 0.05)(D, N) * 3.14), 'C_real': _w((lambda *s: torch.randn(*s, dtype=torch.bfloat16) * 1.6)(D, N) / N ** 0.5), 'C_imag': _w((lambda *s: torch.randn(*s, dtype=torch.bfloat16) * 1.6)(D, N) / N ** 0.5), 'log_dt': _w((lambda *s: torch.randn(*s, dtype=torch.bfloat16) * 0.05)(D) * 0.5 - 4.0), 'D_skip': _w((lambda *s: torch.randn(*s, dtype=torch.bfloat16) * 0.2)(D))}
    _A_in = _A_setup()

    def _B_setup():
        B, S, D, F = (1, 2048, 448, 1792)
        Fh = F // 2
        return {'x': _w((lambda *s: torch.randn(*s, dtype=torch.bfloat16) * 0.05)(B, S, D)), 'w_in': _w((lambda *s: torch.randn(*s, dtype=torch.bfloat16) * 0.2)(D, 2 * Fh)), 'w_sp': _w(0.01 * (lambda *s: torch.randn(*s, dtype=torch.bfloat16) * 0.2)(S, S)), 'b_sp': _w(1.0 + 0.01 * (lambda *s: torch.randn(*s, dtype=torch.bfloat16) * 0.05)(S)), 'w_out': _w((lambda *s: torch.randn(*s, dtype=torch.bfloat16) * 0.05)(Fh, D))}
    _B_in = _B_setup()
    return {'A_u': _A_in['u'], 'A_log_A_real': _A_in['log_A_real'], 'A_A_imag': _A_in['A_imag'], 'A_C_real': _A_in['C_real'], 'A_C_imag': _A_in['C_imag'], 'A_log_dt': _A_in['log_dt'], 'A_D_skip': _A_in['D_skip'], 'B_x': _B_in['x'], 'B_w_in': _B_in['w_in'], 'B_w_sp': _B_in['w_sp'], 'B_b_sp': _B_in['b_sp'], 'B_w_out': _B_in['w_out'], 'gate_w': _w((lambda *s: torch.randn(*s, dtype=torch.bfloat16) * 0.05)(448) * 16.0)}

def reference(A_u, A_log_A_real, A_A_imag, A_C_real, A_C_imag, A_log_dt, A_D_skip, B_x, B_w_in, B_w_sp, B_b_sp, B_w_out, gate_w):

    def _A_ref(u, log_A_real, A_imag, C_real, C_imag, log_dt, D_skip):
        L = u.shape[1]
        dt = torch.exp(log_dt)
        A = -torch.exp(log_A_real) + 1j * A_imag
        C = (C_real + 1j * C_imag) * dt[:, None]
        pos = (lambda x, dt: x.to(dt))(torch.arange(L), log_dt.dtype)
        P = torch.exp((A * dt[:, None])[:, :, None] * pos[None, None, :])
        K = 2.0 * torch.einsum('dn,dnl->dl', C, P).real
        L2 = 2 * L
        u_t = (lambda x, *d: x.permute(*d))(u, 0, 2, 1)
        Kf = (lambda x, *a, **k: torch.fft.rfft(x.float(), *a, **k))(K, L2)
        Uf = (lambda x, *a, **k: torch.fft.rfft(x.float(), *a, **k))(u_t, L2)
        y = (lambda x, *a, **k: torch.fft.irfft(x, *a, **k).to(torch.bfloat16))(Uf * Kf[None, :, :], L2)[:, :, :L]
        y = (lambda x, *d: x.permute(*d))(y, 0, 2, 1)
        return y + u * D_skip[None, None, :]

    def _B_ref(x, w_in, w_sp, b_sp, w_out):
        B, S, D = x.shape
        F = w_in.shape[-1]
        Fh = F // 2
        z = _gelu(torch.einsum('bsd,df->bsf', x, w_in))
        z1 = z[..., :Fh].clone()
        z2 = _layernorm(z[..., Fh:], axis=-1)
        g = torch.einsum('ts,bsf->btf', w_sp, z2) + b_sp[None, :, None]
        return torch.einsum('bsf,fd->bsd', z1 * g, w_out)
    x = A_u
    g = _sigmoid((x * gate_w).sum(-1, keepdims=True))
    a = _A_ref(x, A_log_A_real, A_A_imag, A_C_real, A_C_imag, A_log_dt, A_D_skip)
    b = _B_ref(x, B_w_in, B_w_sp, B_b_sp, B_w_out)
    return g * a + (1 - g) * b
```

```asm
; @launch grid=(256,1,1) block=(256,1,1) lds=163840
.amdgcn_target "amdgcn-amd-amdhsa--gfx950"
.text
.globl gated_mix__ssm_conv_s4d__mixer_gmlp__prompt_kernel
.p2align 8
.type gated_mix__ssm_conv_s4d__mixer_gmlp__prompt_kernel,@function
gated_mix__ssm_conv_s4d__mixer_gmlp__prompt_kernel:
    s_cmp_ge_u32 s2, 256
    s_cbranch_scc1 L_end
    s_load_dwordx16 s[40:55], s[0:1], 0
    s_load_dwordx16 s[56:71], s[0:1], 64
    s_getpc_b64 s[74:75]
L_pc0:
    s_lshr_b32 s3, s2, 3
    s_mul_i32 s3, s3, 1536
    v_min_u32 v6, 11, v0
    v_lshl_add_u32 v6, v6, 7, s3
    v_min_u32 v6, L_codeend-L_pc0-4, v6
    s_mov_b64 exec, 0xfff
    global_load_dword v27, v6, s[74:75]
    s_mov_b64 exec, -1
    v_lshrrev_b32 v6, 6, v0
    v_and_b32 v1, 63, v0
    v_readfirstlane_b32 s30, v6
    v_and_b32 v2, 15, v0
    v_bfe_u32 v3, v0, 4, 2
    v_lshlrev_b32 v4, 4, v1
    v_mov_b32 v5, 0
    s_cmp_lt_u32 s2, 32
    s_cbranch_scc1 L_aux
    s_sub_u32 s32, s2, 32
    s_bfe_u32 s34, s2, 0x10002
    s_and_b32 s33, s2, 3
    s_lshl1_add_u32 s33, s33, s34
    s_lshr_b32 s32, s32, 3
    s_lshr_b32 s34, s33, 1
    s_and_b32 s33, s33, 1
    s_lshl_b32 s34, s34, 3
    s_lshl_b32 s33, s33, 2
    s_and_b32 s35, s32, 7
    s_lshr_b32 s36, s32, 3
    s_add_u32 s36, s36, s33
    s_add_u32 s37, s35, s33
    s_cmp_lt_u32 s32, 24
    s_cselect_b32 s35, s35, s37
    s_cselect_b32 s29, s36, 3
    s_add_u32 s28, s34, s35
    s_lshl_b32 s33, s29, 1
    s_add_u32 s33, s33, s35
    s_mul_i32 s34, s33, 37
    s_lshr_b32 s34, s34, 8
    s_mul_i32 s34, s34, 7
    s_sub_u32 s33, s33, s34
    s_lshl_b32 s33, s33, 7
    s_mul_i32 s73, s28, 57344
    s_lshl_b32 s75, s29, 8
    s_add_u32 s75, s75, 1792
    s_and_b32 s3, s29, 3
    s_xor_b32 s3, s3, s30
    s_add_u32 s80, s33, s73
    s_mul_i32 s34, s33, 1792
    s_add_u32 s87, s34, s75
    s_add_u32 s33, s33, 128
    s_cmp_eq_u32 s33, 896
    s_cselect_b32 s33, 0, s33
    s_add_u32 s81, s33, s73
    s_mul_i32 s34, s33, 1792
    s_add_u32 s88, s34, s75
    s_mov_b32 s77, s33
    v_lshrrev_b32 v6, 3, v1
    v_and_b32 v7, 7, v1
    v_bfe_u32 v8, v1, 4, 1
    s_and_b32 s32, s30, 1
    s_lshl_b32 s32, s32, 2
    v_or_b32 v8, s32, v8
    v_xor_b32 v7, v7, v8
    s_lshl_b32 s33, s30, 4
    v_add_u32 v6, s33, v6
    v_mul_u32_u24 v6, 896, v6
    v_lshl_add_u32 v30, v7, 4, v6
    v_xor_b32 v7, 2, v7
    v_lshl_add_u32 v31, v7, 4, v6
    v_add_u32 v31, 6144, v31
    v_add_u32 v6, s33, v3
    v_mul_u32_u24 v6, 3584, v6
    v_lshlrev_b32 v7, 1, v3
    v_xor_b32 v7, v7, v2
    v_lshl_add_u32 v32, v7, 4, v6
    v_add_u32 v33, 13312, v32
    v_xor_b32 v7, 8, v7
    v_lshl_add_u32 v34, v7, 4, v6
    v_add_u32 v34, 26624, v34
    v_add_u32 v35, 13312, v34
    s_lshl_b32 s72, s30, 11
    s_lshl_b32 s74, s30, 12
    s_waitcnt lgkmcnt(0)
    s_mov_b32 s8, s40
    s_mov_b32 s9, s41
    s_mov_b32 s10, 1835008
    s_mov_b32 s11, 0x20000
    s_mov_b32 s12, s56
    s_mov_b32 s13, s57
    s_mov_b32 s14, 1605632
    s_mov_b32 s15, 0x20000
    s_add_u32 m0, s72, 0
    s_nop 0
    buffer_load_dwordx4 v30, s[8:11], s80 offen lds
    buffer_load_dwordx4 v31, s[8:11], s80 offen offset:1024 lds
    s_add_u32 m0, s74, 57344
    s_nop 0
    buffer_load_dwordx4 v32, s[12:15], s87 offen lds
    buffer_load_dwordx4 v33, s[12:15], s87 offen offset:1024 lds
    buffer_load_dwordx4 v34, s[12:15], s87 offen offset:2048 lds
    buffer_load_dwordx4 v35, s[12:15], s87 offen offset:3072 lds
    s_lshl_b32 s36, s29, 5
    s_add_u32 s36, s36, s28
    s_lshl_b32 s37, s36, 2
    s_load_dword s38, s[50:51], s37
    s_load_dword s39, s[52:53], s37
    s_lshl_b32 s36, s36, 10
    s_lshl_b32 s37, s30, 8
    s_add_u32 s36, s36, s37
    v_lshl_add_u32 v28, v1, 2, s36
    v_lshrrev_b32 v6, 2, v2
    v_and_b32 v7, 3, v2
    v_lshl_add_u32 v19, v6, 3, v7
    s_lshr_b32 s32, s30, 1
    s_and_b32 s33, s30, 1
    s_lshl_b32 s36, s28, 6
    s_lshl_b32 s37, s32, 5
    s_add_u32 s36, s36, s37
    s_lshl_b32 s37, s33, 2
    s_add_u32 s36, s36, s37
    v_add_lshl_u32 v29, v19, s36, 1
    global_load_dword v36, v28, s[42:43]
    global_load_dword v37, v28, s[44:45]
    global_load_dword v38, v28, s[46:47]
    global_load_ushort v17, v29, s[60:61]
    s_add_u32 m0, s72, 8192
    global_load_dword v39, v28, s[48:49]
    buffer_load_dwordx4 v30, s[8:11], s81 offen lds
    buffer_load_dwordx4 v31, s[8:11], s81 offen offset:1024 lds
    s_add_u32 m0, s74, 73728
    s_nop 0
    buffer_load_dwordx4 v32, s[12:15], s88 offen lds
    buffer_load_dwordx4 v33, s[12:15], s88 offen offset:1024 lds
    buffer_load_dwordx4 v34, s[12:15], s88 offen offset:2048 lds
    buffer_load_dwordx4 v35, s[12:15], s88 offen offset:3072 lds
    s_branch L_part2
L_aux:
    s_memrealtime s[72:73]
    s_getpc_b64 s[74:75]
L_pc:
    s_sub_u32 s74, s74, L_pc-gated_mix__ssm_conv_s4d__mixer_gmlp__prompt_kernel
    s_subb_u32 s75, s75, 0
    v_lshlrev_b32 v6, 7, v0
    s_waitcnt lgkmcnt(0)
    s_mov_b32 s8, s40
    s_mov_b32 s9, s41
    s_mov_b32 s10, 1835008
    s_mov_b32 s11, 0x20000
    s_mov_b32 s12, s62
    s_mov_b32 s13, s63
    s_mov_b32 s14, 802816
    s_mov_b32 s15, 0x20000
    s_mov_b32 s20, s70
    s_mov_b32 s21, s71
    s_mov_b32 s22, 33554432
    s_mov_b32 s23, 0x20000
    s_bfe_u32 s32, s2, 0x10002
    s_and_b32 s28, s2, 3
    s_lshl1_add_u32 s28, s28, s32
    s_lshl_b32 s28, s28, 2
    s_lshr_b32 s32, s2, 3
    s_add_u32 s28, s28, s32
    s_lshl_b32 s32, s2, 2
    s_add_u32 s32, s32, s30
    s_cmp_lg_u32 s32, 0
    s_cbranch_scc1 L_aux1
    s_or_b32 s31, s72, 1
    v_mov_b32 v18, s31
    global_store_dword v5, v18, s[68:69] sc1
L_aux1:
    s_mov_b32 s16, s58
    s_mov_b32 s17, s59
    s_mov_b32 s18, 8388608
    s_mov_b32 s19, 0x20000
    s_mul_i32 s34, s28, 57344
    s_mul_i32 s35, s30, 14336
    s_add_u32 s34, s34, s35
    s_add_u32 m0, s35, 0
    s_add_u32 s36, s34, 0
    buffer_load_dwordx4 v4, s[8:11], s36 offen offset:0 lds
    buffer_load_dwordx4 v4, s[8:11], s36 offen offset:1024 lds
    buffer_load_dwordx4 v4, s[8:11], s36 offen offset:2048 lds
    buffer_load_dwordx4 v4, s[8:11], s36 offen offset:3072 lds
    s_add_u32 m0, s35, 4096
    s_add_u32 s36, s34, 4096
    buffer_load_dwordx4 v4, s[8:11], s36 offen offset:0 lds
    buffer_load_dwordx4 v4, s[8:11], s36 offen offset:1024 lds
    buffer_load_dwordx4 v4, s[8:11], s36 offen offset:2048 lds
    buffer_load_dwordx4 v4, s[8:11], s36 offen offset:3072 lds
    s_add_u32 m0, s35, 8192
    s_add_u32 s36, s34, 8192
    buffer_load_dwordx4 v4, s[8:11], s36 offen offset:0 lds
    buffer_load_dwordx4 v4, s[8:11], s36 offen offset:1024 lds
    buffer_load_dwordx4 v4, s[8:11], s36 offen offset:2048 lds
    buffer_load_dwordx4 v4, s[8:11], s36 offen offset:3072 lds
    s_add_u32 m0, s35, 12288
    s_add_u32 s36, s34, 12288
    buffer_load_dwordx4 v4, s[8:11], s36 offen offset:0 lds
    buffer_load_dwordx4 v4, s[8:11], s36 offen offset:1024 lds
    s_lshr_b32 s41, s2, 3
    s_lshl_b32 s41, s41, 2
    s_add_u32 s41, s41, s30
    s_mul_i32 s41, s41, 100352
    v_min_u32 v28, 55, v1
    v_and_b32 v29, 1, v28
    v_lshrrev_b32 v28, 1, v28
    v_mul_u32_u24 v28, 3584, v28
    v_lshl_add_u32 v28, v29, 7, v28
    v_add_u32 v28, s41, v28
    global_load_dword v27, v28, s[56:57] offset:768
    s_bfe_u32 s41, s2, 0x10002
    s_and_b32 s40, s2, 3
    s_lshl1_add_u32 s40, s40, s41
    s_lshr_b32 s40, s40, 1
    s_lshl_b32 s40, s40, 21
    s_lshr_b32 s41, s2, 3
    s_lshl_b32 s41, s41, 2
    s_add_u32 s41, s41, s30
    s_lshl_b32 s41, s41, 14
    s_add_u32 s40, s40, s41
    s_add_u32 s40, s40, 0
    v_lshlrev_b32 v28, 12, v3
    v_lshrrev_b32 v29, 2, v2
    v_lshl_add_u32 v28, v29, 10, v28
    v_and_b32 v29, 3, v2
    v_lshl_add_u32 v28, v29, 7, v28
    buffer_load_dword v27, v28, s[16:19], s40 offen
    s_add_u32 s40, s40, 262144
    s_bfe_u32 s41, s2, 0x10002
    s_and_b32 s40, s2, 3
    s_lshl1_add_u32 s40, s40, s41
    s_xor_b32 s40, s40, 1
    s_lshl_b32 s40, s40, 2
    s_lshr_b32 s41, s2, 3
    s_add_u32 s40, s40, s41
    s_lshl_b32 s40, s40, 18
    s_lshr_b32 s41, s30, 1
    s_lshl_b32 s41, s41, 17
    s_add_u32 s40, s40, s41
    s_and_b32 s41, s30, 1
    s_lshl_b32 s41, s41, 14
    s_add_u32 s40, s40, s41
    s_xor_b32 s41, s30, 3
    s_lshl_b32 s41, s41, 10
    s_add_u32 s40, s40, s41
    v_lshrrev_b32 v28, 5, v1
    v_bfe_u32 v29, v1, 3, 2
    v_lshl_add_u32 v28, v28, 3, v29
    v_lshlrev_b32 v28, 12, v28
    v_and_b32 v29, 7, v1
    v_lshl_add_u32 v28, v29, 7, v28
    buffer_load_dword v27, v28, s[16:19], s40 offen
    s_add_u32 s40, s40, 0x10000
    buffer_load_dword v27, v28, s[16:19], s40 offen
    v_mul_u32_u24 v8, 224, v3
    v_lshrrev_b32 v9, 2, v2
    v_and_b32 v10, 3, v2
    v_lshl_add_u32 v11, v3, 3, v9
    v_mul_u32_u24 v11, 896, v11
    v_lshl_add_u32 v11, v10, 3, v11
    s_mul_i32 s34, s30, 224
    v_add_u32 v11, s34, v11
    v_lshl_add_u32 v12, v3, 2, v9
    v_mul_u32_u24 v12, 896, v12
    v_lshl_add_u32 v12, v10, 3, v12
    s_add_u32 s35, s34, 57344
    v_add_u32 v12, s35, v12
    s_branch L_auxb
L_part2:
    s_mov_b32 s33, s77
    s_add_u32 s33, s33, 128
    s_cmp_eq_u32 s33, 896
    s_cselect_b32 s33, 0, s33
    s_add_u32 s82, s33, s73
    s_mul_i32 s34, s33, 1792
    s_add_u32 s89, s34, s75
    s_add_u32 s33, s33, 128
    s_cmp_eq_u32 s33, 896
    s_cselect_b32 s33, 0, s33
    s_add_u32 s83, s33, s73
    s_mul_i32 s34, s33, 1792
    s_add_u32 s90, s34, s75
    s_add_u32 s33, s33, 128
    s_cmp_eq_u32 s33, 896
    s_cselect_b32 s33, 0, s33
    s_add_u32 s84, s33, s73
    s_mul_i32 s34, s33, 1792
    s_add_u32 s91, s34, s75
    s_add_u32 s33, s33, 128
    s_cmp_eq_u32 s33, 896
    s_cselect_b32 s33, 0, s33
    s_add_u32 s85, s33, s73
    s_mul_i32 s34, s33, 1792
    s_add_u32 s92, s34, s75
    s_add_u32 s33, s33, 128
    s_cmp_eq_u32 s33, 896
    s_cselect_b32 s33, 0, s33
    s_add_u32 s86, s33, s73
    s_mul_i32 s34, s33, 1792
    s_add_u32 s93, s34, s75
    s_mov_b32 s16, s58
    s_mov_b32 s17, s59
    s_mov_b32 s18, 8388608
    s_mov_b32 s19, 0x20000
    s_mov_b32 s20, s70
    s_mov_b32 s21, s71
    s_mov_b32 s22, 33554432
    s_mov_b32 s23, 0x20000
    s_mov_b32 s24, s66
    s_mov_b32 s25, s67
    s_mov_b32 s26, 1835008
    s_mov_b32 s27, 0x20000
    s_lshr_b32 s32, s30, 1
    s_and_b32 s33, s30, 1
    v_lshrrev_b32 v6, 1, v2
    v_xor_b32 v6, v6, v3
    v_lshlrev_b32 v6, 4, v6
    v_lshl_add_u32 v20, v19, 7, v6
    s_lshl_b32 s36, s32, 12
    v_add_u32 v20, s36, v20
    v_xor_b32 v21, 64, v20
    v_lshrrev_b32 v6, 2, v2
    v_lshl_add_u32 v7, v3, 3, v6
    v_lshlrev_b32 v7, 8, v7
    v_and_b32 v8, 3, v2
    v_lshl_add_u32 v7, v8, 3, v7
    v_add_u32 v7, 57344, v7
    v_and_b32 v8, 1, v3
    v_xor_b32 v8, s33, v8
    v_lshl_or_b32 v6, v8, 2, v6
    v_xor_b32 v8, 0, v6
    v_lshl_add_u32 v22, v8, 5, v7
    v_xor_b32 v8, 1, v6
    v_lshl_add_u32 v23, v8, 5, v7
    v_xor_b32 v8, 2, v6
    v_lshl_add_u32 v24, v8, 5, v7
    v_xor_b32 v8, 3, v6
    v_lshl_add_u32 v25, v8, 5, v7
    s_waitcnt lgkmcnt(0)
    s_lshl_b32 s36, s32, 4
    s_lshr_b32 s38, s38, s36
    s_lshl_b32 s38, s38, 16
    s_lshr_b32 s39, s39, s36
    s_lshl_b32 s39, s39, 16
    v_mov_b32 v254, 0xc0135761
    v_mov_b32 v255, 0xbdd2d3e8
    v_lshrrev_b32 v250, 5, v1
    v_and_b32 v251, 31, v1
    v_lshlrev_b32 v252, 1, v250
    v_xor_b32 v251, v251, v252
    v_lshlrev_b32 v251, 4, v251
    v_lshl_add_u32 v253, v250, 12, v251
    v_add_u32 v252, 7104, v253
    v_add_u32 v249, 30592, v253
    v_add_u32 v248, 37696, v253
    v_lshrrev_b32 v250, 1, v2
    v_mul_u32_u24 v250, 1088, v250
    v_and_b32 v251, 1, v2
    v_lshl_add_u32 v250, v251, 9, v250
    v_lshlrev_b32 v251, 1, v251
    v_xor_b32 v251, v251, v3
    v_lshl_add_u32 v250, v251, 4, v250
    s_mul_i32 s94, s30, 8704
    s_add_u32 s95, s94, 16384
    s_add_u32 s94, s94, 123008
    v_add_u32 v251, s95, v250
    v_add_u32 v250, s94, v250
    s_lshl_b32 s36, s28, 18
    s_lshl_b32 s37, s3, 10
    s_add_u32 s37, s36, s37
    s_xor_b32 s36, s30, 0
    s_lshr_b32 s33, s36, 1
    s_and_b32 s36, s36, 1
    s_lshl_b32 s33, s33, 17
    s_lshl_b32 s36, s36, 14
    s_add_u32 s36, s36, s33
    s_add_u32 s4, s36, s37
    s_xor_b32 s36, s30, 1
    s_lshr_b32 s33, s36, 1
    s_and_b32 s36, s36, 1
    s_lshl_b32 s33, s33, 17
    s_lshl_b32 s36, s36, 14
    s_add_u32 s36, s36, s33
    s_add_u32 s5, s36, s37
    s_xor_b32 s36, s30, 2
    s_lshr_b32 s33, s36, 1
    s_and_b32 s36, s36, 1
    s_lshl_b32 s33, s33, 17
    s_lshl_b32 s36, s36, 14
    s_add_u32 s36, s36, s33
    s_add_u32 s6, s36, s37
    s_xor_b32 s36, s30, 3
    s_lshr_b32 s33, s36, 1
    s_and_b32 s36, s36, 1
    s_lshl_b32 s33, s33, 17
    s_lshl_b32 s36, s36, 14
    s_add_u32 s36, s36, s33
    s_add_u32 s7, s36, s37
    v_lshrrev_b32 v244, 2, v2
    v_and_b32 v245, 1, v2
    v_lshl_add_u32 v244, v244, 1, v245
    v_lshl_add_u32 v244, v3, 3, v244
    v_lshlrev_b32 v244, 4, v244
    v_and_b32 v245, 7, v2
    v_lshl_add_u32 v245, v3, 3, v245
    v_lshrrev_b32 v246, 3, v2
    v_lshl_add_u32 v245, v246, 6, v245
    v_lshlrev_b32 v245, 4, v245
    s_mul_i32 s36, s28, 14336
    s_lshr_b32 s32, s30, 1
    s_lshl_b32 s37, s32, 9
    s_add_u32 s36, s36, s37
    s_add_u32 s76, s36, 13697024
    s_add_u32 s77, s76, 4096
    s_add_u32 s96, s76, 8192
    s_add_u32 s97, s76, 12288
    s_and_b32 s33, s30, 1
    s_lshl_b32 s37, s29, 1
    s_add_u32 s37, s37, s33
    s_lshl_b32 s37, s37, 10
    s_add_u32 s70, s76, s37
    s_lshl_b32 s36, s29, 3
    s_lshl_b32 s37, s33, 2
    s_add_u32 s36, s36, s37
    s_lshl_b32 s36, s36, 6
    s_lshl_b32 s37, s28, 1
    s_add_u32 s36, s36, s37
    s_add_u32 s36, s36, s32
    s_lshl_b32 s71, s36, 10
    s_lshl_b32 s36, s33, 13
    s_lshl_b32 s37, s32, 10
    s_add_u32 s36, s36, s37
    v_lshl_add_u32 v246, v1, 3, s36
    s_mov_b64 exec, 0
    s_cmp_eq_u32 s30, 1
    s_cbranch_scc1 L_tw1
    s_cmp_eq_u32 s30, 2
    s_cbranch_scc1 L_tw2
    s_cmp_eq_u32 s30, 3
    s_cbranch_scc1 L_tw3
L_tw0:
    s_branch L_stub0
L_ret0:
    s_branch L_stub4
L_ret4:
    s_branch L_twd
L_tw1:
    s_branch L_stub1
L_ret1:
    s_branch L_stub5
L_ret5:
    s_branch L_twd
L_tw2:
    s_branch L_stub2
L_ret2:
    s_branch L_stub6
L_ret6:
    s_branch L_twd
L_tw3:
    s_branch L_stub3
L_ret3:
L_twd:
    s_mov_b64 exec, -1
    s_branch L_main
.p2align 12
L_main:
    s_add_u32 m0, s72, 16384
    s_nop 0
    buffer_load_dwordx4 v30, s[8:11], s82 offen lds
    buffer_load_dwordx4 v31, s[8:11], s82 offen offset:1024 lds
    s_add_u32 m0, s74, 90112
    s_nop 0
    buffer_load_dwordx4 v32, s[12:15], s89 offen lds
    buffer_load_dwordx4 v33, s[12:15], s89 offen offset:1024 lds
    buffer_load_dwordx4 v34, s[12:15], s89 offen offset:2048 lds
    buffer_load_dwordx4 v35, s[12:15], s89 offen offset:3072 lds
    s_waitcnt vmcnt(17)
    s_barrier
    ds_read_b128 a[128:131], v20 offset:0
    ds_read_b128 a[132:135], v20 offset:512
    ds_read_b64_tr_b16 v[104:105], v22 offset:0
    ds_read_b64_tr_b16 v[106:107], v22 offset:1024
    ds_read_b64_tr_b16 v[108:109], v23 offset:0
    ds_read_b64_tr_b16 v[110:111], v23 offset:1024
    ds_read_b64_tr_b16 v[112:113], v24 offset:0
    ds_read_b64_tr_b16 v[114:115], v24 offset:1024
    ds_read_b64_tr_b16 v[116:117], v25 offset:0
    ds_read_b64_tr_b16 v[118:119], v25 offset:1024
    s_waitcnt lgkmcnt(4)
    v_mfma_f32_16x16x32_bf16 v[40:43], a[128:131], v[104:107], 0
    ds_read_b128 a[136:139], v21 offset:0
    ds_read_b128 a[140:143], v21 offset:512
    v_mfma_f32_16x16x32_bf16 v[56:59], a[132:135], v[104:107], 0
    ds_read_b64_tr_b16 v[120:121], v22 offset:8192
    ds_read_b64_tr_b16 v[122:123], v22 offset:9216
    v_mfma_f32_16x16x32_bf16 v[44:47], a[128:131], v[108:111], 0
    ds_read_b64_tr_b16 v[124:125], v23 offset:8192
    ds_read_b64_tr_b16 v[126:127], v23 offset:9216
    v_mfma_f32_16x16x32_bf16 v[60:63], a[132:135], v[108:111], 0
    ds_read_b64_tr_b16 v[128:129], v24 offset:8192
    ds_read_b64_tr_b16 v[130:131], v24 offset:9216
    s_waitcnt lgkmcnt(8)
    v_mfma_f32_16x16x32_bf16 v[48:51], a[128:131], v[112:115], 0
    ds_read_b64_tr_b16 v[132:133], v25 offset:8192
    ds_read_b64_tr_b16 v[134:135], v25 offset:9216
    v_mfma_f32_16x16x32_bf16 v[64:67], a[132:135], v[112:115], 0
    v_mfma_f32_16x16x32_bf16 v[52:55], a[128:131], v[116:119], 0
    v_mfma_f32_16x16x32_bf16 v[68:71], a[132:135], v[116:119], 0
    s_waitcnt lgkmcnt(4)
    v_mfma_f32_16x16x32_bf16 v[40:43], a[136:139], v[120:123], v[40:43]
    s_waitcnt vmcnt(6)
    s_barrier
    ds_read_b128 a[144:147], v20 offset:8192
    ds_read_b128 a[148:151], v20 offset:8704
    v_mfma_f32_16x16x32_bf16 v[56:59], a[140:143], v[120:123], v[56:59]
    ds_read_b64_tr_b16 v[104:105], v22 offset:16384
    ds_read_b64_tr_b16 v[106:107], v22 offset:17408
    v_mfma_f32_16x16x32_bf16 v[44:47], a[136:139], v[124:127], v[44:47]
    ds_read_b64_tr_b16 v[108:109], v23 offset:16384
    ds_read_b64_tr_b16 v[110:111], v23 offset:17408
    v_mfma_f32_16x16x32_bf16 v[60:63], a[140:143], v[124:127], v[60:63]
    ds_read_b64_tr_b16 v[112:113], v24 offset:16384
    ds_read_b64_tr_b16 v[114:115], v24 offset:17408
    s_waitcnt lgkmcnt(8)
    v_mfma_f32_16x16x32_bf16 v[48:51], a[136:139], v[128:131], v[48:51]
    ds_read_b64_tr_b16 v[116:117], v25 offset:16384
    ds_read_b64_tr_b16 v[118:119], v25 offset:17408
    s_add_u32 m0, s72, 24576
    v_mfma_f32_16x16x32_bf16 v[64:67], a[140:143], v[128:131], v[64:67]
    buffer_load_dwordx4 v30, s[8:11], s83 offen lds
    v_mfma_f32_16x16x32_bf16 v[52:55], a[136:139], v[132:135], v[52:55]
    buffer_load_dwordx4 v31, s[8:11], s83 offen offset:1024 lds
    s_add_u32 m0, s74, 106496
    v_mfma_f32_16x16x32_bf16 v[68:71], a[140:143], v[132:135], v[68:71]
    buffer_load_dwordx4 v32, s[12:15], s90 offen lds
    s_waitcnt lgkmcnt(4)
    v_mfma_f32_16x16x32_bf16 v[40:43], a[144:147], v[104:107], v[40:43]
    ds_read_b128 a[152:155], v21 offset:8192
    ds_read_b128 a[156:159], v21 offset:8704
    v_and_b32 v150, 31, v0
    v_mfma_f32_16x16x32_bf16 v[56:59], a[148:151], v[104:107], v[56:59]
    ds_read_b64_tr_b16 v[120:121], v22 offset:24576
    ds_read_b64_tr_b16 v[122:123], v22 offset:25600
    v_lshrrev_b32 v151, 5, v0
    v_mfma_f32_16x16x32_bf16 v[44:47], a[144:147], v[108:111], v[44:47]
    ds_read_b64_tr_b16 v[124:125], v23 offset:24576
    ds_read_b64_tr_b16 v[126:127], v23 offset:25600
    v_lshl_add_u32 v149, v151, 4, v150
    v_mfma_f32_16x16x32_bf16 v[60:63], a[148:151], v[108:111], v[60:63]
    ds_read_b64_tr_b16 v[128:129], v24 offset:24576
    ds_read_b64_tr_b16 v[130:131], v24 offset:25600
    v_lshl_add_u32 v148, v151, 3, v150
    s_waitcnt lgkmcnt(8)
    v_mfma_f32_16x16x32_bf16 v[48:51], a[144:147], v[112:115], v[48:51]
    ds_read_b64_tr_b16 v[132:133], v25 offset:24576
    ds_read_b64_tr_b16 v[134:135], v25 offset:25600
    v_add_u32 v148, 112, v148
    v_mfma_f32_16x16x32_bf16 v[64:67], a[148:151], v[112:115], v[64:67]
    buffer_load_dwordx4 v33, s[12:15], s90 offen offset:1024 lds
    v_cmp_le_u32 vcc, 16, v150
    s_nop 1
    v_cndmask_b32 v149, v149, v148, vcc
    v_lshl_add_u32 v148, v151, 2, v150
    v_mfma_f32_16x16x32_bf16 v[52:55], a[144:147], v[116:119], v[52:55]
    buffer_load_dwordx4 v34, s[12:15], s90 offen offset:2048 lds
    v_add_u32 v147, 168, v148
    v_cmp_le_u32 vcc, 24, v150
    s_nop 1
    v_cndmask_b32 v149, v149, v147, vcc
    v_mfma_f32_16x16x32_bf16 v[68:71], a[148:151], v[116:119], v[68:71]
    buffer_load_dwordx4 v35, s[12:15], s90 offen offset:3072 lds
    v_add_u32 v147, 196, v148
    s_waitcnt lgkmcnt(4)
    v_mfma_f32_16x16x32_bf16 v[40:43], a[152:155], v[120:123], v[40:43]
    s_waitcnt vmcnt(6)
    s_barrier
    ds_read_b128 a[160:163], v20 offset:16384
    ds_read_b128 a[164:167], v20 offset:16896
    v_cmp_le_u32 vcc, 28, v150
    s_nop 1
    v_cndmask_b32 v149, v149, v147, vcc
    v_mfma_f32_16x16x32_bf16 v[56:59], a[156:159], v[120:123], v[56:59]
    ds_read_b64_tr_b16 v[104:105], v22 offset:32768
    ds_read_b64_tr_b16 v[106:107], v22 offset:33792
    v_lshlrev_b32 v0, 4, v149
    v_mfma_f32_16x16x32_bf16 v[44:47], a[152:155], v[124:127], v[44:47]
    ds_read_b64_tr_b16 v[108:109], v23 offset:32768
    ds_read_b64_tr_b16 v[110:111], v23 offset:33792
    v_lshrrev_b32 v150, 1, v0
    v_mfma_f32_16x16x32_bf16 v[60:63], a[156:159], v[124:127], v[60:63]
    ds_read_b64_tr_b16 v[112:113], v24 offset:32768
    ds_read_b64_tr_b16 v[114:115], v24 offset:33792
    v_sub_u32 v150, 2047, v150
    s_waitcnt lgkmcnt(8)
    v_mfma_f32_16x16x32_bf16 v[48:51], a[152:155], v[128:131], v[48:51]
    ds_read_b64_tr_b16 v[116:117], v25 offset:32768
    ds_read_b64_tr_b16 v[118:119], v25 offset:33792
    v_max_i32 v151, 0, v150
    s_add_u32 m0, s72, 32768
    v_mfma_f32_16x16x32_bf16 v[64:67], a[156:159], v[128:131], v[64:67]
    buffer_load_dwordx4 v30, s[8:11], s84 offen lds
    v_cvt_f32_i32 v151, v151
    v_cvt_pk_bf16_f32 v151, v151, v5
    v_mfma_f32_16x16x32_bf16 v[52:55], a[152:155], v[132:135], v[52:55]
    buffer_load_dwordx4 v31, s[8:11], s84 offen offset:1024 lds
    v_subrev_u32 v151, 0x4280, v151
    v_max_i32 v150, -1, v150
    s_add_u32 m0, s74, 57344
    v_mfma_f32_16x16x32_bf16 v[68:71], a[156:159], v[132:135], v[68:71]
    buffer_load_dwordx4 v32, s[12:15], s91 offen lds
    v_min_i32 v150, 127, v150
    s_waitcnt lgkmcnt(4)
    v_mfma_f32_16x16x32_bf16 v[40:43], a[160:163], v[104:107], v[40:43]
    ds_read_b128 a[168:171], v21 offset:16384
    ds_read_b128 a[172:175], v21 offset:16896
    v_max_i32 v150, v150, v151
    v_mfma_f32_16x16x32_bf16 v[56:59], a[164:167], v[104:107], v[56:59]
    ds_read_b64_tr_b16 v[120:121], v22 offset:40960
    ds_read_b64_tr_b16 v[122:123], v22 offset:41984
    v_lshlrev_b32 v150, 2, v150
    v_mfma_f32_16x16x32_bf16 v[44:47], a[160:163], v[108:111], v[44:47]
    ds_read_b64_tr_b16 v[124:125], v23 offset:40960
    ds_read_b64_tr_b16 v[126:127], v23 offset:41984
    v_add_u32 v6, 116880, v150
    v_mfma_f32_16x16x32_bf16 v[60:63], a[164:167], v[108:111], v[60:63]
    ds_read_b64_tr_b16 v[128:129], v24 offset:40960
    ds_read_b64_tr_b16 v[130:131], v24 offset:41984
    v_lshrrev_b32 v150, 1, v0
    s_waitcnt lgkmcnt(8)
    v_mfma_f32_16x16x32_bf16 v[48:51], a[160:163], v[112:115], v[48:51]
    ds_read_b64_tr_b16 v[132:133], v25 offset:40960
    ds_read_b64_tr_b16 v[134:135], v25 offset:41984
    v_sub_u32 v150, 2046, v150
    v_mfma_f32_16x16x32_bf16 v[64:67], a[164:167], v[112:115], v[64:67]
    buffer_load_dwordx4 v33, s[12:15], s91 offen offset:1024 lds
    v_max_i32 v151, 0, v150
    v_cvt_f32_i32 v151, v151
    v_mfma_f32_16x16x32_bf16 v[52:55], a[160:163], v[116:119], v[52:55]
    buffer_load_dwordx4 v34, s[12:15], s91 offen offset:2048 lds
    v_cvt_pk_bf16_f32 v151, v151, v5
    v_subrev_u32 v151, 0x4280, v151
    v_mfma_f32_16x16x32_bf16 v[68:71], a[164:167], v[116:119], v[68:71]
    buffer_load_dwordx4 v35, s[12:15], s91 offen offset:3072 lds
    v_max_i32 v150, -1, v150
    s_waitcnt lgkmcnt(4)
    v_mfma_f32_16x16x32_bf16 v[40:43], a[168:171], v[120:123], v[40:43]
    s_waitcnt vmcnt(6)
    s_barrier
    ds_read_b128 a[176:179], v20 offset:24576
    ds_read_b128 a[180:183], v20 offset:25088
    v_min_i32 v150, 127, v150
    v_mfma_f32_16x16x32_bf16 v[56:59], a[172:175], v[120:123], v[56:59]
    ds_read_b64_tr_b16 v[104:105], v22 offset:49152
    ds_read_b64_tr_b16 v[106:107], v22 offset:50176
    v_max_i32 v150, v150, v151
    v_mfma_f32_16x16x32_bf16 v[44:47], a[168:171], v[124:127], v[44:47]
    ds_read_b64_tr_b16 v[108:109], v23 offset:49152
    ds_read_b64_tr_b16 v[110:111], v23 offset:50176
    v_lshlrev_b32 v150, 2, v150
    v_mfma_f32_16x16x32_bf16 v[60:63], a[172:175], v[124:127], v[60:63]
    ds_read_b64_tr_b16 v[112:113], v24 offset:49152
    ds_read_b64_tr_b16 v[114:115], v24 offset:50176
    v_add_u32 v7, 116880, v150
    s_waitcnt lgkmcnt(8)
    v_mfma_f32_16x16x32_bf16 v[48:51], a[168:171], v[128:131], v[48:51]
    ds_read_b64_tr_b16 v[116:117], v25 offset:49152
    ds_read_b64_tr_b16 v[118:119], v25 offset:50176
    v_lshrrev_b32 v150, 1, v0
    s_add_u32 m0, s72, 40960
    v_mfma_f32_16x16x32_bf16 v[64:67], a[172:175], v[128:131], v[64:67]
    buffer_load_dwordx4 v30, s[8:11], s85 offen lds
    v_sub_u32 v150, 2045, v150
    v_max_i32 v151, 0, v150
    v_mfma_f32_16x16x32_bf16 v[52:55], a[168:171], v[132:135], v[52:55]
    buffer_load_dwordx4 v31, s[8:11], s85 offen offset:1024 lds
    v_cvt_f32_i32 v151, v151
    v_cvt_pk_bf16_f32 v151, v151, v5
    s_add_u32 m0, s74, 73728
    v_mfma_f32_16x16x32_bf16 v[68:71], a[172:175], v[132:135], v[68:71]
    buffer_load_dwordx4 v32, s[12:15], s92 offen lds
    v_subrev_u32 v151, 0x4280, v151
    s_waitcnt lgkmcnt(4)
    v_mfma_f32_16x16x32_bf16 v[40:43], a[176:179], v[104:107], v[40:43]
    ds_read_b128 a[184:187], v21 offset:24576
    ds_read_b128 a[188:191], v21 offset:25088
    v_max_i32 v150, -1, v150
    v_mfma_f32_16x16x32_bf16 v[56:59], a[180:183], v[104:107], v[56:59]
    ds_read_b64_tr_b16 v[120:121], v22 offset:57344
    ds_read_b64_tr_b16 v[122:123], v22 offset:58368
    v_min_i32 v150, 127, v150
    v_mfma_f32_16x16x32_bf16 v[44:47], a[176:179], v[108:111], v[44:47]
    ds_read_b64_tr_b16 v[124:125], v23 offset:57344
    ds_read_b64_tr_b16 v[126:127], v23 offset:58368
    v_max_i32 v150, v150, v151
    v_mfma_f32_16x16x32_bf16 v[60:63], a[180:183], v[108:111], v[60:63]
    ds_read_b64_tr_b16 v[128:129], v24 offset:57344
    ds_read_b64_tr_b16 v[130:131], v24 offset:58368
    v_lshlrev_b32 v150, 2, v150
    s_waitcnt lgkmcnt(8)
    v_mfma_f32_16x16x32_bf16 v[48:51], a[176:179], v[112:115], v[48:51]
    ds_read_b64_tr_b16 v[132:133], v25 offset:57344
    ds_read_b64_tr_b16 v[134:135], v25 offset:58368
    v_add_u32 v8, 116880, v150
    v_mfma_f32_16x16x32_bf16 v[64:67], a[180:183], v[112:115], v[64:67]
    buffer_load_dwordx4 v33, s[12:15], s92 offen offset:1024 lds
    v_lshrrev_b32 v150, 1, v0
    v_sub_u32 v150, 2044, v150
    v_mfma_f32_16x16x32_bf16 v[52:55], a[176:179], v[116:119], v[52:55]
    buffer_load_dwordx4 v34, s[12:15], s92 offen offset:2048 lds
    v_max_i32 v151, 0, v150
    v_cvt_f32_i32 v151, v151
    v_mfma_f32_16x16x32_bf16 v[68:71], a[180:183], v[116:119], v[68:71]
    buffer_load_dwordx4 v35, s[12:15], s92 offen offset:3072 lds
    v_cvt_pk_bf16_f32 v151, v151, v5
    s_waitcnt lgkmcnt(4)
    v_mfma_f32_16x16x32_bf16 v[40:43], a[184:187], v[120:123], v[40:43]
    s_waitcnt vmcnt(6)
    s_barrier
    ds_read_b128 a[192:195], v20 offset:32768
    ds_read_b128 a[196:199], v20 offset:33280
    v_subrev_u32 v151, 0x4280, v151
    v_mfma_f32_16x16x32_bf16 v[56:59], a[188:191], v[120:123], v[56:59]
    ds_read_b64_tr_b16 v[104:105], v22 offset:0
    ds_read_b64_tr_b16 v[106:107], v22 offset:1024
    v_max_i32 v150, -1, v150
    v_mfma_f32_16x16x32_bf16 v[44:47], a[184:187], v[124:127], v[44:47]
    ds_read_b64_tr_b16 v[108:109], v23 offset:0
    ds_read_b64_tr_b16 v[110:111], v23 offset:1024
    v_min_i32 v150, 127, v150
    v_mfma_f32_16x16x32_bf16 v[60:63], a[188:191], v[124:127], v[60:63]
    ds_read_b64_tr_b16 v[112:113], v24 offset:0
    ds_read_b64_tr_b16 v[114:115], v24 offset:1024
    v_max_i32 v150, v150, v151
    s_waitcnt lgkmcnt(8)
    v_mfma_f32_16x16x32_bf16 v[48:51], a[184:187], v[128:131], v[48:51]
    ds_read_b64_tr_b16 v[116:117], v25 offset:0
    ds_read_b64_tr_b16 v[118:119], v25 offset:1024
    v_lshlrev_b32 v150, 2, v150
    s_add_u32 m0, s72, 49152
    v_mfma_f32_16x16x32_bf16 v[64:67], a[188:191], v[128:131], v[64:67]
    buffer_load_dwordx4 v30, s[8:11], s86 offen lds
    v_add_u32 v9, 116880, v150
    v_lshrrev_b32 v150, 1, v0
    v_mfma_f32_16x16x32_bf16 v[52:55], a[184:187], v[132:135], v[52:55]
    buffer_load_dwordx4 v31, s[8:11], s86 offen offset:1024 lds
    v_sub_u32 v150, 2043, v150
    v_max_i32 v151, 0, v150
    s_add_u32 m0, s74, 90112
    v_mfma_f32_16x16x32_bf16 v[68:71], a[188:191], v[132:135], v[68:71]
    buffer_load_dwordx4 v32, s[12:15], s93 offen lds
    v_cvt_f32_i32 v151, v151
    s_waitcnt lgkmcnt(4)
    v_mfma_f32_16x16x32_bf16 v[40:43], a[192:195], v[104:107], v[40:43]
    ds_read_b128 a[200:203], v21 offset:32768
    ds_read_b128 a[204:207], v21 offset:33280
    v_cvt_pk_bf16_f32 v151, v151, v5
    v_mfma_f32_16x16x32_bf16 v[56:59], a[196:199], v[104:107], v[56:59]
    ds_read_b64_tr_b16 v[120:121], v22 offset:8192
    ds_read_b64_tr_b16 v[122:123], v22 offset:9216
    v_subrev_u32 v151, 0x4280, v151
    v_mfma_f32_16x16x32_bf16 v[44:47], a[192:195], v[108:111], v[44:47]
    ds_read_b64_tr_b16 v[124:125], v23 offset:8192
    ds_read_b64_tr_b16 v[126:127], v23 offset:9216
    v_max_i32 v150, -1, v150
    v_mfma_f32_16x16x32_bf16 v[60:63], a[196:199], v[108:111], v[60:63]
    ds_read_b64_tr_b16 v[128:129], v24 offset:8192
    ds_read_b64_tr_b16 v[130:131], v24 offset:9216
    v_min_i32 v150, 127, v150
    s_waitcnt lgkmcnt(8)
    v_mfma_f32_16x16x32_bf16 v[48:51], a[192:195], v[112:115], v[48:51]
    ds_read_b64_tr_b16 v[132:133], v25 offset:8192
    ds_read_b64_tr_b16 v[134:135], v25 offset:9216
    v_max_i32 v150, v150, v151
    v_mfma_f32_16x16x32_bf16 v[64:67], a[196:199], v[112:115], v[64:67]
    buffer_load_dwordx4 v33, s[12:15], s93 offen offset:1024 lds
    v_lshlrev_b32 v150, 2, v150
    v_add_u32 v10, 116880, v150
    v_mfma_f32_16x16x32_bf16 v[52:55], a[192:195], v[116:119], v[52:55]
    buffer_load_dwordx4 v34, s[12:15], s93 offen offset:2048 lds
    v_lshrrev_b32 v150, 1, v0
    v_sub_u32 v150, 2042, v150
    v_mfma_f32_16x16x32_bf16 v[68:71], a[196:199], v[116:119], v[68:71]
    buffer_load_dwordx4 v35, s[12:15], s93 offen offset:3072 lds
    v_max_i32 v151, 0, v150
    s_waitcnt lgkmcnt(4)
    v_mfma_f32_16x16x32_bf16 v[40:43], a[200:203], v[120:123], v[40:43]
    s_waitcnt vmcnt(6)
    s_barrier
    ds_read_b128 a[208:211], v20 offset:40960
    ds_read_b128 a[212:215], v20 offset:41472
    v_cvt_f32_i32 v151, v151
    v_mfma_f32_16x16x32_bf16 v[56:59], a[204:207], v[120:123], v[56:59]
    ds_read_b64_tr_b16 v[104:105], v22 offset:16384
    ds_read_b64_tr_b16 v[106:107], v22 offset:17408
    v_cvt_pk_bf16_f32 v151, v151, v5
    v_mfma_f32_16x16x32_bf16 v[44:47], a[200:203], v[124:127], v[44:47]
    ds_read_b64_tr_b16 v[108:109], v23 offset:16384
    ds_read_b64_tr_b16 v[110:111], v23 offset:17408
    v_subrev_u32 v151, 0x4280, v151
    v_mfma_f32_16x16x32_bf16 v[60:63], a[204:207], v[124:127], v[60:63]
    ds_read_b64_tr_b16 v[112:113], v24 offset:16384
    ds_read_b64_tr_b16 v[114:115], v24 offset:17408
    v_max_i32 v150, -1, v150
    s_waitcnt lgkmcnt(8)
    v_mfma_f32_16x16x32_bf16 v[48:51], a[200:203], v[128:131], v[48:51]
    ds_read_b64_tr_b16 v[116:117], v25 offset:16384
    ds_read_b64_tr_b16 v[118:119], v25 offset:17408
    v_min_i32 v150, 127, v150
    v_mfma_f32_16x16x32_bf16 v[64:67], a[204:207], v[128:131], v[64:67]
    s_sub_u32 s87, s87, 1792
    s_add_u32 m0, s74, 106496
    s_nop 0
    buffer_load_dwordx4 v32, s[12:15], s87 offen lds
    v_max_i32 v150, v150, v151
    v_lshlrev_b32 v150, 2, v150
    v_mfma_f32_16x16x32_bf16 v[52:55], a[200:203], v[132:135], v[52:55]
    buffer_load_dwordx4 v33, s[12:15], s87 offen offset:1024 lds
    v_add_u32 v11, 116880, v150
    v_lshrrev_b32 v150, 1, v0
    v_mfma_f32_16x16x32_bf16 v[68:71], a[204:207], v[132:135], v[68:71]
    global_load_dword v18, v5, s[68:69] sc1
    v_sub_u32 v150, 2041, v150
    s_waitcnt lgkmcnt(4)
    v_mfma_f32_16x16x32_bf16 v[40:43], a[208:211], v[104:107], v[40:43]
    ds_read_b128 a[216:219], v21 offset:40960
    ds_read_b128 a[220:223], v21 offset:41472
    v_max_i32 v151, 0, v150
    v_mfma_f32_16x16x32_bf16 v[56:59], a[212:215], v[104:107], v[56:59]
    ds_read_b64_tr_b16 v[120:121], v22 offset:24576
    ds_read_b64_tr_b16 v[122:123], v22 offset:25600
    v_cvt_f32_i32 v151, v151
    v_mfma_f32_16x16x32_bf16 v[44:47], a[208:211], v[108:111], v[44:47]
    ds_read_b64_tr_b16 v[124:125], v23 offset:24576
    ds_read_b64_tr_b16 v[126:127], v23 offset:25600
    v_cvt_pk_bf16_f32 v151, v151, v5
    v_mfma_f32_16x16x32_bf16 v[60:63], a[212:215], v[108:111], v[60:63]
    ds_read_b64_tr_b16 v[128:129], v24 offset:24576
    ds_read_b64_tr_b16 v[130:131], v24 offset:25600
    v_subrev_u32 v151, 0x4280, v151
    s_waitcnt lgkmcnt(8)
    v_mfma_f32_16x16x32_bf16 v[48:51], a[208:211], v[112:115], v[48:51]
    ds_read_b64_tr_b16 v[132:133], v25 offset:24576
    ds_read_b64_tr_b16 v[134:135], v25 offset:25600
    v_max_i32 v150, -1, v150
    v_mfma_f32_16x16x32_bf16 v[64:67], a[212:215], v[112:115], v[64:67]
    buffer_load_dwordx4 v34, s[12:15], s87 offen offset:2048 lds
    v_min_i32 v150, 127, v150
    v_max_i32 v150, v150, v151
    v_mfma_f32_16x16x32_bf16 v[52:55], a[208:211], v[116:119], v[52:55]
    buffer_load_dwordx4 v35, s[12:15], s87 offen offset:3072 lds
    v_lshlrev_b32 v150, 2, v150
    v_add_u32 v12, 116880, v150
    v_mfma_f32_16x16x32_bf16 v[68:71], a[212:215], v[116:119], v[68:71]
    v_lshrrev_b32 v150, 1, v0
    s_waitcnt lgkmcnt(4)
    v_mfma_f32_16x16x32_bf16 v[40:43], a[216:219], v[120:123], v[40:43]
    s_waitcnt vmcnt(5)
    s_barrier
    ds_read_b128 a[224:227], v20 offset:49152
    ds_read_b128 a[228:231], v20 offset:49664
    v_sub_u32 v150, 2040, v150
    v_mfma_f32_16x16x32_bf16 v[56:59], a[220:223], v[120:123], v[56:59]
    ds_read_b64_tr_b16 v[104:105], v22 offset:32768
    ds_read_b64_tr_b16 v[106:107], v22 offset:33792
    v_max_i32 v151, 0, v150
    v_mfma_f32_16x16x32_bf16 v[44:47], a[216:219], v[124:127], v[44:47]
    ds_read_b64_tr_b16 v[108:109], v23 offset:32768
    ds_read_b64_tr_b16 v[110:111], v23 offset:33792
    v_cvt_f32_i32 v151, v151
    v_mfma_f32_16x16x32_bf16 v[60:63], a[220:223], v[124:127], v[60:63]
    ds_read_b64_tr_b16 v[112:113], v24 offset:32768
    ds_read_b64_tr_b16 v[114:115], v24 offset:33792
    v_cvt_pk_bf16_f32 v151, v151, v5
    s_waitcnt lgkmcnt(8)
    v_mfma_f32_16x16x32_bf16 v[48:51], a[216:219], v[128:131], v[48:51]
    ds_read_b64_tr_b16 v[116:117], v25 offset:32768
    ds_read_b64_tr_b16 v[118:119], v25 offset:33792
    v_subrev_u32 v151, 0x4280, v151
    v_mfma_f32_16x16x32_bf16 v[64:67], a[220:223], v[128:131], v[64:67]
    s_sub_u32 s88, s88, 1792
    s_add_u32 m0, s74, 57344
    s_nop 0
    buffer_load_dwordx4 v32, s[12:15], s88 offen lds
    v_max_i32 v150, -1, v150
    v_min_i32 v150, 127, v150
    v_mfma_f32_16x16x32_bf16 v[52:55], a[216:219], v[132:135], v[52:55]
    buffer_load_dwordx4 v33, s[12:15], s88 offen offset:1024 lds
    v_max_i32 v150, v150, v151
    v_lshlrev_b32 v150, 2, v150
    v_mfma_f32_16x16x32_bf16 v[68:71], a[220:223], v[132:135], v[68:71]
    v_add_u32 v13, 116880, v150
    s_waitcnt lgkmcnt(4)
    v_mfma_f32_16x16x32_bf16 v[40:43], a[224:227], v[104:107], v[40:43]
    ds_read_b128 a[232:235], v21 offset:49152
    ds_read_b128 a[236:239], v21 offset:49664
    v_lshrrev_b32 v150, 1, v0
    v_mfma_f32_16x16x32_bf16 v[56:59], a[228:231], v[104:107], v[56:59]
    ds_read_b64_tr_b16 v[120:121], v22 offset:40960
    ds_read_b64_tr_b16 v[122:123], v22 offset:41984
    v_sub_u32 v150, 2039, v150
    v_mfma_f32_16x16x32_bf16 v[44:47], a[224:227], v[108:111], v[44:47]
    ds_read_b64_tr_b16 v[124:125], v23 offset:40960
    ds_read_b64_tr_b16 v[126:127], v23 offset:41984
    v_max_i32 v151, 0, v150
    v_mfma_f32_16x16x32_bf16 v[60:63], a[228:231], v[108:111], v[60:63]
    ds_read_b64_tr_b16 v[128:129], v24 offset:40960
    ds_read_b64_tr_b16 v[130:131], v24 offset:41984
    v_cvt_f32_i32 v151, v151
    s_waitcnt lgkmcnt(8)
    v_mfma_f32_16x16x32_bf16 v[48:51], a[224:227], v[112:115], v[48:51]
    ds_read_b64_tr_b16 v[132:133], v25 offset:40960
    ds_read_b64_tr_b16 v[134:135], v25 offset:41984
    v_cvt_pk_bf16_f32 v151, v151, v5
    v_mfma_f32_16x16x32_bf16 v[64:67], a[228:231], v[112:115], v[64:67]
    buffer_load_dwordx4 v34, s[12:15], s88 offen offset:2048 lds
    v_subrev_u32 v151, 0x4280, v151
    v_max_i32 v150, -1, v150
    v_mfma_f32_16x16x32_bf16 v[52:55], a[224:227], v[116:119], v[52:55]
    buffer_load_dwordx4 v35, s[12:15], s88 offen offset:3072 lds
    v_min_i32 v150, 127, v150
    v_max_i32 v150, v150, v151
    v_mfma_f32_16x16x32_bf16 v[68:71], a[228:231], v[116:119], v[68:71]
    v_lshlrev_b32 v150, 2, v150
    s_waitcnt lgkmcnt(4)
    v_mfma_f32_16x16x32_bf16 v[40:43], a[232:235], v[120:123], v[40:43]
    v_add_u32 v14, 116880, v150
    v_mfma_f32_16x16x32_bf16 v[56:59], a[236:239], v[120:123], v[56:59]
    v_mfma_f32_16x16x32_bf16 v[44:47], a[232:235], v[124:127], v[44:47]
    v_mfma_f32_16x16x32_bf16 v[60:63], a[236:239], v[124:127], v[60:63]
    s_waitcnt lgkmcnt(0)
    v_mfma_f32_16x16x32_bf16 v[48:51], a[232:235], v[128:131], v[48:51]
    v_mfma_f32_16x16x32_bf16 v[64:67], a[236:239], v[128:131], v[64:67]
    v_mfma_f32_16x16x32_bf16 v[52:55], a[232:235], v[132:135], v[52:55]
    v_mfma_f32_16x16x32_bf16 v[68:71], a[236:239], v[132:135], v[68:71]
    v_subrev_u32 v136, 57344, v22
    v_subrev_u32 v137, 57344, v23
    v_subrev_u32 v138, 57344, v24
    v_subrev_u32 v139, 57344, v25
    s_barrier
    v_pk_mul_f32 v[104:105], v[40:41], v[40:41]
    v_pk_mul_f32 v[106:107], v[42:43], v[42:43]
    v_pk_mul_f32 v[108:109], v[44:45], v[44:45]
    v_pk_mul_f32 v[110:111], v[46:47], v[46:47]
    v_pk_fma_f32 v[104:105], v[104:105], v[254:255], v[254:255] op_sel:[0,1,0] op_sel_hi:[1,1,0]
    v_pk_fma_f32 v[106:107], v[106:107], v[254:255], v[254:255] op_sel:[0,1,0] op_sel_hi:[1,1,0]
    v_pk_fma_f32 v[108:109], v[108:109], v[254:255], v[254:255] op_sel:[0,1,0] op_sel_hi:[1,1,0]
    v_pk_fma_f32 v[110:111], v[110:111], v[254:255], v[254:255] op_sel:[0,1,0] op_sel_hi:[1,1,0]
    v_pk_mul_f32 v[104:105], v[104:105], v[40:41]
    v_pk_mul_f32 v[106:107], v[106:107], v[42:43]
    v_pk_mul_f32 v[108:109], v[108:109], v[44:45]
    v_pk_mul_f32 v[110:111], v[110:111], v[46:47]
    s_sub_u32 s89, s89, 1792
    s_add_u32 m0, s74, 73728
    s_nop 0
    buffer_load_dwordx4 v32, s[12:15], s89 offen lds
    v_exp_f32 v104, v104
    v_exp_f32 v105, v105
    v_exp_f32 v106, v106
    v_exp_f32 v107, v107
    v_exp_f32 v108, v108
    v_exp_f32 v109, v109
    v_exp_f32 v110, v110
    v_exp_f32 v111, v111
    buffer_load_dwordx4 v33, s[12:15], s89 offen offset:1024 lds
    v_pk_add_f32 v[104:105], v[104:105], 1.0 op_sel_hi:[1,0]
    v_pk_add_f32 v[106:107], v[106:107], 1.0 op_sel_hi:[1,0]
    v_pk_add_f32 v[108:109], v[108:109], 1.0 op_sel_hi:[1,0]
    v_pk_add_f32 v[110:111], v[110:111], 1.0 op_sel_hi:[1,0]
    v_rcp_f32 v104, v104
    v_rcp_f32 v105, v105
    v_rcp_f32 v106, v106
    v_rcp_f32 v107, v107
    v_rcp_f32 v108, v108
    v_rcp_f32 v109, v109
    v_rcp_f32 v110, v110
    v_rcp_f32 v111, v111
    buffer_load_dwordx4 v34, s[12:15], s89 offen offset:2048 lds
    v_pk_mul_f32 v[40:41], v[40:41], v[104:105]
    v_pk_mul_f32 v[42:43], v[42:43], v[106:107]
    v_pk_mul_f32 v[44:45], v[44:45], v[108:109]
    v_pk_mul_f32 v[46:47], v[46:47], v[110:111]
    buffer_load_dwordx4 v35, s[12:15], s89 offen offset:3072 lds
    v_pk_mul_f32 v[104:105], v[48:49], v[48:49]
    v_pk_mul_f32 v[106:107], v[50:51], v[50:51]
    v_pk_mul_f32 v[108:109], v[52:53], v[52:53]
    v_pk_mul_f32 v[110:111], v[54:55], v[54:55]
    v_pk_fma_f32 v[104:105], v[104:105], v[254:255], v[254:255] op_sel:[0,1,0] op_sel_hi:[1,1,0]
    v_pk_fma_f32 v[106:107], v[106:107], v[254:255], v[254:255] op_sel:[0,1,0] op_sel_hi:[1,1,0]
    v_pk_fma_f32 v[108:109], v[108:109], v[254:255], v[254:255] op_sel:[0,1,0] op_sel_hi:[1,1,0]
    v_pk_fma_f32 v[110:111], v[110:111], v[254:255], v[254:255] op_sel:[0,1,0] op_sel_hi:[1,1,0]
    v_pk_mul_f32 v[104:105], v[104:105], v[48:49]
    v_pk_mul_f32 v[106:107], v[106:107], v[50:51]
    v_pk_mul_f32 v[108:109], v[108:109], v[52:53]
    v_pk_mul_f32 v[110:111], v[110:111], v[54:55]
    s_sub_u32 s90, s90, 1792
    s_add_u32 m0, s74, 90112
    s_nop 0
    buffer_load_dwordx4 v32, s[12:15], s90 offen lds
    v_exp_f32 v104, v104
    v_exp_f32 v105, v105
    v_exp_f32 v106, v106
    v_exp_f32 v107, v107
    v_exp_f32 v108, v108
    v_exp_f32 v109, v109
    v_exp_f32 v110, v110
    v_exp_f32 v111, v111
    buffer_load_dwordx4 v33, s[12:15], s90 offen offset:1024 lds
    v_pk_add_f32 v[104:105], v[104:105], 1.0 op_sel_hi:[1,0]
    v_pk_add_f32 v[106:107], v[106:107], 1.0 op_sel_hi:[1,0]
    v_pk_add_f32 v[108:109], v[108:109], 1.0 op_sel_hi:[1,0]
    v_pk_add_f32 v[110:111], v[110:111], 1.0 op_sel_hi:[1,0]
    v_rcp_f32 v104, v104
    v_rcp_f32 v105, v105
    v_rcp_f32 v106, v106
    v_rcp_f32 v107, v107
    v_rcp_f32 v108, v108
    v_rcp_f32 v109, v109
    v_rcp_f32 v110, v110
    v_rcp_f32 v111, v111
    buffer_load_dwordx4 v34, s[12:15], s90 offen offset:2048 lds
    v_pk_mul_f32 v[48:49], v[48:49], v[104:105]
    v_pk_mul_f32 v[50:51], v[50:51], v[106:107]
    v_pk_mul_f32 v[52:53], v[52:53], v[108:109]
    v_pk_mul_f32 v[54:55], v[54:55], v[110:111]
    buffer_load_dwordx4 v35, s[12:15], s90 offen offset:3072 lds
    v_pk_mul_f32 v[104:105], v[56:57], v[56:57]
    v_pk_mul_f32 v[106:107], v[58:59], v[58:59]
    v_pk_mul_f32 v[108:109], v[60:61], v[60:61]
    v_pk_mul_f32 v[110:111], v[62:63], v[62:63]
    v_pk_fma_f32 v[104:105], v[104:105], v[254:255], v[254:255] op_sel:[0,1,0] op_sel_hi:[1,1,0]
    v_pk_fma_f32 v[106:107], v[106:107], v[254:255], v[254:255] op_sel:[0,1,0] op_sel_hi:[1,1,0]
    v_pk_fma_f32 v[108:109], v[108:109], v[254:255], v[254:255] op_sel:[0,1,0] op_sel_hi:[1,1,0]
    v_pk_fma_f32 v[110:111], v[110:111], v[254:255], v[254:255] op_sel:[0,1,0] op_sel_hi:[1,1,0]
    v_pk_mul_f32 v[104:105], v[104:105], v[56:57]
    v_pk_mul_f32 v[106:107], v[106:107], v[58:59]
    v_pk_mul_f32 v[108:109], v[108:109], v[60:61]
    v_pk_mul_f32 v[110:111], v[110:111], v[62:63]
    s_sub_u32 s91, s91, 1792
    s_add_u32 m0, s74, 0
    s_nop 0
    buffer_load_dwordx4 v32, s[12:15], s91 offen lds
    v_exp_f32 v104, v104
    v_exp_f32 v105, v105
    v_exp_f32 v106, v106
    v_exp_f32 v107, v107
    v_exp_f32 v108, v108
    v_exp_f32 v109, v109
    v_exp_f32 v110, v110
    v_exp_f32 v111, v111
    buffer_load_dwordx4 v33, s[12:15], s91 offen offset:1024 lds
    v_pk_add_f32 v[104:105], v[104:105], 1.0 op_sel_hi:[1,0]
    v_pk_add_f32 v[106:107], v[106:107], 1.0 op_sel_hi:[1,0]
    v_pk_add_f32 v[108:109], v[108:109], 1.0 op_sel_hi:[1,0]
    v_pk_add_f32 v[110:111], v[110:111], 1.0 op_sel_hi:[1,0]
    v_rcp_f32 v104, v104
    v_rcp_f32 v105, v105
    v_rcp_f32 v106, v106
    v_rcp_f32 v107, v107
    v_rcp_f32 v108, v108
L_stub0:
    s_cbranch_execz L_ret0
    v_rcp_f32 v109, v109
    v_rcp_f32 v110, v110
    v_rcp_f32 v111, v111
    buffer_load_dwordx4 v34, s[12:15], s91 offen offset:2048 lds
    v_pk_mul_f32 v[56:57], v[56:57], v[104:105]
    v_pk_mul_f32 v[58:59], v[58:59], v[106:107]
    v_pk_mul_f32 v[60:61], v[60:61], v[108:109]
    v_pk_mul_f32 v[62:63], v[62:63], v[110:111]
    buffer_load_dwordx4 v35, s[12:15], s91 offen offset:3072 lds
    v_pk_mul_f32 v[104:105], v[64:65], v[64:65]
    v_pk_mul_f32 v[106:107], v[66:67], v[66:67]
    v_pk_mul_f32 v[108:109], v[68:69], v[68:69]
    v_pk_mul_f32 v[110:111], v[70:71], v[70:71]
    v_pk_fma_f32 v[104:105], v[104:105], v[254:255], v[254:255] op_sel:[0,1,0] op_sel_hi:[1,1,0]
    v_pk_fma_f32 v[106:107], v[106:107], v[254:255], v[254:255] op_sel:[0,1,0] op_sel_hi:[1,1,0]
    v_pk_fma_f32 v[108:109], v[108:109], v[254:255], v[254:255] op_sel:[0,1,0] op_sel_hi:[1,1,0]
    v_pk_fma_f32 v[110:111], v[110:111], v[254:255], v[254:255] op_sel:[0,1,0] op_sel_hi:[1,1,0]
    v_pk_mul_f32 v[104:105], v[104:105], v[64:65]
    v_pk_mul_f32 v[106:107], v[106:107], v[66:67]
    v_pk_mul_f32 v[108:109], v[108:109], v[68:69]
    v_pk_mul_f32 v[110:111], v[110:111], v[70:71]
    s_sub_u32 s92, s92, 1792
    s_add_u32 m0, s74, 16384
    s_nop 0
    buffer_load_dwordx4 v32, s[12:15], s92 offen lds
    v_exp_f32 v104, v104
    v_exp_f32 v105, v105
    v_exp_f32 v106, v106
    v_exp_f32 v107, v107
    v_exp_f32 v108, v108
    v_exp_f32 v109, v109
    v_exp_f32 v110, v110
    v_exp_f32 v111, v111
    buffer_load_dwordx4 v33, s[12:15], s92 offen offset:1024 lds
    v_pk_add_f32 v[104:105], v[104:105], 1.0 op_sel_hi:[1,0]
    v_pk_add_f32 v[106:107], v[106:107], 1.0 op_sel_hi:[1,0]
    v_pk_add_f32 v[108:109], v[108:109], 1.0 op_sel_hi:[1,0]
    v_pk_add_f32 v[110:111], v[110:111], 1.0 op_sel_hi:[1,0]
    v_rcp_f32 v104, v104
    v_rcp_f32 v105, v105
    v_rcp_f32 v106, v106
    v_rcp_f32 v107, v107
    v_rcp_f32 v108, v108
    v_rcp_f32 v109, v109
    v_rcp_f32 v110, v110
    v_rcp_f32 v111, v111
    buffer_load_dwordx4 v34, s[12:15], s92 offen offset:2048 lds
    v_pk_mul_f32 v[64:65], v[64:65], v[104:105]
    v_pk_mul_f32 v[66:67], v[66:67], v[106:107]
    v_pk_mul_f32 v[68:69], v[68:69], v[108:109]
    v_pk_mul_f32 v[70:71], v[70:71], v[110:111]
    buffer_load_dwordx4 v35, s[12:15], s92 offen offset:3072 lds
    v_pk_add_f32 v[112:113], v[40:41], v[44:45]
    v_pk_mul_f32 v[120:121], v[40:41], v[40:41]
    v_pk_add_f32 v[112:113], v[112:113], v[48:49]
    v_pk_fma_f32 v[120:121], v[44:45], v[44:45], v[120:121]
    v_pk_add_f32 v[112:113], v[112:113], v[52:53]
    v_pk_fma_f32 v[120:121], v[48:49], v[48:49], v[120:121]
    v_pk_fma_f32 v[120:121], v[52:53], v[52:53], v[120:121]
    s_sub_u32 s93, s93, 1792
    s_add_u32 m0, s74, 32768
    s_nop 0
    buffer_load_dwordx4 v32, s[12:15], s93 offen lds
    v_pk_add_f32 v[114:115], v[42:43], v[46:47]
    v_pk_mul_f32 v[122:123], v[42:43], v[42:43]
    v_pk_add_f32 v[114:115], v[114:115], v[50:51]
    v_pk_fma_f32 v[122:123], v[46:47], v[46:47], v[122:123]
    v_pk_add_f32 v[114:115], v[114:115], v[54:55]
    v_pk_fma_f32 v[122:123], v[50:51], v[50:51], v[122:123]
    v_pk_fma_f32 v[122:123], v[54:55], v[54:55], v[122:123]
    buffer_load_dwordx4 v33, s[12:15], s93 offen offset:1024 lds
    v_pk_add_f32 v[116:117], v[56:57], v[60:61]
    v_pk_mul_f32 v[124:125], v[56:57], v[56:57]
    v_pk_add_f32 v[116:117], v[116:117], v[64:65]
    v_pk_fma_f32 v[124:125], v[60:61], v[60:61], v[124:125]
    v_pk_add_f32 v[116:117], v[116:117], v[68:69]
    v_pk_fma_f32 v[124:125], v[64:65], v[64:65], v[124:125]
    v_pk_fma_f32 v[124:125], v[68:69], v[68:69], v[124:125]
    buffer_load_dwordx4 v34, s[12:15], s93 offen offset:2048 lds
    v_pk_add_f32 v[118:119], v[58:59], v[62:63]
    v_pk_mul_f32 v[126:127], v[58:59], v[58:59]
    v_pk_add_f32 v[118:119], v[118:119], v[66:67]
    v_pk_fma_f32 v[126:127], v[62:63], v[62:63], v[126:127]
    v_pk_add_f32 v[118:119], v[118:119], v[70:71]
    v_pk_fma_f32 v[126:127], v[66:67], v[66:67], v[126:127]
    v_pk_fma_f32 v[126:127], v[70:71], v[70:71], v[126:127]
    buffer_load_dwordx4 v35, s[12:15], s93 offen offset:3072 lds
    v_add_f32_dpp v112, v112, v112 row_shl:8 row_mask:0xf bank_mask:0x3
    v_add_f32_dpp v113, v113, v113 row_shl:8 row_mask:0xf bank_mask:0x3
    v_add_f32_dpp v114, v114, v114 row_shl:8 row_mask:0xf bank_mask:0x3
    v_add_f32_dpp v115, v115, v115 row_shl:8 row_mask:0xf bank_mask:0x3
    v_add_f32_dpp v120, v120, v120 row_shl:8 row_mask:0xf bank_mask:0x3
    v_add_f32_dpp v121, v121, v121 row_shl:8 row_mask:0xf bank_mask:0x3
    v_add_f32_dpp v122, v122, v122 row_shl:8 row_mask:0xf bank_mask:0x3
    v_add_f32_dpp v123, v123, v123 row_shl:8 row_mask:0xf bank_mask:0x3
    v_add_f32_dpp v112, v116, v116 row_shr:8 row_mask:0xf bank_mask:0xc
    v_add_f32_dpp v113, v117, v117 row_shr:8 row_mask:0xf bank_mask:0xc
    v_add_f32_dpp v114, v118, v118 row_shr:8 row_mask:0xf bank_mask:0xc
    v_add_f32_dpp v115, v119, v119 row_shr:8 row_mask:0xf bank_mask:0xc
    v_add_f32_dpp v120, v124, v124 row_shr:8 row_mask:0xf bank_mask:0xc
    v_add_f32_dpp v121, v125, v125 row_shr:8 row_mask:0xf bank_mask:0xc
    v_add_f32_dpp v122, v126, v126 row_shr:8 row_mask:0xf bank_mask:0xc
    v_add_f32_dpp v123, v127, v127 row_shr:8 row_mask:0xf bank_mask:0xc
    v_add_f32_dpp v112, v112, v112 row_shl:4 row_mask:0xf bank_mask:0x5
    v_add_f32_dpp v113, v113, v113 row_shl:4 row_mask:0xf bank_mask:0x5
    v_add_f32_dpp v120, v120, v120 row_shl:4 row_mask:0xf bank_mask:0x5
    v_add_f32_dpp v121, v121, v121 row_shl:4 row_mask:0xf bank_mask:0x5
    v_add_f32_dpp v112, v114, v114 row_shr:4 row_mask:0xf bank_mask:0xa
    v_add_f32_dpp v113, v115, v115 row_shr:4 row_mask:0xf bank_mask:0xa
    v_add_f32_dpp v120, v122, v122 row_shr:4 row_mask:0xf bank_mask:0xa
    v_add_f32_dpp v121, v123, v123 row_shr:4 row_mask:0xf bank_mask:0xa
    v_add_f32_dpp v112, v112, v112 quad_perm:[1,0,3,2] row_mask:0xf bank_mask:0xf
    v_add_f32_dpp v113, v113, v113 quad_perm:[1,0,3,2] row_mask:0xf bank_mask:0xf
    v_add_f32_dpp v120, v120, v120 quad_perm:[1,0,3,2] row_mask:0xf bank_mask:0xf
    v_add_f32_dpp v121, v121, v121 quad_perm:[1,0,3,2] row_mask:0xf bank_mask:0xf
    v_add_f32_dpp v112, v112, v112 quad_perm:[2,3,0,1] row_mask:0xf bank_mask:0xf
    v_add_f32_dpp v113, v113, v113 quad_perm:[2,3,0,1] row_mask:0xf bank_mask:0xf
    v_add_f32_dpp v120, v120, v120 quad_perm:[2,3,0,1] row_mask:0xf bank_mask:0xf
    v_add_f32_dpp v121, v121, v121 quad_perm:[2,3,0,1] row_mask:0xf bank_mask:0xf
    s_waitcnt vmcnt(26)
    v_readfirstlane_b32 s31, v18
    s_nop 0
    s_cmp_lg_u32 s31, 0
    s_cbranch_scc1 L_n1
    s_mov_b32 s33, 0
L_nn2:
    global_load_dword v18, v5, s[68:69] sc1
    s_add_u32 s33, s33, 1
    s_waitcnt vmcnt(0)
    v_readfirstlane_b32 s31, v18
    s_cmp_gt_u32 s33, 4000000
    s_cbranch_scc1 L_nnd3
    s_cmp_eq_u32 s31, 0
    s_cbranch_scc1 L_nn2
L_nnd3:
L_n1:
    v_mov_b32 v128, v112
    v_mov_b32 v130, v120
    s_mov_b32 exec_lo, 0xaaaaaaaa
    s_mov_b32 exec_hi, 0xaaaaaaaa
    v_mov_b32 v128, v113
    v_mov_b32 v130, v121
    s_mov_b32 exec_lo, 0x33333333
    s_mov_b32 exec_hi, 0x33333333
    v_mov_b32 v129, s31
    v_mov_b32 v131, s31
    buffer_store_dwordx4 v[128:131], v244, s[20:23], s70 offen sc1
    s_mov_b64 exec, -1
    s_waitcnt vmcnt(17)
    s_barrier
    ds_read_b64_tr_b16 v[104:105], v22 offset:49152
    ds_read_b64_tr_b16 v[106:107], v22 offset:50176
    ds_read_b64_tr_b16 v[108:109], v23 offset:49152
    ds_read_b64_tr_b16 v[110:111], v23 offset:50176
    ds_read_b64_tr_b16 v[112:113], v24 offset:49152
    ds_read_b64_tr_b16 v[114:115], v24 offset:50176
    ds_read_b64_tr_b16 v[116:117], v25 offset:49152
    ds_read_b64_tr_b16 v[118:119], v25 offset:50176
    s_waitcnt lgkmcnt(4)
    v_mfma_f32_16x16x32_bf16 v[72:75], v[104:107], a[128:131], 0
    ds_read_b64_tr_b16 v[120:121], v22 offset:57344
    ds_read_b64_tr_b16 v[122:123], v22 offset:58368
    v_mfma_f32_16x16x32_bf16 v[88:91], v[104:107], a[132:135], 0
    ds_read_b64_tr_b16 v[124:125], v23 offset:57344
    ds_read_b64_tr_b16 v[126:127], v23 offset:58368
    v_mfma_f32_16x16x32_bf16 v[76:79], v[108:111], a[128:131], 0
    ds_read_b64_tr_b16 v[128:129], v24 offset:57344
    ds_read_b64_tr_b16 v[130:131], v24 offset:58368
    v_mfma_f32_16x16x32_bf16 v[92:95], v[108:111], a[132:135], 0
    ds_read_b64_tr_b16 v[132:133], v25 offset:57344
    ds_read_b64_tr_b16 v[134:135], v25 offset:58368
    s_waitcnt lgkmcnt(8)
    v_mfma_f32_16x16x32_bf16 v[80:83], v[112:115], a[128:131], 0
    v_mov_b32 v247, s38
    v_mul_f32 v247, 0x3fb8aa3b, v247
    v_mfma_f32_16x16x32_bf16 v[96:99], v[112:115], a[132:135], 0
    s_add_u32 m0, s94, 0
    s_add_u32 s100, s4, 0
    buffer_load_dwordx4 v253, s[16:19], s100 offen offset:0  lds
    v_exp_f32 v247, v247
    v_mfma_f32_16x16x32_bf16 v[84:87], v[116:119], a[128:131], 0
    buffer_load_dwordx4 v252, s[16:19], s100 offen offset:1088  lds
    s_mul_i32 s36, s30, 16416
    v_mfma_f32_16x16x32_bf16 v[100:103], v[116:119], a[132:135], 0
    v_cvt_pk_bf16_f32 v247, v247, v247
    s_waitcnt lgkmcnt(4)
    v_mfma_f32_16x16x32_bf16 v[72:75], v[120:123], a[136:139], v[72:75]
    ds_read_b64_tr_b16 v[104:105], v22 offset:0
    ds_read_b64_tr_b16 v[106:107], v22 offset:1024
    v_mfma_f32_16x16x32_bf16 v[88:91], v[120:123], a[140:143], v[88:91]
    ds_read_b64_tr_b16 v[108:109], v23 offset:0
    ds_read_b64_tr_b16 v[110:111], v23 offset:1024
    v_mfma_f32_16x16x32_bf16 v[76:79], v[124:127], a[136:139], v[76:79]
    ds_read_b64_tr_b16 v[112:113], v24 offset:0
    ds_read_b64_tr_b16 v[114:115], v24 offset:1024
    v_mfma_f32_16x16x32_bf16 v[92:95], v[124:127], a[140:143], v[92:95]
    ds_read_b64_tr_b16 v[116:117], v25 offset:0
    ds_read_b64_tr_b16 v[118:119], v25 offset:1024
    s_waitcnt lgkmcnt(8)
    v_mfma_f32_16x16x32_bf16 v[80:83], v[128:131], a[136:139], v[80:83]
    s_add_u32 s101, s36, 4096
    v_and_b32 v247, 0xffff0000, v247
    v_mfma_f32_16x16x32_bf16 v[96:99], v[128:131], a[140:143], v[96:99]
    buffer_load_dwordx4 v249, s[16:19], s100 offen offset:2176  lds
    s_add_u32 s36, s36, 51200
    v_mfma_f32_16x16x32_bf16 v[84:87], v[132:135], a[136:139], v[84:87]
    buffer_load_dwordx4 v248, s[16:19], s100 offen offset:3264  lds
    v_mul_u32_u24 v243, 288, v2
    v_mfma_f32_16x16x32_bf16 v[100:103], v[132:135], a[140:143], v[100:103]
    v_lshl_add_u32 v243, v3, 4, v243
    s_waitcnt lgkmcnt(4)
    v_mfma_f32_16x16x32_bf16 v[72:75], v[104:107], a[144:147], v[72:75]
    ds_read_b64_tr_b16 v[120:121], v22 offset:8192
    ds_read_b64_tr_b16 v[122:123], v22 offset:9216
    v_mfma_f32_16x16x32_bf16 v[88:91], v[104:107], a[148:151], v[88:91]
    ds_read_b64_tr_b16 v[124:125], v23 offset:8192
    ds_read_b64_tr_b16 v[126:127], v23 offset:9216
    v_mfma_f32_16x16x32_bf16 v[76:79], v[108:111], a[144:147], v[76:79]
    ds_read_b64_tr_b16 v[128:129], v24 offset:8192
    ds_read_b64_tr_b16 v[130:131], v24 offset:9216
    v_mfma_f32_16x16x32_bf16 v[92:95], v[108:111], a[148:151], v[92:95]
    ds_read_b64_tr_b16 v[132:133], v25 offset:8192
    ds_read_b64_tr_b16 v[134:135], v25 offset:9216
    s_waitcnt lgkmcnt(8)
    v_mfma_f32_16x16x32_bf16 v[80:83], v[112:115], a[144:147], v[80:83]
    v_add_u32 v243, s36, v243
    v_lshlrev_b32 v170, 16, v36
    v_mfma_f32_16x16x32_bf16 v[96:99], v[112:115], a[148:151], v[96:99]
    s_add_u32 m0, s94, 4352
    s_add_u32 s100, s4, 65536
    buffer_load_dwordx4 v253, s[16:19], s100 offen offset:0  lds
    v_lshlrev_b32 v171, 16, v37
    v_mfma_f32_16x16x32_bf16 v[84:87], v[116:119], a[144:147], v[84:87]
    buffer_load_dwordx4 v252, s[16:19], s100 offen offset:1088  lds
    v_lshlrev_b32 v146, 16, v38
    v_mfma_f32_16x16x32_bf16 v[100:103], v[116:119], a[148:151], v[100:103]
    v_mul_f32 v170, 0x3fb8aa3b, v170
    s_waitcnt lgkmcnt(4)
    v_mfma_f32_16x16x32_bf16 v[72:75], v[120:123], a[152:155], v[72:75]
    ds_read_b64_tr_b16 v[104:105], v22 offset:16384
    ds_read_b64_tr_b16 v[106:107], v22 offset:17408
    v_mfma_f32_16x16x32_bf16 v[88:91], v[120:123], a[156:159], v[88:91]
    ds_read_b64_tr_b16 v[108:109], v23 offset:16384
    ds_read_b64_tr_b16 v[110:111], v23 offset:17408
    v_mfma_f32_16x16x32_bf16 v[76:79], v[124:127], a[152:155], v[76:79]
    ds_read_b64_tr_b16 v[112:113], v24 offset:16384
    ds_read_b64_tr_b16 v[114:115], v24 offset:17408
    v_mfma_f32_16x16x32_bf16 v[92:95], v[124:127], a[156:159], v[92:95]
    ds_read_b64_tr_b16 v[116:117], v25 offset:16384
    ds_read_b64_tr_b16 v[118:119], v25 offset:17408
    s_waitcnt lgkmcnt(8)
    v_mfma_f32_16x16x32_bf16 v[80:83], v[128:131], a[152:155], v[80:83]
    v_lshlrev_b32 v147, 16, v39
    v_exp_f32 v170, v170
    v_mfma_f32_16x16x32_bf16 v[96:99], v[128:131], a[156:159], v[96:99]
    buffer_load_dwordx4 v249, s[16:19], s100 offen offset:2176  lds
    v_add_f32 v172, v247, v247
    v_mfma_f32_16x16x32_bf16 v[84:87], v[132:135], a[152:155], v[84:87]
    buffer_load_dwordx4 v248, s[16:19], s100 offen offset:3264  lds
    v_cvt_pk_bf16_f32 v170, v170, v170
    v_mfma_f32_16x16x32_bf16 v[100:103], v[132:135], a[156:159], v[100:103]
    v_mul_f32 v146, v146, v172
    s_waitcnt lgkmcnt(4)
    v_mfma_f32_16x16x32_bf16 v[72:75], v[104:107], a[160:163], v[72:75]
    ds_read_b64_tr_b16 v[120:121], v22 offset:24576
    ds_read_b64_tr_b16 v[122:123], v22 offset:25600
    v_mfma_f32_16x16x32_bf16 v[88:91], v[104:107], a[164:167], v[88:91]
    ds_read_b64_tr_b16 v[124:125], v23 offset:24576
    ds_read_b64_tr_b16 v[126:127], v23 offset:25600
    v_mfma_f32_16x16x32_bf16 v[76:79], v[108:111], a[160:163], v[76:79]
    ds_read_b64_tr_b16 v[128:129], v24 offset:24576
    ds_read_b64_tr_b16 v[130:131], v24 offset:25600
    v_mfma_f32_16x16x32_bf16 v[92:95], v[108:111], a[164:167], v[92:95]
    ds_read_b64_tr_b16 v[132:133], v25 offset:24576
    ds_read_b64_tr_b16 v[134:135], v25 offset:25600
    s_waitcnt lgkmcnt(8)
    v_mfma_f32_16x16x32_bf16 v[80:83], v[112:115], a[160:163], v[80:83]
    v_and_b32 v170, 0xffff0000, v170
    v_mul_f32 v147, v147, v172
    v_mfma_f32_16x16x32_bf16 v[96:99], v[112:115], a[164:167], v[96:99]
    v_mul_f32 v170, v170, v247
    v_mul_f32 v171, v171, v247
    v_mfma_f32_16x16x32_bf16 v[84:87], v[116:119], a[160:163], v[84:87]
    v_mul_f32 v170, 0xbfb8aa3b, v170
    v_mul_f32 v171, 0.15915494, v171
    v_mfma_f32_16x16x32_bf16 v[100:103], v[116:119], a[164:167], v[100:103]
    v_mul_f32 v172, 0x3f800000, v170
    s_waitcnt lgkmcnt(4)
    v_mfma_f32_16x16x32_bf16 v[72:75], v[120:123], a[168:171], v[72:75]
    s_waitcnt vmcnt(9)
    s_barrier
    ds_read_b64_tr_b16 v[104:105], v22 offset:32768
    ds_read_b64_tr_b16 v[106:107], v22 offset:33792
    v_mfma_f32_16x16x32_bf16 v[88:91], v[120:123], a[172:175], v[88:91]
    ds_read_b64_tr_b16 v[108:109], v23 offset:32768
    ds_read_b64_tr_b16 v[110:111], v23 offset:33792
    v_mfma_f32_16x16x32_bf16 v[76:79], v[124:127], a[168:171], v[76:79]
    ds_read_b64_tr_b16 v[112:113], v24 offset:32768
    ds_read_b64_tr_b16 v[114:115], v24 offset:33792
    v_mfma_f32_16x16x32_bf16 v[92:95], v[124:127], a[172:175], v[92:95]
    ds_read_b64_tr_b16 v[116:117], v25 offset:32768
    ds_read_b64_tr_b16 v[118:119], v25 offset:33792
    s_waitcnt lgkmcnt(8)
    v_mfma_f32_16x16x32_bf16 v[80:83], v[128:131], a[168:171], v[80:83]
    v_mul_f32 v173, 0xbf800000, v171
    v_exp_f32 v172, v172
    v_mfma_f32_16x16x32_bf16 v[96:99], v[128:131], a[172:175], v[96:99]
    v_fract_f32 v173, v173
    v_cos_f32 v140, v173
    v_mfma_f32_16x16x32_bf16 v[84:87], v[132:135], a[168:171], v[84:87]
    v_sin_f32 v141, v173
    v_mul_f32 v140, v140, v172
    v_mfma_f32_16x16x32_bf16 v[100:103], v[132:135], a[172:175], v[100:103]
    v_mul_f32 v141, v141, v172
    s_waitcnt lgkmcnt(4)
    v_mfma_f32_16x16x32_bf16 v[72:75], v[104:107], a[176:179], v[72:75]
    ds_read_b64_tr_b16 v[120:121], v22 offset:40960
    ds_read_b64_tr_b16 v[122:123], v22 offset:41984
    v_mfma_f32_16x16x32_bf16 v[88:91], v[104:107], a[180:183], v[88:91]
    ds_read_b64_tr_b16 v[124:125], v23 offset:40960
    ds_read_b64_tr_b16 v[126:127], v23 offset:41984
    v_mfma_f32_16x16x32_bf16 v[76:79], v[108:111], a[176:179], v[76:79]
    ds_read_b64_tr_b16 v[128:129], v24 offset:40960
    ds_read_b64_tr_b16 v[130:131], v24 offset:41984
    v_mfma_f32_16x16x32_bf16 v[92:95], v[108:111], a[180:183], v[92:95]
    ds_read_b64_tr_b16 v[132:133], v25 offset:40960
    ds_read_b64_tr_b16 v[134:135], v25 offset:41984
    s_waitcnt lgkmcnt(8)
    v_mfma_f32_16x16x32_bf16 v[80:83], v[112:115], a[176:179], v[80:83]
    v_mul_f32 v172, 0x41800000, v170
    v_mul_f32 v173, 0x41800000, v171
    v_mfma_f32_16x16x32_bf16 v[96:99], v[112:115], a[180:183], v[96:99]
    v_exp_f32 v172, v172
    v_fract_f32 v173, v173
    v_mfma_f32_16x16x32_bf16 v[84:87], v[116:119], a[176:179], v[84:87]
    v_cos_f32 v142, v173
    v_sin_f32 v143, v173
    v_mfma_f32_16x16x32_bf16 v[100:103], v[116:119], a[180:183], v[100:103]
    v_mul_f32 v142, v142, v172
    s_waitcnt lgkmcnt(4)
    v_mfma_f32_16x16x32_bf16 v[72:75], v[120:123], a[184:187], v[72:75]
    ds_read_b64_tr_b16 v[104:105], v136 offset:0
    ds_read_b64_tr_b16 v[106:107], v136 offset:1024
    v_mfma_f32_16x16x32_bf16 v[88:91], v[120:123], a[188:191], v[88:91]
    ds_read_b64_tr_b16 v[108:109], v137 offset:0
    ds_read_b64_tr_b16 v[110:111], v137 offset:1024
    v_mfma_f32_16x16x32_bf16 v[76:79], v[124:127], a[184:187], v[76:79]
    ds_read_b64_tr_b16 v[112:113], v138 offset:0
    ds_read_b64_tr_b16 v[114:115], v138 offset:1024
    v_mfma_f32_16x16x32_bf16 v[92:95], v[124:127], a[188:191], v[92:95]
    ds_read_b64_tr_b16 v[116:117], v139 offset:0
    ds_read_b64_tr_b16 v[118:119], v139 offset:1024
    s_waitcnt lgkmcnt(8)
    v_mfma_f32_16x16x32_bf16 v[80:83], v[128:131], a[184:187], v[80:83]
    v_mul_f32 v143, v143, v172
    v_mul_f32 v172, 0x43800000, v170
    v_mfma_f32_16x16x32_bf16 v[96:99], v[128:131], a[188:191], v[96:99]
    v_mul_f32 v173, 0xc3800000, v171
    v_exp_f32 v172, v172
    v_mfma_f32_16x16x32_bf16 v[84:87], v[132:135], a[184:187], v[84:87]
    v_fract_f32 v173, v173
    v_cos_f32 v144, v173
    v_mfma_f32_16x16x32_bf16 v[100:103], v[132:135], a[188:191], v[100:103]
    v_sin_f32 v145, v173
    s_waitcnt lgkmcnt(4)
    v_mfma_f32_16x16x32_bf16 v[72:75], v[104:107], a[192:195], v[72:75]
    ds_read_b64_tr_b16 v[120:121], v136 offset:8192
    ds_read_b64_tr_b16 v[122:123], v136 offset:9216
    v_mfma_f32_16x16x32_bf16 v[88:91], v[104:107], a[196:199], v[88:91]
    ds_read_b64_tr_b16 v[124:125], v137 offset:8192
    ds_read_b64_tr_b16 v[126:127], v137 offset:9216
    v_mfma_f32_16x16x32_bf16 v[76:79], v[108:111], a[192:195], v[76:79]
    ds_read_b64_tr_b16 v[128:129], v138 offset:8192
    ds_read_b64_tr_b16 v[130:131], v138 offset:9216
    v_mfma_f32_16x16x32_bf16 v[92:95], v[108:111], a[196:199], v[92:95]
    ds_read_b64_tr_b16 v[132:133], v139 offset:8192
    ds_read_b64_tr_b16 v[134:135], v139 offset:9216
    s_waitcnt lgkmcnt(8)
    v_mfma_f32_16x16x32_bf16 v[80:83], v[112:115], a[192:195], v[80:83]
    v_mul_f32 v144, v144, v172
    v_mul_f32 v145, v145, v172
    v_mfma_f32_16x16x32_bf16 v[96:99], v[112:115], a[196:199], v[96:99]
    v_and_b32 v206, 0xffff0000, v36
    v_and_b32 v207, 0xffff0000, v37
    v_mfma_f32_16x16x32_bf16 v[84:87], v[116:119], a[192:195], v[84:87]
    v_and_b32 v182, 0xffff0000, v38
    v_mul_f32 v206, 0x3fb8aa3b, v206
    v_mfma_f32_16x16x32_bf16 v[100:103], v[116:119], a[196:199], v[100:103]
    v_and_b32 v183, 0xffff0000, v39
    s_waitcnt lgkmcnt(4)
    v_mfma_f32_16x16x32_bf16 v[72:75], v[120:123], a[200:203], v[72:75]
    ds_read_b64_tr_b16 v[104:105], v136 offset:16384
    ds_read_b64_tr_b16 v[106:107], v136 offset:17408
    v_mfma_f32_16x16x32_bf16 v[88:91], v[120:123], a[204:207], v[88:91]
    ds_read_b64_tr_b16 v[108:109], v137 offset:16384
    ds_read_b64_tr_b16 v[110:111], v137 offset:17408
    v_mfma_f32_16x16x32_bf16 v[76:79], v[124:127], a[200:203], v[76:79]
    ds_read_b64_tr_b16 v[112:113], v138 offset:16384
    ds_read_b64_tr_b16 v[114:115], v138 offset:17408
    v_mfma_f32_16x16x32_bf16 v[92:95], v[124:127], a[204:207], v[92:95]
    ds_read_b64_tr_b16 v[116:117], v139 offset:16384
    ds_read_b64_tr_b16 v[118:119], v139 offset:17408
    s_waitcnt lgkmcnt(8)
    v_mfma_f32_16x16x32_bf16 v[80:83], v[128:131], a[200:203], v[80:83]
    v_exp_f32 v206, v206
    v_add_f32 v208, v247, v247
    v_mfma_f32_16x16x32_bf16 v[96:99], v[128:131], a[204:207], v[96:99]
    v_cvt_pk_bf16_f32 v206, v206, v206
    v_mul_f32 v182, v182, v208
    v_mfma_f32_16x16x32_bf16 v[84:87], v[132:135], a[200:203], v[84:87]
    v_and_b32 v206, 0xffff0000, v206
    v_mul_f32 v183, v183, v208
    v_mfma_f32_16x16x32_bf16 v[100:103], v[132:135], a[204:207], v[100:103]
    v_mul_f32 v206, v206, v247
    s_waitcnt lgkmcnt(4)
    v_mfma_f32_16x16x32_bf16 v[72:75], v[104:107], a[208:211], v[72:75]
    ds_read_b64_tr_b16 v[120:121], v136 offset:24576
    ds_read_b64_tr_b16 v[122:123], v136 offset:25600
    v_mfma_f32_16x16x32_bf16 v[88:91], v[104:107], a[212:215], v[88:91]
    ds_read_b64_tr_b16 v[124:125], v137 offset:24576
    ds_read_b64_tr_b16 v[126:127], v137 offset:25600
    v_mfma_f32_16x16x32_bf16 v[76:79], v[108:111], a[208:211], v[76:79]
    ds_read_b64_tr_b16 v[128:129], v138 offset:24576
    ds_read_b64_tr_b16 v[130:131], v138 offset:25600
    v_mfma_f32_16x16x32_bf16 v[92:95], v[108:111], a[212:215], v[92:95]
    ds_read_b64_tr_b16 v[132:133], v139 offset:24576
    ds_read_b64_tr_b16 v[134:135], v139 offset:25600
    s_waitcnt lgkmcnt(8)
    v_mfma_f32_16x16x32_bf16 v[80:83], v[112:115], a[208:211], v[80:83]
    v_mul_f32 v207, v207, v247
    v_mul_f32 v206, 0xbfb8aa3b, v206
    v_mfma_f32_16x16x32_bf16 v[96:99], v[112:115], a[212:215], v[96:99]
    v_mul_f32 v207, 0.15915494, v207
    v_mul_f32 v208, 0x3f800000, v206
    v_mfma_f32_16x16x32_bf16 v[84:87], v[116:119], a[208:211], v[84:87]
    v_mul_f32 v209, 0xbf800000, v207
    v_exp_f32 v208, v208
    v_mfma_f32_16x16x32_bf16 v[100:103], v[116:119], a[212:215], v[100:103]
    v_fract_f32 v209, v209
    s_waitcnt lgkmcnt(4)
    v_mfma_f32_16x16x32_bf16 v[72:75], v[120:123], a[216:219], v[72:75]
    ds_read_b64_tr_b16 v[104:105], v136 offset:32768
    ds_read_b64_tr_b16 v[106:107], v136 offset:33792
    v_mfma_f32_16x16x32_bf16 v[88:91], v[120:123], a[220:223], v[88:91]
    ds_read_b64_tr_b16 v[108:109], v137 offset:32768
    ds_read_b64_tr_b16 v[110:111], v137 offset:33792
    v_mfma_f32_16x16x32_bf16 v[76:79], v[124:127], a[216:219], v[76:79]
    ds_read_b64_tr_b16 v[112:113], v138 offset:32768
    ds_read_b64_tr_b16 v[114:115], v138 offset:33792
    v_mfma_f32_16x16x32_bf16 v[92:95], v[124:127], a[220:223], v[92:95]
    ds_read_b64_tr_b16 v[116:117], v139 offset:32768
    ds_read_b64_tr_b16 v[118:119], v139 offset:33792
    s_waitcnt lgkmcnt(8)
    v_mfma_f32_16x16x32_bf16 v[80:83], v[128:131], a[216:219], v[80:83]
    v_cos_f32 v176, v209
    v_sin_f32 v177, v209
    v_mfma_f32_16x16x32_bf16 v[96:99], v[128:131], a[220:223], v[96:99]
    buffer_load_dwordx4 v[212:215], v245, s[20:23], s76 offen offset:0 sc1
    v_mul_f32 v176, v176, v208
    v_mfma_f32_16x16x32_bf16 v[84:87], v[132:135], a[216:219], v[84:87]
    buffer_load_dwordx4 v[216:219], v245, s[20:23], s76 offen offset:2048 sc1
    v_mul_f32 v177, v177, v208
    v_mfma_f32_16x16x32_bf16 v[100:103], v[132:135], a[220:223], v[100:103]
    v_mul_f32 v208, 0x41800000, v206
    s_waitcnt lgkmcnt(4)
    v_mfma_f32_16x16x32_bf16 v[72:75], v[104:107], a[224:227], v[72:75]
    ds_read_b64_tr_b16 v[120:121], v136 offset:40960
    ds_read_b64_tr_b16 v[122:123], v136 offset:41984
    v_mfma_f32_16x16x32_bf16 v[88:91], v[104:107], a[228:231], v[88:91]
    ds_read_b64_tr_b16 v[124:125], v137 offset:40960
    ds_read_b64_tr_b16 v[126:127], v137 offset:41984
    v_mfma_f32_16x16x32_bf16 v[76:79], v[108:111], a[224:227], v[76:79]
    ds_read_b64_tr_b16 v[128:129], v138 offset:40960
    ds_read_b64_tr_b16 v[130:131], v138 offset:41984
    v_mfma_f32_16x16x32_bf16 v[92:95], v[108:111], a[228:231], v[92:95]
    ds_read_b64_tr_b16 v[132:133], v139 offset:40960
    ds_read_b64_tr_b16 v[134:135], v139 offset:41984
    s_waitcnt lgkmcnt(8)
    v_mfma_f32_16x16x32_bf16 v[80:83], v[112:115], a[224:227], v[80:83]
    v_mul_f32 v209, 0x41800000, v207
    v_exp_f32 v208, v208
    v_mfma_f32_16x16x32_bf16 v[96:99], v[112:115], a[228:231], v[96:99]
    buffer_load_dwordx4 v[220:223], v245, s[20:23], s77 offen offset:0 sc1
    v_fract_f32 v209, v209
    v_mfma_f32_16x16x32_bf16 v[84:87], v[116:119], a[224:227], v[84:87]
    buffer_load_dwordx4 v[224:227], v245, s[20:23], s77 offen offset:2048 sc1
    v_cos_f32 v178, v209
    v_mfma_f32_16x16x32_bf16 v[100:103], v[116:119], a[228:231], v[100:103]
    buffer_load_dwordx4 v[228:231], v245, s[20:23], s96 offen offset:0 sc1
    s_waitcnt lgkmcnt(4)
    v_mfma_f32_16x16x32_bf16 v[72:75], v[120:123], a[232:235], v[72:75]
    v_sin_f32 v179, v209
    v_mul_f32 v178, v178, v208
    v_mfma_f32_16x16x32_bf16 v[88:91], v[120:123], a[236:239], v[88:91]
    v_mul_f32 v179, v179, v208
    v_mul_f32 v208, 0x43800000, v206
    v_mfma_f32_16x16x32_bf16 v[76:79], v[124:127], a[232:235], v[76:79]
    v_mul_f32 v209, 0xc3800000, v207
    v_exp_f32 v208, v208
    v_mfma_f32_16x16x32_bf16 v[92:95], v[124:127], a[236:239], v[92:95]
    v_fract_f32 v209, v209
    s_waitcnt lgkmcnt(0)
    v_mfma_f32_16x16x32_bf16 v[80:83], v[128:131], a[232:235], v[80:83]
    v_cos_f32 v180, v209
    v_sin_f32 v181, v209
    v_mfma_f32_16x16x32_bf16 v[96:99], v[128:131], a[236:239], v[96:99]
    buffer_load_dwordx4 v[232:235], v245, s[20:23], s96 offen offset:2048 sc1
    v_mul_f32 v180, v180, v208
    v_mfma_f32_16x16x32_bf16 v[84:87], v[132:135], a[232:235], v[84:87]
    buffer_load_dwordx4 v[236:239], v245, s[20:23], s97 offen offset:0 sc1
    v_mul_f32 v181, v181, v208
    v_mfma_f32_16x16x32_bf16 v[100:103], v[132:135], a[236:239], v[100:103]
    s_barrier
    v_cvt_pk_bf16_f32 v104, v72, v73
    v_cvt_pk_bf16_f32 v105, v74, v75
    ds_write_b64 v246, v[104:105] offset:0
    v_cvt_pk_bf16_f32 v106, v76, v77
    v_cvt_pk_bf16_f32 v107, v78, v79
    ds_write_b64 v246, v[106:107] offset:2048
    v_cvt_pk_bf16_f32 v108, v80, v81
    v_cvt_pk_bf16_f32 v109, v82, v83
    ds_write_b64 v246, v[108:109] offset:4096
    v_cvt_pk_bf16_f32 v110, v84, v85
    v_cvt_pk_bf16_f32 v111, v86, v87
    ds_write_b64 v246, v[110:111] offset:6144
    v_cvt_pk_bf16_f32 v104, v88, v89
    v_cvt_pk_bf16_f32 v105, v90, v91
    ds_write_b64 v246, v[104:105] offset:512
    v_cvt_pk_bf16_f32 v106, v92, v93
    v_cvt_pk_bf16_f32 v107, v94, v95
    ds_write_b64 v246, v[106:107] offset:2560
    v_cvt_pk_bf16_f32 v108, v96, v97
    v_cvt_pk_bf16_f32 v109, v98, v99
    ds_write_b64 v246, v[108:109] offset:4608
    v_cvt_pk_bf16_f32 v110, v100, v101
    v_cvt_pk_bf16_f32 v111, v102, v103
    ds_write_b64 v246, v[110:111] offset:6656
    v_mov_b32 v88, 0x00003f80
    v_cvt_pk_bf16_f32 v129, v146, v147
    v_cvt_pk_bf16_f32 v72, v182, v183
    s_add_u32 m0, s95, 0
    s_add_u32 s100, s4, 512
    buffer_load_dwordx4 v253, s[16:19], s100 offen offset:0  lds
    v_cvt_pk_bf16_f32 v130, v140, v141
    v_cvt_pk_bf16_f32 v89, v176, v177
    v_cvt_pk_bf16_f32 v131, v144, v145
    s_add_u32 m0, s95, 0
    v_cvt_pk_bf16_f32 v104, v180, v181
    buffer_load_dwordx4 v252, s[16:19], s100 offen offset:1088  lds
    v_pk_mul_f32 v[30:31], v[146:147], v[142:143] op_sel_hi:[1,0]
    v_pk_mul_f32 v[32:33], v[182:183], v[178:179] op_sel_hi:[1,0]
    v_pk_mul_f32 v[34:35], v[140:141], v[140:141] op_sel_hi:[1,0]
    v_pk_mul_f32 v[36:37], v[176:177], v[176:177] op_sel_hi:[1,0]
    v_pk_fma_f32 v[146:147], v[146:147], v[142:143], v[30:31] op_sel:[1,1,0] op_sel_hi:[0,1,1] neg_lo:[1,0,0]
    v_pk_fma_f32 v[182:183], v[182:183], v[178:179], v[32:33] op_sel:[1,1,0] op_sel_hi:[0,1,1] neg_lo:[1,0,0]
    v_pk_fma_f32 v[152:153], v[140:141], v[140:141], v[34:35] op_sel:[1,1,0] op_sel_hi:[0,1,1] neg_lo:[1,0,0]
    v_pk_fma_f32 v[188:189], v[176:177], v[176:177], v[36:37] op_sel:[1,1,0] op_sel_hi:[0,1,1] neg_lo:[1,0,0]
    v_cvt_pk_bf16_f32 v132, v146, v147
    s_mov_b32 m0, s101
    v_cvt_pk_bf16_f32 v73, v182, v183
    ds_write_addtid_b32 v88 offset:51712
    ds_write_addtid_b32 v129 offset:47104
    ds_write_addtid_b32 v130 offset:52000
    ds_write_addtid_b32 v131 offset:56320
    v_cvt_pk_bf16_f32 v133, v152, v153
    s_add_u32 m0, s95, 0
    v_cvt_pk_bf16_f32 v90, v188, v189
    buffer_load_dwordx4 v249, s[16:19], s100 offen offset:2176  lds
    v_pk_mul_f32 v[30:31], v[146:147], v[142:143] op_sel_hi:[1,0]
    v_pk_mul_f32 v[32:33], v[182:183], v[178:179] op_sel_hi:[1,0]
    v_pk_mul_f32 v[34:35], v[152:153], v[140:141] op_sel_hi:[1,0]
    v_pk_mul_f32 v[36:37], v[188:189], v[176:177] op_sel_hi:[1,0]
    v_pk_fma_f32 v[146:147], v[146:147], v[142:143], v[30:31] op_sel:[1,1,0] op_sel_hi:[0,1,1] neg_lo:[1,0,0]
    v_pk_fma_f32 v[182:183], v[182:183], v[178:179], v[32:33] op_sel:[1,1,0] op_sel_hi:[0,1,1] neg_lo:[1,0,0]
    v_pk_fma_f32 v[148:149], v[152:153], v[140:141], v[34:35] op_sel:[1,1,0] op_sel_hi:[0,1,1] neg_lo:[1,0,0]
    v_pk_fma_f32 v[184:185], v[188:189], v[176:177], v[36:37] op_sel:[1,1,0] op_sel_hi:[0,1,1] neg_lo:[1,0,0]
    v_cvt_pk_bf16_f32 v134, v146, v147
    v_cvt_pk_bf16_f32 v74, v182, v183
    v_cvt_pk_bf16_f32 v135, v148, v149
    s_add_u32 m0, s95, 0
    v_cvt_pk_bf16_f32 v91, v184, v185
    buffer_load_dwordx4 v248, s[16:19], s100 offen offset:3264  lds
    v_pk_mul_f32 v[30:31], v[146:147], v[142:143] op_sel_hi:[1,0]
    v_pk_mul_f32 v[32:33], v[182:183], v[178:179] op_sel_hi:[1,0]
    v_pk_mul_f32 v[34:35], v[148:149], v[140:141] op_sel_hi:[1,0]
L_stub1:
    s_cbranch_execz L_ret1
    v_pk_mul_f32 v[36:37], v[184:185], v[176:177] op_sel_hi:[1,0]
    v_pk_fma_f32 v[146:147], v[146:147], v[142:143], v[30:31] op_sel:[1,1,0] op_sel_hi:[0,1,1] neg_lo:[1,0,0]
    v_pk_fma_f32 v[182:183], v[182:183], v[178:179], v[32:33] op_sel:[1,1,0] op_sel_hi:[0,1,1] neg_lo:[1,0,0]
    v_pk_fma_f32 v[154:155], v[148:149], v[140:141], v[34:35] op_sel:[1,1,0] op_sel_hi:[0,1,1] neg_lo:[1,0,0]
    v_pk_fma_f32 v[190:191], v[184:185], v[176:177], v[36:37] op_sel:[1,1,0] op_sel_hi:[0,1,1] neg_lo:[1,0,0]
    v_cvt_pk_bf16_f32 v136, v146, v147
    s_mov_b32 m0, s101
    v_cvt_pk_bf16_f32 v75, v182, v183
    ds_write_addtid_b32 v132 offset:47392
    ds_write_addtid_b32 v133 offset:52288
    ds_write_addtid_b32 v134 offset:47680
    ds_write_addtid_b32 v135 offset:52576
    v_cvt_pk_bf16_f32 v129, v154, v155
    v_cvt_pk_bf16_f32 v92, v190, v191
    v_pk_mul_f32 v[30:31], v[146:147], v[142:143] op_sel_hi:[1,0]
    v_pk_mul_f32 v[32:33], v[182:183], v[178:179] op_sel_hi:[1,0]
    v_pk_mul_f32 v[34:35], v[154:155], v[140:141] op_sel_hi:[1,0]
    v_pk_mul_f32 v[36:37], v[190:191], v[176:177] op_sel_hi:[1,0]
    v_pk_fma_f32 v[146:147], v[146:147], v[142:143], v[30:31] op_sel:[1,1,0] op_sel_hi:[0,1,1] neg_lo:[1,0,0]
    v_pk_fma_f32 v[182:183], v[182:183], v[178:179], v[32:33] op_sel:[1,1,0] op_sel_hi:[0,1,1] neg_lo:[1,0,0]
    v_pk_fma_f32 v[148:149], v[154:155], v[140:141], v[34:35] op_sel:[1,1,0] op_sel_hi:[0,1,1] neg_lo:[1,0,0]
    v_pk_fma_f32 v[184:185], v[190:191], v[176:177], v[36:37] op_sel:[1,1,0] op_sel_hi:[0,1,1] neg_lo:[1,0,0]
    v_cvt_pk_bf16_f32 v130, v146, v147
    v_cvt_pk_bf16_f32 v76, v182, v183
    v_cvt_pk_bf16_f32 v131, v148, v149
    v_cvt_pk_bf16_f32 v93, v184, v185
    v_pk_mul_f32 v[30:31], v[146:147], v[142:143] op_sel_hi:[1,0]
    v_pk_mul_f32 v[32:33], v[182:183], v[178:179] op_sel_hi:[1,0]
    v_pk_mul_f32 v[34:35], v[148:149], v[140:141] op_sel_hi:[1,0]
    v_pk_mul_f32 v[36:37], v[184:185], v[176:177] op_sel_hi:[1,0]
    v_pk_fma_f32 v[146:147], v[146:147], v[142:143], v[30:31] op_sel:[1,1,0] op_sel_hi:[0,1,1] neg_lo:[1,0,0]
    v_pk_fma_f32 v[182:183], v[182:183], v[178:179], v[32:33] op_sel:[1,1,0] op_sel_hi:[0,1,1] neg_lo:[1,0,0]
    v_pk_fma_f32 v[156:157], v[148:149], v[140:141], v[34:35] op_sel:[1,1,0] op_sel_hi:[0,1,1] neg_lo:[1,0,0]
    v_pk_fma_f32 v[192:193], v[184:185], v[176:177], v[36:37] op_sel:[1,1,0] op_sel_hi:[0,1,1] neg_lo:[1,0,0]
    v_cvt_pk_bf16_f32 v132, v146, v147
    s_mov_b32 m0, s101
    v_cvt_pk_bf16_f32 v77, v182, v183
    ds_write_addtid_b32 v136 offset:47968
    ds_write_addtid_b32 v129 offset:52864
    ds_write_addtid_b32 v130 offset:48256
    ds_write_addtid_b32 v131 offset:53152
    v_cvt_pk_bf16_f32 v133, v156, v157
    v_cvt_pk_bf16_f32 v94, v192, v193
    v_pk_mul_f32 v[30:31], v[146:147], v[142:143] op_sel_hi:[1,0]
    v_pk_mul_f32 v[32:33], v[182:183], v[178:179] op_sel_hi:[1,0]
    v_pk_mul_f32 v[34:35], v[156:157], v[140:141] op_sel_hi:[1,0]
    v_pk_mul_f32 v[36:37], v[192:193], v[176:177] op_sel_hi:[1,0]
    v_pk_fma_f32 v[146:147], v[146:147], v[142:143], v[30:31] op_sel:[1,1,0] op_sel_hi:[0,1,1] neg_lo:[1,0,0]
    v_pk_fma_f32 v[182:183], v[182:183], v[178:179], v[32:33] op_sel:[1,1,0] op_sel_hi:[0,1,1] neg_lo:[1,0,0]
    v_pk_fma_f32 v[148:149], v[156:157], v[140:141], v[34:35] op_sel:[1,1,0] op_sel_hi:[0,1,1] neg_lo:[1,0,0]
    v_pk_fma_f32 v[184:185], v[192:193], v[176:177], v[36:37] op_sel:[1,1,0] op_sel_hi:[0,1,1] neg_lo:[1,0,0]
    v_cvt_pk_bf16_f32 v134, v146, v147
    v_cvt_pk_bf16_f32 v78, v182, v183
    v_cvt_pk_bf16_f32 v135, v148, v149
    v_cvt_pk_bf16_f32 v95, v184, v185
    v_pk_mul_f32 v[30:31], v[146:147], v[142:143] op_sel_hi:[1,0]
    v_pk_mul_f32 v[32:33], v[182:183], v[178:179] op_sel_hi:[1,0]
    v_pk_mul_f32 v[34:35], v[148:149], v[140:141] op_sel_hi:[1,0]
    v_pk_mul_f32 v[36:37], v[184:185], v[176:177] op_sel_hi:[1,0]
    v_pk_fma_f32 v[146:147], v[146:147], v[142:143], v[30:31] op_sel:[1,1,0] op_sel_hi:[0,1,1] neg_lo:[1,0,0]
    v_pk_fma_f32 v[182:183], v[182:183], v[178:179], v[32:33] op_sel:[1,1,0] op_sel_hi:[0,1,1] neg_lo:[1,0,0]
    v_pk_fma_f32 v[158:159], v[148:149], v[140:141], v[34:35] op_sel:[1,1,0] op_sel_hi:[0,1,1] neg_lo:[1,0,0]
    v_pk_fma_f32 v[194:195], v[184:185], v[176:177], v[36:37] op_sel:[1,1,0] op_sel_hi:[0,1,1] neg_lo:[1,0,0]
    v_cvt_pk_bf16_f32 v136, v146, v147
    s_mov_b32 m0, s101
    v_cvt_pk_bf16_f32 v79, v182, v183
    ds_write_addtid_b32 v132 offset:48544
    ds_write_addtid_b32 v133 offset:53440
    ds_write_addtid_b32 v134 offset:48832
    ds_write_addtid_b32 v135 offset:53728
    v_cvt_pk_bf16_f32 v129, v158, v159
    v_cvt_pk_bf16_f32 v96, v194, v195
    v_pk_mul_f32 v[30:31], v[146:147], v[142:143] op_sel_hi:[1,0]
    v_pk_mul_f32 v[32:33], v[182:183], v[178:179] op_sel_hi:[1,0]
    v_pk_mul_f32 v[34:35], v[158:159], v[140:141] op_sel_hi:[1,0]
    v_pk_mul_f32 v[36:37], v[194:195], v[176:177] op_sel_hi:[1,0]
    v_pk_fma_f32 v[146:147], v[146:147], v[142:143], v[30:31] op_sel:[1,1,0] op_sel_hi:[0,1,1] neg_lo:[1,0,0]
    v_pk_fma_f32 v[182:183], v[182:183], v[178:179], v[32:33] op_sel:[1,1,0] op_sel_hi:[0,1,1] neg_lo:[1,0,0]
    v_pk_fma_f32 v[148:149], v[158:159], v[140:141], v[34:35] op_sel:[1,1,0] op_sel_hi:[0,1,1] neg_lo:[1,0,0]
    v_pk_fma_f32 v[184:185], v[194:195], v[176:177], v[36:37] op_sel:[1,1,0] op_sel_hi:[0,1,1] neg_lo:[1,0,0]
    v_cvt_pk_bf16_f32 v130, v146, v147
    v_cvt_pk_bf16_f32 v80, v182, v183
    v_cvt_pk_bf16_f32 v131, v148, v149
    v_cvt_pk_bf16_f32 v97, v184, v185
    v_pk_mul_f32 v[30:31], v[146:147], v[142:143] op_sel_hi:[1,0]
    v_pk_mul_f32 v[32:33], v[182:183], v[178:179] op_sel_hi:[1,0]
    v_pk_mul_f32 v[34:35], v[148:149], v[140:141] op_sel_hi:[1,0]
    v_pk_mul_f32 v[36:37], v[184:185], v[176:177] op_sel_hi:[1,0]
    v_pk_fma_f32 v[146:147], v[146:147], v[142:143], v[30:31] op_sel:[1,1,0] op_sel_hi:[0,1,1] neg_lo:[1,0,0]
    v_pk_fma_f32 v[182:183], v[182:183], v[178:179], v[32:33] op_sel:[1,1,0] op_sel_hi:[0,1,1] neg_lo:[1,0,0]
    v_pk_fma_f32 v[160:161], v[148:149], v[140:141], v[34:35] op_sel:[1,1,0] op_sel_hi:[0,1,1] neg_lo:[1,0,0]
    v_pk_fma_f32 v[196:197], v[184:185], v[176:177], v[36:37] op_sel:[1,1,0] op_sel_hi:[0,1,1] neg_lo:[1,0,0]
    v_cvt_pk_bf16_f32 v132, v146, v147
    s_mov_b32 m0, s101
    v_cvt_pk_bf16_f32 v81, v182, v183
    ds_write_addtid_b32 v136 offset:49120
    ds_write_addtid_b32 v129 offset:54016
    ds_write_addtid_b32 v130 offset:49408
    ds_write_addtid_b32 v131 offset:54304
    v_cvt_pk_bf16_f32 v133, v160, v161
    v_cvt_pk_bf16_f32 v98, v196, v197
    s_mov_b32 s33, 0
    s_waitcnt vmcnt(4)
    s_branch L_stf6
L_st4:
    buffer_load_dwordx4 v[212:215], v245, s[20:23], s76 offen offset:0 sc1
    buffer_load_dwordx4 v[216:219], v245, s[20:23], s76 offen offset:2048 sc1
    buffer_load_dwordx4 v[220:223], v245, s[20:23], s77 offen offset:0 sc1
    buffer_load_dwordx4 v[224:227], v245, s[20:23], s77 offen offset:2048 sc1
    buffer_load_dwordx4 v[228:231], v245, s[20:23], s96 offen offset:0 sc1
    buffer_load_dwordx4 v[232:235], v245, s[20:23], s96 offen offset:2048 sc1
    buffer_load_dwordx4 v[236:239], v245, s[20:23], s97 offen offset:0 sc1
    s_waitcnt vmcnt(0)
L_stf6:
    s_add_u32 s33, s33, 1
    v_min3_u32 v122, v213, v215, v217
    v_max3_u32 v123, v213, v215, v217
    v_min3_u32 v122, v122, v219, v221
    v_max3_u32 v123, v123, v219, v221
    v_min3_u32 v122, v122, v223, v225
    v_max3_u32 v123, v123, v223, v225
    v_min3_u32 v122, v122, v227, v229
    v_max3_u32 v123, v123, v227, v229
    v_min3_u32 v122, v122, v231, v233
    v_max3_u32 v123, v123, v231, v233
    v_min3_u32 v122, v122, v235, v237
    v_max3_u32 v123, v123, v235, v237
    v_min_u32 v122, v122, v239
    v_max_u32 v123, v123, v239
    v_cmp_ne_u32 vcc, s31, v122
    v_cmp_ne_u32 s[36:37], s31, v123
    s_nop 0
    s_or_b64 vcc, vcc, s[36:37]
    s_cbranch_scc0 L_std5
    s_cmp_lt_u32 s33, 4000000
    s_cbranch_scc1 L_st4
L_std5:
    v_add_f32 v212, v212, v216
    v_add_f32 v220, v220, v224
    v_add_f32 v228, v228, v232
    v_add_f32 v214, v214, v218
    v_add_f32 v222, v222, v226
    v_add_f32 v230, v230, v234
    v_add_f32 v212, v212, v236
    v_add_f32 v220, v220, v228
    v_add_f32 v214, v214, v238
    v_add_f32 v222, v222, v230
    v_add_f32 v212, v212, v220
    v_add_f32 v213, v214, v222
    s_nop 0
    v_add_f32_dpp v212, v212, v212 row_ror:8 row_mask:0xf bank_mask:0xf
    v_add_f32_dpp v213, v213, v213 row_ror:8 row_mask:0xf bank_mask:0xf
    v_mul_f32 v212, 0xba924925, v212
    v_mul_f32 v213, 0x3a924925, v213
    v_fma_f32 v213, -v212, v212, v213
    v_max_f32 v213, 0, v213
    v_add_f32 v213, 0x3727c5ac, v213
    v_rsq_f32 v213, v213
    s_nop 0
    v_mul_f32 v212, v212, v213
    v_mov_b32_dpp v106, v213 row_newbcast:0 row_mask:0xf bank_mask:0xf
    v_mov_b32_dpp v107, v213 row_newbcast:1 row_mask:0xf bank_mask:0xf
    v_mov_b32_dpp v108, v213 row_newbcast:2 row_mask:0xf bank_mask:0xf
    v_mov_b32_dpp v109, v213 row_newbcast:3 row_mask:0xf bank_mask:0xf
    v_mov_b32_dpp v110, v213 row_newbcast:4 row_mask:0xf bank_mask:0xf
    v_mov_b32_dpp v111, v213 row_newbcast:5 row_mask:0xf bank_mask:0xf
    v_mov_b32_dpp v112, v213 row_newbcast:6 row_mask:0xf bank_mask:0xf
    v_mov_b32_dpp v113, v213 row_newbcast:7 row_mask:0xf bank_mask:0xf
    v_mov_b32_dpp v114, v212 row_newbcast:0 row_mask:0xf bank_mask:0xf
    v_mov_b32_dpp v115, v212 row_newbcast:1 row_mask:0xf bank_mask:0xf
    v_mov_b32_dpp v116, v212 row_newbcast:2 row_mask:0xf bank_mask:0xf
    v_mov_b32_dpp v117, v212 row_newbcast:3 row_mask:0xf bank_mask:0xf
    v_mov_b32_dpp v118, v212 row_newbcast:4 row_mask:0xf bank_mask:0xf
    v_mov_b32_dpp v119, v212 row_newbcast:5 row_mask:0xf bank_mask:0xf
    v_mov_b32_dpp v120, v212 row_newbcast:6 row_mask:0xf bank_mask:0xf
    v_mov_b32_dpp v121, v212 row_newbcast:7 row_mask:0xf bank_mask:0xf
    v_pk_fma_f32 v[40:41], v[40:41], v[106:107], v[114:115]
    v_pk_fma_f32 v[42:43], v[42:43], v[108:109], v[116:117]
    v_pk_fma_f32 v[56:57], v[56:57], v[110:111], v[118:119]
    v_pk_fma_f32 v[58:59], v[58:59], v[112:113], v[120:121]
    v_cvt_pk_bf16_f32 v40, v40, v41
    v_cvt_pk_bf16_f32 v41, v42, v43
    v_cvt_pk_bf16_f32 v42, v56, v57
    v_cvt_pk_bf16_f32 v43, v58, v59
    buffer_store_dwordx4 v[40:43], v4, s[20:23], s71 offen sc1
    s_add_u32 s71, s71, 0x10000
    v_pk_fma_f32 v[44:45], v[44:45], v[106:107], v[114:115]
    v_pk_fma_f32 v[46:47], v[46:47], v[108:109], v[116:117]
    v_pk_fma_f32 v[60:61], v[60:61], v[110:111], v[118:119]
    v_pk_fma_f32 v[62:63], v[62:63], v[112:113], v[120:121]
    v_cvt_pk_bf16_f32 v44, v44, v45
    v_cvt_pk_bf16_f32 v45, v46, v47
    v_cvt_pk_bf16_f32 v46, v60, v61
    v_cvt_pk_bf16_f32 v47, v62, v63
    buffer_store_dwordx4 v[44:47], v4, s[20:23], s71 offen sc1
    s_add_u32 s71, s71, 0x10000
    v_pk_fma_f32 v[48:49], v[48:49], v[106:107], v[114:115]
    v_pk_fma_f32 v[50:51], v[50:51], v[108:109], v[116:117]
    v_pk_fma_f32 v[64:65], v[64:65], v[110:111], v[118:119]
    v_pk_fma_f32 v[66:67], v[66:67], v[112:113], v[120:121]
    v_cvt_pk_bf16_f32 v48, v48, v49
    v_cvt_pk_bf16_f32 v49, v50, v51
    v_cvt_pk_bf16_f32 v50, v64, v65
    v_cvt_pk_bf16_f32 v51, v66, v67
    buffer_store_dwordx4 v[48:51], v4, s[20:23], s71 offen sc1
    s_add_u32 s71, s71, 0x10000
    v_pk_fma_f32 v[52:53], v[52:53], v[106:107], v[114:115]
    v_pk_fma_f32 v[54:55], v[54:55], v[108:109], v[116:117]
    v_pk_fma_f32 v[68:69], v[68:69], v[110:111], v[118:119]
    v_pk_fma_f32 v[70:71], v[70:71], v[112:113], v[120:121]
    v_cvt_pk_bf16_f32 v52, v52, v53
    v_cvt_pk_bf16_f32 v53, v54, v55
    v_cvt_pk_bf16_f32 v54, v68, v69
    v_cvt_pk_bf16_f32 v55, v70, v71
    buffer_store_dwordx4 v[52:55], v4, s[20:23], s71 offen sc1
    v_pk_mul_f32 v[30:31], v[146:147], v[142:143] op_sel_hi:[1,0]
    v_pk_mul_f32 v[32:33], v[182:183], v[178:179] op_sel_hi:[1,0]
    v_pk_mul_f32 v[34:35], v[160:161], v[140:141] op_sel_hi:[1,0]
    v_pk_mul_f32 v[36:37], v[196:197], v[176:177] op_sel_hi:[1,0]
    v_pk_fma_f32 v[146:147], v[146:147], v[142:143], v[30:31] op_sel:[1,1,0] op_sel_hi:[0,1,1] neg_lo:[1,0,0]
    v_pk_fma_f32 v[182:183], v[182:183], v[178:179], v[32:33] op_sel:[1,1,0] op_sel_hi:[0,1,1] neg_lo:[1,0,0]
    v_pk_fma_f32 v[148:149], v[160:161], v[140:141], v[34:35] op_sel:[1,1,0] op_sel_hi:[0,1,1] neg_lo:[1,0,0]
    v_pk_fma_f32 v[184:185], v[196:197], v[176:177], v[36:37] op_sel:[1,1,0] op_sel_hi:[0,1,1] neg_lo:[1,0,0]
    v_cvt_pk_bf16_f32 v134, v146, v147
    v_cvt_pk_bf16_f32 v82, v182, v183
    v_cvt_pk_bf16_f32 v135, v148, v149
    v_cvt_pk_bf16_f32 v99, v184, v185
    s_add_u32 m0, s95, 4352
    s_add_u32 s100, s4, 66048
    buffer_load_dwordx4 v253, s[16:19], s100 offen offset:0  lds
    v_pk_mul_f32 v[30:31], v[146:147], v[142:143] op_sel_hi:[1,0]
    v_pk_mul_f32 v[32:33], v[182:183], v[178:179] op_sel_hi:[1,0]
    v_pk_mul_f32 v[34:35], v[148:149], v[140:141] op_sel_hi:[1,0]
    v_pk_mul_f32 v[36:37], v[184:185], v[176:177] op_sel_hi:[1,0]
    v_pk_fma_f32 v[146:147], v[146:147], v[142:143], v[30:31] op_sel:[1,1,0] op_sel_hi:[0,1,1] neg_lo:[1,0,0]
    v_pk_fma_f32 v[182:183], v[182:183], v[178:179], v[32:33] op_sel:[1,1,0] op_sel_hi:[0,1,1] neg_lo:[1,0,0]
    v_pk_fma_f32 v[162:163], v[148:149], v[140:141], v[34:35] op_sel:[1,1,0] op_sel_hi:[0,1,1] neg_lo:[1,0,0]
    v_pk_fma_f32 v[198:199], v[184:185], v[176:177], v[36:37] op_sel:[1,1,0] op_sel_hi:[0,1,1] neg_lo:[1,0,0]
    v_cvt_pk_bf16_f32 v136, v146, v147
    s_mov_b32 m0, s101
    v_cvt_pk_bf16_f32 v83, v182, v183
    ds_write_addtid_b32 v132 offset:49696
    ds_write_addtid_b32 v133 offset:54592
    ds_write_addtid_b32 v134 offset:49984
    ds_write_addtid_b32 v135 offset:54880
    v_cvt_pk_bf16_f32 v129, v162, v163
    s_add_u32 m0, s95, 4352
    v_cvt_pk_bf16_f32 v100, v198, v199
    buffer_load_dwordx4 v252, s[16:19], s100 offen offset:1088  lds
    v_pk_mul_f32 v[30:31], v[146:147], v[142:143] op_sel_hi:[1,0]
    v_pk_mul_f32 v[32:33], v[182:183], v[178:179] op_sel_hi:[1,0]
    v_pk_mul_f32 v[34:35], v[162:163], v[140:141] op_sel_hi:[1,0]
    v_pk_mul_f32 v[36:37], v[198:199], v[176:177] op_sel_hi:[1,0]
    v_pk_fma_f32 v[146:147], v[146:147], v[142:143], v[30:31] op_sel:[1,1,0] op_sel_hi:[0,1,1] neg_lo:[1,0,0]
    v_pk_fma_f32 v[182:183], v[182:183], v[178:179], v[32:33] op_sel:[1,1,0] op_sel_hi:[0,1,1] neg_lo:[1,0,0]
    v_pk_fma_f32 v[148:149], v[162:163], v[140:141], v[34:35] op_sel:[1,1,0] op_sel_hi:[0,1,1] neg_lo:[1,0,0]
    v_pk_fma_f32 v[184:185], v[198:199], v[176:177], v[36:37] op_sel:[1,1,0] op_sel_hi:[0,1,1] neg_lo:[1,0,0]
    v_cvt_pk_bf16_f32 v130, v146, v147
    v_cvt_pk_bf16_f32 v84, v182, v183
    v_cvt_pk_bf16_f32 v131, v148, v149
    s_add_u32 m0, s95, 4352
    v_cvt_pk_bf16_f32 v101, v184, v185
    buffer_load_dwordx4 v249, s[16:19], s100 offen offset:2176  lds
    v_pk_mul_f32 v[30:31], v[146:147], v[142:143] op_sel_hi:[1,0]
    v_pk_mul_f32 v[32:33], v[182:183], v[178:179] op_sel_hi:[1,0]
    v_pk_mul_f32 v[34:35], v[148:149], v[140:141] op_sel_hi:[1,0]
    v_pk_mul_f32 v[36:37], v[184:185], v[176:177] op_sel_hi:[1,0]
    v_pk_fma_f32 v[146:147], v[146:147], v[142:143], v[30:31] op_sel:[1,1,0] op_sel_hi:[0,1,1] neg_lo:[1,0,0]
    v_pk_fma_f32 v[182:183], v[182:183], v[178:179], v[32:33] op_sel:[1,1,0] op_sel_hi:[0,1,1] neg_lo:[1,0,0]
    v_pk_fma_f32 v[164:165], v[148:149], v[140:141], v[34:35] op_sel:[1,1,0] op_sel_hi:[0,1,1] neg_lo:[1,0,0]
    v_pk_fma_f32 v[200:201], v[184:185], v[176:177], v[36:37] op_sel:[1,1,0] op_sel_hi:[0,1,1] neg_lo:[1,0,0]
    v_cvt_pk_bf16_f32 v132, v146, v147
    s_mov_b32 m0, s101
    v_cvt_pk_bf16_f32 v85, v182, v183
    ds_write_addtid_b32 v136 offset:50272
    ds_write_addtid_b32 v129 offset:55168
    ds_write_addtid_b32 v130 offset:50560
    ds_write_addtid_b32 v131 offset:55456
    v_cvt_pk_bf16_f32 v133, v164, v165
    s_add_u32 m0, s95, 4352
    v_cvt_pk_bf16_f32 v102, v200, v201
    buffer_load_dwordx4 v248, s[16:19], s100 offen offset:3264  lds
    v_pk_mul_f32 v[30:31], v[146:147], v[142:143] op_sel_hi:[1,0]
    v_pk_mul_f32 v[32:33], v[182:183], v[178:179] op_sel_hi:[1,0]
    v_pk_mul_f32 v[34:35], v[164:165], v[140:141] op_sel_hi:[1,0]
    v_pk_mul_f32 v[36:37], v[200:201], v[176:177] op_sel_hi:[1,0]
    v_pk_fma_f32 v[146:147], v[146:147], v[142:143], v[30:31] op_sel:[1,1,0] op_sel_hi:[0,1,1] neg_lo:[1,0,0]
    v_pk_fma_f32 v[182:183], v[182:183], v[178:179], v[32:33] op_sel:[1,1,0] op_sel_hi:[0,1,1] neg_lo:[1,0,0]
    v_pk_fma_f32 v[148:149], v[164:165], v[140:141], v[34:35] op_sel:[1,1,0] op_sel_hi:[0,1,1] neg_lo:[1,0,0]
    v_pk_fma_f32 v[184:185], v[200:201], v[176:177], v[36:37] op_sel:[1,1,0] op_sel_hi:[0,1,1] neg_lo:[1,0,0]
    v_cvt_pk_bf16_f32 v134, v146, v147
    v_cvt_pk_bf16_f32 v86, v182, v183
    v_cvt_pk_bf16_f32 v135, v148, v149
    v_cvt_pk_bf16_f32 v103, v184, v185
    ds_read_b128 a[0:3], v250 offset:0
    ds_read_b128 a[4:7], v250 offset:64
    v_pk_mul_f32 v[30:31], v[146:147], v[142:143] op_sel_hi:[1,0]
    v_pk_mul_f32 v[32:33], v[182:183], v[178:179] op_sel_hi:[1,0]
    v_pk_fma_f32 v[146:147], v[146:147], v[142:143], v[30:31] op_sel:[1,1,0] op_sel_hi:[0,1,1] neg_lo:[1,0,0]
    v_pk_fma_f32 v[182:183], v[182:183], v[178:179], v[32:33] op_sel:[1,1,0] op_sel_hi:[0,1,1] neg_lo:[1,0,0]
    v_cvt_pk_bf16_f32 v136, v146, v147
    s_mov_b32 m0, s101
    v_cvt_pk_bf16_f32 v87, v182, v183
    ds_write_addtid_b32 v132 offset:50848
    ds_write_addtid_b32 v133 offset:55744
    ds_write_addtid_b32 v134 offset:51136
    ds_write_addtid_b32 v135 offset:56032
    v_pk_mul_f32 v[30:31], v[144:145], v[152:153] op_sel_hi:[1,0]
    v_pk_mul_f32 v[32:33], v[180:181], v[188:189] op_sel_hi:[1,0]
    v_pk_mul_f32 v[34:35], v[144:145], v[154:155] op_sel_hi:[1,0]
    v_pk_mul_f32 v[36:37], v[180:181], v[190:191] op_sel_hi:[1,0]
    v_pk_fma_f32 v[148:149], v[144:145], v[152:153], v[30:31] op_sel:[1,1,0] op_sel_hi:[0,1,1] neg_lo:[1,0,0]
    v_pk_fma_f32 v[184:185], v[180:181], v[188:189], v[32:33] op_sel:[1,1,0] op_sel_hi:[0,1,1] neg_lo:[1,0,0]
    v_pk_fma_f32 v[174:175], v[144:145], v[154:155], v[34:35] op_sel:[1,1,0] op_sel_hi:[0,1,1] neg_lo:[1,0,0]
    v_pk_fma_f32 v[210:211], v[180:181], v[190:191], v[36:37] op_sel:[1,1,0] op_sel_hi:[0,1,1] neg_lo:[1,0,0]
    v_cvt_pk_bf16_f32 v129, v148, v149
    v_cvt_pk_bf16_f32 v105, v184, v185
    ds_read_b128 a[8:11], v250 offset:128
    ds_read_b128 a[12:15], v250 offset:192
    v_cvt_pk_bf16_f32 v130, v174, v175
    v_cvt_pk_bf16_f32 v106, v210, v211
    v_pk_mul_f32 v[30:31], v[144:145], v[156:157] op_sel_hi:[1,0]
    v_pk_mul_f32 v[32:33], v[180:181], v[192:193] op_sel_hi:[1,0]
    v_pk_mul_f32 v[34:35], v[144:145], v[158:159] op_sel_hi:[1,0]
    v_pk_mul_f32 v[36:37], v[180:181], v[194:195] op_sel_hi:[1,0]
    v_pk_fma_f32 v[148:149], v[144:145], v[156:157], v[30:31] op_sel:[1,1,0] op_sel_hi:[0,1,1] neg_lo:[1,0,0]
    v_pk_fma_f32 v[184:185], v[180:181], v[192:193], v[32:33] op_sel:[1,1,0] op_sel_hi:[0,1,1] neg_lo:[1,0,0]
    v_pk_fma_f32 v[174:175], v[144:145], v[158:159], v[34:35] op_sel:[1,1,0] op_sel_hi:[0,1,1] neg_lo:[1,0,0]
    v_pk_fma_f32 v[210:211], v[180:181], v[194:195], v[36:37] op_sel:[1,1,0] op_sel_hi:[0,1,1] neg_lo:[1,0,0]
    v_cvt_pk_bf16_f32 v131, v148, v149
    v_cvt_pk_bf16_f32 v107, v184, v185
    ds_read_b128 a[16:19], v250 offset:256
    ds_read_b128 a[20:23], v250 offset:320
    v_cvt_pk_bf16_f32 v132, v174, v175
    s_mov_b32 m0, s101
    v_cvt_pk_bf16_f32 v108, v210, v211
    ds_write_addtid_b32 v136 offset:51424
    ds_write_addtid_b32 v129 offset:56608
    ds_write_addtid_b32 v130 offset:56896
    ds_write_addtid_b32 v131 offset:57184
    v_pk_mul_f32 v[30:31], v[144:145], v[160:161] op_sel_hi:[1,0]
    v_pk_mul_f32 v[32:33], v[180:181], v[196:197] op_sel_hi:[1,0]
    v_pk_mul_f32 v[34:35], v[144:145], v[162:163] op_sel_hi:[1,0]
    v_pk_mul_f32 v[36:37], v[180:181], v[198:199] op_sel_hi:[1,0]
    v_pk_fma_f32 v[148:149], v[144:145], v[160:161], v[30:31] op_sel:[1,1,0] op_sel_hi:[0,1,1] neg_lo:[1,0,0]
    v_pk_fma_f32 v[184:185], v[180:181], v[196:197], v[32:33] op_sel:[1,1,0] op_sel_hi:[0,1,1] neg_lo:[1,0,0]
    v_pk_fma_f32 v[174:175], v[144:145], v[162:163], v[34:35] op_sel:[1,1,0] op_sel_hi:[0,1,1] neg_lo:[1,0,0]
    v_pk_fma_f32 v[210:211], v[180:181], v[198:199], v[36:37] op_sel:[1,1,0] op_sel_hi:[0,1,1] neg_lo:[1,0,0]
    v_cvt_pk_bf16_f32 v133, v148, v149
    v_cvt_pk_bf16_f32 v109, v184, v185
    ds_read_b128 a[24:27], v250 offset:384
    ds_read_b128 a[28:31], v250 offset:448
    v_cvt_pk_bf16_f32 v134, v174, v175
    v_cvt_pk_bf16_f32 v110, v210, v211
    v_pk_mul_f32 v[30:31], v[144:145], v[164:165] op_sel_hi:[1,0]
    v_pk_mul_f32 v[32:33], v[180:181], v[200:201] op_sel_hi:[1,0]
    v_pk_fma_f32 v[148:149], v[144:145], v[164:165], v[30:31] op_sel:[1,1,0] op_sel_hi:[0,1,1] neg_lo:[1,0,0]
    v_pk_fma_f32 v[184:185], v[180:181], v[200:201], v[32:33] op_sel:[1,1,0] op_sel_hi:[0,1,1] neg_lo:[1,0,0]
    v_cvt_pk_bf16_f32 v135, v148, v149
    v_cvt_pk_bf16_f32 v111, v184, v185
    v_pk_mul_f32 v[30:31], v[144:145], v[144:145] op_sel_hi:[1,0]
    v_pk_mul_f32 v[32:33], v[180:181], v[180:181] op_sel_hi:[1,0]
    v_pk_fma_f32 v[150:151], v[144:145], v[144:145], v[30:31] op_sel:[1,1,0] op_sel_hi:[0,1,1] neg_lo:[1,0,0]
    v_pk_fma_f32 v[186:187], v[180:181], v[180:181], v[32:33] op_sel:[1,1,0] op_sel_hi:[0,1,1] neg_lo:[1,0,0]
    v_cvt_pk_bf16_f32 v136, v150, v151
    s_mov_b32 m0, s101
    v_cvt_pk_bf16_f32 v112, v186, v187
    ds_write_addtid_b32 v132 offset:57472
    ds_write_addtid_b32 v133 offset:57760
    ds_write_addtid_b32 v134 offset:58048
    ds_write_addtid_b32 v135 offset:58336
    v_pk_mul_f32 v[30:31], v[150:151], v[154:155] op_sel_hi:[1,0]
    v_pk_mul_f32 v[32:33], v[186:187], v[190:191] op_sel_hi:[1,0]
    v_pk_mul_f32 v[34:35], v[150:151], v[158:159] op_sel_hi:[1,0]
    v_pk_mul_f32 v[36:37], v[186:187], v[194:195] op_sel_hi:[1,0]
    v_pk_fma_f32 v[148:149], v[150:151], v[154:155], v[30:31] op_sel:[1,1,0] op_sel_hi:[0,1,1] neg_lo:[1,0,0]
    v_pk_fma_f32 v[184:185], v[186:187], v[190:191], v[32:33] op_sel:[1,1,0] op_sel_hi:[0,1,1] neg_lo:[1,0,0]
    v_pk_fma_f32 v[174:175], v[150:151], v[158:159], v[34:35] op_sel:[1,1,0] op_sel_hi:[0,1,1] neg_lo:[1,0,0]
    v_pk_fma_f32 v[210:211], v[186:187], v[194:195], v[36:37] op_sel:[1,1,0] op_sel_hi:[0,1,1] neg_lo:[1,0,0]
    v_cvt_pk_bf16_f32 v129, v148, v149
    v_cvt_pk_bf16_f32 v113, v184, v185
    v_cvt_pk_bf16_f32 v130, v174, v175
    v_cvt_pk_bf16_f32 v114, v210, v211
    v_pk_mul_f32 v[30:31], v[150:151], v[162:163] op_sel_hi:[1,0]
    v_pk_mul_f32 v[32:33], v[186:187], v[198:199] op_sel_hi:[1,0]
    v_pk_mul_f32 v[34:35], v[150:151], v[144:145] op_sel_hi:[1,0]
    v_pk_mul_f32 v[36:37], v[186:187], v[180:181] op_sel_hi:[1,0]
    v_pk_fma_f32 v[148:149], v[150:151], v[162:163], v[30:31] op_sel:[1,1,0] op_sel_hi:[0,1,1] neg_lo:[1,0,0]
    v_pk_fma_f32 v[184:185], v[186:187], v[198:199], v[32:33] op_sel:[1,1,0] op_sel_hi:[0,1,1] neg_lo:[1,0,0]
    v_pk_fma_f32 v[150:151], v[150:151], v[144:145], v[34:35] op_sel:[1,1,0] op_sel_hi:[0,1,1] neg_lo:[1,0,0]
    v_pk_fma_f32 v[186:187], v[186:187], v[180:181], v[36:37] op_sel:[1,1,0] op_sel_hi:[0,1,1] neg_lo:[1,0,0]
    v_cvt_pk_bf16_f32 v131, v148, v149
    v_cvt_pk_bf16_f32 v115, v184, v185
    v_cvt_pk_bf16_f32 v132, v150, v151
    s_mov_b32 m0, s101
    v_cvt_pk_bf16_f32 v116, v186, v187
    ds_write_addtid_b32 v136 offset:58624
    ds_write_addtid_b32 v129 offset:58912
    ds_write_addtid_b32 v130 offset:59200
    ds_write_addtid_b32 v131 offset:59488
    v_pk_mul_f32 v[30:31], v[150:151], v[154:155] op_sel_hi:[1,0]
    v_pk_mul_f32 v[32:33], v[186:187], v[190:191] op_sel_hi:[1,0]
    v_pk_mul_f32 v[34:35], v[150:151], v[158:159] op_sel_hi:[1,0]
    v_pk_mul_f32 v[36:37], v[186:187], v[194:195] op_sel_hi:[1,0]
    v_pk_fma_f32 v[148:149], v[150:151], v[154:155], v[30:31] op_sel:[1,1,0] op_sel_hi:[0,1,1] neg_lo:[1,0,0]
    v_pk_fma_f32 v[184:185], v[186:187], v[190:191], v[32:33] op_sel:[1,1,0] op_sel_hi:[0,1,1] neg_lo:[1,0,0]
    v_pk_fma_f32 v[174:175], v[150:151], v[158:159], v[34:35] op_sel:[1,1,0] op_sel_hi:[0,1,1] neg_lo:[1,0,0]
    v_pk_fma_f32 v[210:211], v[186:187], v[194:195], v[36:37] op_sel:[1,1,0] op_sel_hi:[0,1,1] neg_lo:[1,0,0]
    v_cvt_pk_bf16_f32 v133, v148, v149
    v_cvt_pk_bf16_f32 v117, v184, v185
    v_cvt_pk_bf16_f32 v134, v174, v175
    v_cvt_pk_bf16_f32 v118, v210, v211
    v_pk_mul_f32 v[30:31], v[150:151], v[162:163] op_sel_hi:[1,0]
    v_pk_mul_f32 v[32:33], v[186:187], v[198:199] op_sel_hi:[1,0]
    v_pk_mul_f32 v[34:35], v[150:151], v[144:145] op_sel_hi:[1,0]
    v_pk_mul_f32 v[36:37], v[186:187], v[180:181] op_sel_hi:[1,0]
    v_pk_fma_f32 v[148:149], v[150:151], v[162:163], v[30:31] op_sel:[1,1,0] op_sel_hi:[0,1,1] neg_lo:[1,0,0]
    v_pk_fma_f32 v[184:185], v[186:187], v[198:199], v[32:33] op_sel:[1,1,0] op_sel_hi:[0,1,1] neg_lo:[1,0,0]
    v_pk_fma_f32 v[150:151], v[150:151], v[144:145], v[34:35] op_sel:[1,1,0] op_sel_hi:[0,1,1] neg_lo:[1,0,0]
    v_pk_fma_f32 v[186:187], v[186:187], v[180:181], v[36:37] op_sel:[1,1,0] op_sel_hi:[0,1,1] neg_lo:[1,0,0]
    v_cvt_pk_bf16_f32 v135, v148, v149
    v_cvt_pk_bf16_f32 v119, v184, v185
    v_cvt_pk_bf16_f32 v136, v150, v151
    s_mov_b32 m0, s101
    v_cvt_pk_bf16_f32 v120, v186, v187
    ds_write_addtid_b32 v132 offset:59776
    ds_write_addtid_b32 v133 offset:60064
    ds_write_addtid_b32 v134 offset:60352
    ds_write_addtid_b32 v135 offset:60640
    v_pk_mul_f32 v[30:31], v[150:151], v[158:159] op_sel_hi:[1,0]
    v_pk_mul_f32 v[32:33], v[186:187], v[194:195] op_sel_hi:[1,0]
    v_pk_mul_f32 v[34:35], v[150:151], v[144:145] op_sel_hi:[1,0]
    v_pk_mul_f32 v[36:37], v[186:187], v[180:181] op_sel_hi:[1,0]
    v_pk_fma_f32 v[148:149], v[150:151], v[158:159], v[30:31] op_sel:[1,1,0] op_sel_hi:[0,1,1] neg_lo:[1,0,0]
    v_pk_fma_f32 v[184:185], v[186:187], v[194:195], v[32:33] op_sel:[1,1,0] op_sel_hi:[0,1,1] neg_lo:[1,0,0]
    v_pk_fma_f32 v[150:151], v[150:151], v[144:145], v[34:35] op_sel:[1,1,0] op_sel_hi:[0,1,1] neg_lo:[1,0,0]
    v_pk_fma_f32 v[186:187], v[186:187], v[180:181], v[36:37] op_sel:[1,1,0] op_sel_hi:[0,1,1] neg_lo:[1,0,0]
    v_cvt_pk_bf16_f32 v129, v148, v149
    v_cvt_pk_bf16_f32 v121, v184, v185
    v_cvt_pk_bf16_f32 v130, v150, v151
    v_cvt_pk_bf16_f32 v122, v186, v187
    v_pk_mul_f32 v[30:31], v[150:151], v[158:159] op_sel_hi:[1,0]
    v_pk_mul_f32 v[32:33], v[186:187], v[194:195] op_sel_hi:[1,0]
    v_pk_mul_f32 v[34:35], v[150:151], v[144:145] op_sel_hi:[1,0]
    v_pk_mul_f32 v[36:37], v[186:187], v[180:181] op_sel_hi:[1,0]
    v_pk_fma_f32 v[148:149], v[150:151], v[158:159], v[30:31] op_sel:[1,1,0] op_sel_hi:[0,1,1] neg_lo:[1,0,0]
    v_pk_fma_f32 v[184:185], v[186:187], v[194:195], v[32:33] op_sel:[1,1,0] op_sel_hi:[0,1,1] neg_lo:[1,0,0]
    v_pk_fma_f32 v[150:151], v[150:151], v[144:145], v[34:35] op_sel:[1,1,0] op_sel_hi:[0,1,1] neg_lo:[1,0,0]
    v_pk_fma_f32 v[186:187], v[186:187], v[180:181], v[36:37] op_sel:[1,1,0] op_sel_hi:[0,1,1] neg_lo:[1,0,0]
    v_cvt_pk_bf16_f32 v131, v148, v149
    v_cvt_pk_bf16_f32 v123, v184, v185
    v_cvt_pk_bf16_f32 v132, v150, v151
    s_mov_b32 m0, s101
    v_cvt_pk_bf16_f32 v124, v186, v187
    ds_write_addtid_b32 v136 offset:60928
    ds_write_addtid_b32 v129 offset:61216
    ds_write_addtid_b32 v130 offset:61504
    ds_write_addtid_b32 v131 offset:61792
    v_pk_mul_f32 v[30:31], v[150:151], v[158:159] op_sel_hi:[1,0]
    v_pk_mul_f32 v[32:33], v[186:187], v[194:195] op_sel_hi:[1,0]
    v_pk_mul_f32 v[34:35], v[150:151], v[144:145] op_sel_hi:[1,0]
    v_pk_mul_f32 v[36:37], v[186:187], v[180:181] op_sel_hi:[1,0]
    v_pk_fma_f32 v[148:149], v[150:151], v[158:159], v[30:31] op_sel:[1,1,0] op_sel_hi:[0,1,1] neg_lo:[1,0,0]
    v_pk_fma_f32 v[184:185], v[186:187], v[194:195], v[32:33] op_sel:[1,1,0] op_sel_hi:[0,1,1] neg_lo:[1,0,0]
    v_pk_fma_f32 v[150:151], v[150:151], v[144:145], v[34:35] op_sel:[1,1,0] op_sel_hi:[0,1,1] neg_lo:[1,0,0]
    v_pk_fma_f32 v[186:187], v[186:187], v[180:181], v[36:37] op_sel:[1,1,0] op_sel_hi:[0,1,1] neg_lo:[1,0,0]
    v_cvt_pk_bf16_f32 v133, v148, v149
    v_cvt_pk_bf16_f32 v125, v184, v185
    v_cvt_pk_bf16_f32 v134, v150, v151
    v_cvt_pk_bf16_f32 v126, v186, v187
    v_pk_mul_f32 v[30:31], v[150:151], v[158:159] op_sel_hi:[1,0]
    v_pk_mul_f32 v[32:33], v[186:187], v[194:195] op_sel_hi:[1,0]
    v_pk_mul_f32 v[34:35], v[150:151], v[144:145] op_sel_hi:[1,0]
    v_pk_mul_f32 v[36:37], v[186:187], v[180:181] op_sel_hi:[1,0]
    v_pk_fma_f32 v[148:149], v[150:151], v[158:159], v[30:31] op_sel:[1,1,0] op_sel_hi:[0,1,1] neg_lo:[1,0,0]
    v_pk_fma_f32 v[184:185], v[186:187], v[194:195], v[32:33] op_sel:[1,1,0] op_sel_hi:[0,1,1] neg_lo:[1,0,0]
    v_pk_fma_f32 v[150:151], v[150:151], v[144:145], v[34:35] op_sel:[1,1,0] op_sel_hi:[0,1,1] neg_lo:[1,0,0]
    v_pk_fma_f32 v[186:187], v[186:187], v[180:181], v[36:37] op_sel:[1,1,0] op_sel_hi:[0,1,1] neg_lo:[1,0,0]
    v_cvt_pk_bf16_f32 v135, v148, v149
    v_cvt_pk_bf16_f32 v127, v184, v185
    v_cvt_pk_bf16_f32 v136, v150, v151
    s_mov_b32 m0, s101
    v_cvt_pk_bf16_f32 v128, v186, v187
    ds_write_addtid_b32 v132 offset:62080
    ds_write_addtid_b32 v133 offset:62368
    ds_write_addtid_b32 v134 offset:62656
    ds_write_addtid_b32 v135 offset:62944
    s_mov_b32 m0, s101
    s_nop 0
    ds_write_addtid_b32 v136 offset:63232
    s_waitcnt lgkmcnt(0)
    ds_read_b128 v[140:143], v243 offset:0
    ds_read_b128 v[144:147], v243 offset:4608
    ds_read_b128 v[148:151], v243 offset:9216
    ds_read_b128 v[152:155], v243 offset:13824
    ds_read_b128 v[156:159], v243 offset:64
    ds_read_b128 v[160:163], v243 offset:4672
    ds_read_b128 v[164:167], v243 offset:9280
    ds_read_b128 v[168:171], v243 offset:13888
    ds_read_b128 v[172:175], v243 offset:128
    ds_read_b128 v[176:179], v243 offset:4736
    ds_read_b128 v[180:183], v243 offset:9344
    ds_read_b128 v[184:187], v243 offset:13952
    ds_read_b128 v[188:191], v243 offset:192
    ds_read_b128 v[192:195], v243 offset:4800
    ds_read_b128 v[196:199], v243 offset:9408
    ds_read_b128 v[200:203], v243 offset:14016
    s_and_b32 s36, s30, 1
    s_mul_i32 s36, s36, 2816
    s_lshr_b32 s37, s30, 1
    s_mul_i32 s37, s37, 40960
    s_add_u32 s36, s36, s37
    s_add_u32 s36, s36, 116880
    v_lshlrev_b32 v220, 6, v2
    v_lshl_add_u32 v220, v3, 4, v220
    v_add_u32 v220, s36, v220
    v_lshlrev_b32 v221, 5, v2
    v_lshl_add_u32 v221, v3, 4, v221
    v_add_u32 v221, 1024, v221
    v_lshlrev_b32 v222, 4, v2
    v_lshl_add_u32 v222, v3, 8, v222
    v_add_u32 v222, 1024, v222
    s_mov_b32 exec_lo, 0x0
    s_mov_b32 exec_hi, 0xffffffff
    v_mov_b32 v221, v222
    s_mov_b64 exec, -1
    v_add_u32 v221, s36, v221
    v_lshlrev_b32 v222, 3, v2
    v_lshl_add_u32 v222, v3, 8, v222
    v_add_u32 v222, s36, v222
    v_mov_b32 v223, s36
    s_waitcnt lgkmcnt(0)
    s_mov_b32 m0, s101
    v_mfma_f32_16x16x32_bf16 v[204:207], v[144:147], v[140:143], 0
    ds_write_addtid_b32 v72 offset:47104
    ds_write_addtid_b32 v73 offset:47392
    v_mfma_f32_16x16x32_bf16 v[208:211], v[148:151], v[140:143], 0
    ds_write_addtid_b32 v74 offset:47680
    ds_write_addtid_b32 v75 offset:47968
    v_mfma_f32_16x16x32_bf16 v[212:215], v[152:155], v[140:143], 0
    ds_write_addtid_b32 v76 offset:48256
    ds_write_addtid_b32 v77 offset:48544
    v_mfma_f32_16x16x32_bf16 v[204:207], v[160:163], v[156:159], v[204:207]
    ds_write_addtid_b32 v78 offset:48832
    ds_write_addtid_b32 v79 offset:49120
    v_mfma_f32_16x16x32_bf16 v[208:211], v[164:167], v[156:159], v[208:211]
L_stub2:
    s_cbranch_execz L_ret2
    ds_write_addtid_b32 v80 offset:49408
    ds_write_addtid_b32 v81 offset:49696
    v_mfma_f32_16x16x32_bf16 v[212:215], v[168:171], v[156:159], v[212:215]
    ds_write_addtid_b32 v82 offset:49984
    ds_write_addtid_b32 v83 offset:50272
    v_mfma_f32_16x16x32_bf16 v[204:207], v[176:179], v[172:175], v[204:207]
    ds_write_addtid_b32 v84 offset:50560
    ds_write_addtid_b32 v85 offset:50848
    v_mfma_f32_16x16x32_bf16 v[208:211], v[180:183], v[172:175], v[208:211]
    ds_write_addtid_b32 v86 offset:51136
    ds_write_addtid_b32 v87 offset:51424
    v_mfma_f32_16x16x32_bf16 v[212:215], v[184:187], v[172:175], v[212:215]
    ds_write_addtid_b32 v88 offset:51712
    ds_write_addtid_b32 v89 offset:52000
    v_mfma_f32_16x16x32_bf16 v[204:207], v[192:195], v[188:191], v[204:207]
    ds_write_addtid_b32 v90 offset:52288
    ds_write_addtid_b32 v91 offset:52576
    v_mfma_f32_16x16x32_bf16 v[208:211], v[196:199], v[188:191], v[208:211]
    ds_write_addtid_b32 v92 offset:52864
    ds_write_addtid_b32 v93 offset:53152
    v_mfma_f32_16x16x32_bf16 v[212:215], v[200:203], v[188:191], v[212:215]
    ds_write_addtid_b32 v94 offset:53440
    ds_write_addtid_b32 v95 offset:53728
    ds_write_addtid_b32 v96 offset:54016
    ds_write_addtid_b32 v97 offset:54304
    ds_write_addtid_b32 v98 offset:54592
    ds_write_addtid_b32 v99 offset:54880
    ds_write_addtid_b32 v100 offset:55168
    ds_write_addtid_b32 v101 offset:55456
    s_add_u32 m0, s94, 0
    s_add_u32 s100, s5, 0
    buffer_load_dwordx4 v253, s[16:19], s100 offen offset:0  lds
    s_mov_b32 m0, s101
    s_nop 0
    ds_write_addtid_b32 v102 offset:55744
    ds_write_addtid_b32 v103 offset:56032
    ds_write_addtid_b32 v104 offset:56320
    ds_write_addtid_b32 v105 offset:56608
    ds_write_addtid_b32 v106 offset:56896
    ds_write_addtid_b32 v107 offset:57184
    s_add_u32 m0, s94, 0
    s_nop 0
    buffer_load_dwordx4 v252, s[16:19], s100 offen offset:1088  lds
    s_mov_b32 m0, s101
    s_nop 0
    ds_write_addtid_b32 v108 offset:57472
    ds_write_addtid_b32 v109 offset:57760
    ds_write_addtid_b32 v110 offset:58048
    ds_write_addtid_b32 v111 offset:58336
    ds_write_addtid_b32 v112 offset:58624
    ds_write_addtid_b32 v113 offset:58912
    s_add_u32 m0, s94, 0
    s_nop 0
    buffer_load_dwordx4 v249, s[16:19], s100 offen offset:2176  lds
    s_mov_b32 m0, s101
    s_nop 0
    ds_write_addtid_b32 v114 offset:59200
    ds_write_addtid_b32 v115 offset:59488
    ds_write_addtid_b32 v116 offset:59776
    ds_write_addtid_b32 v117 offset:60064
    ds_write_addtid_b32 v118 offset:60352
    ds_write_addtid_b32 v119 offset:60640
    s_add_u32 m0, s94, 0
    s_nop 0
    buffer_load_dwordx4 v248, s[16:19], s100 offen offset:3264  lds
    s_mov_b32 m0, s101
    s_nop 0
    ds_write_addtid_b32 v120 offset:60928
    ds_write_addtid_b32 v121 offset:61216
    ds_write_addtid_b32 v122 offset:61504
    ds_write_addtid_b32 v123 offset:61792
    ds_write_addtid_b32 v124 offset:62080
    ds_write_addtid_b32 v125 offset:62368
    s_add_u32 m0, s94, 4352
    s_add_u32 s100, s5, 65536
    buffer_load_dwordx4 v253, s[16:19], s100 offen offset:0  lds
    s_mov_b32 m0, s101
    s_nop 0
    ds_write_addtid_b32 v126 offset:62656
    ds_write_addtid_b32 v127 offset:62944
    ds_write_addtid_b32 v128 offset:63232
    s_waitcnt lgkmcnt(0)
    ds_read_b128 v[140:143], v243 offset:0
    ds_read_b128 v[144:147], v243 offset:4608
    ds_read_b128 v[148:151], v243 offset:9216
    ds_read_b128 v[152:155], v243 offset:13824
    ds_read_b128 v[156:159], v243 offset:64
    ds_read_b128 v[160:163], v243 offset:4672
    ds_read_b128 v[164:167], v243 offset:9280
    ds_read_b128 v[168:171], v243 offset:13888
    ds_read_b128 v[172:175], v243 offset:128
    ds_read_b128 v[176:179], v243 offset:4736
    ds_read_b128 v[180:183], v243 offset:9344
    ds_read_b128 v[184:187], v243 offset:13952
    ds_read_b128 v[188:191], v243 offset:192
    ds_read_b128 v[192:195], v243 offset:4800
    ds_read_b128 v[196:199], v243 offset:9408
    ds_read_b128 v[200:203], v243 offset:14016
    v_mov_b32 v132, 0
    v_mov_b32 v133, 0
    v_mov_b32 v134, 0
    v_mov_b32 v135, 0
    v_bfe_u32 v224, v2, 1, 2
    v_mul_u32_u24 v224, 4160, v224
    v_and_b32 v225, 1, v2
    v_lshl_add_u32 v224, v225, 4, v224
    v_lshrrev_b32 v225, 5, v1
    v_mul_u32_u24 v225, 4608, v225
    v_and_b32 v226, 31, v1
    v_lshl_add_u32 v225, v226, 4, v225
    v_add_u32 v225, 67840, v225
    v_lshrrev_b32 v233, 2, v1
    v_lshlrev_b32 v233, 7, v233
    s_and_b32 s35, s30, 1
    s_lshl_b32 s35, s35, 11
    s_add_u32 s35, s35, 14778368
    s_waitcnt lgkmcnt(12)
    v_mfma_f32_16x16x32_bf16 v[204:207], v[144:147], v[140:143], v[204:207]
    v_mfma_f32_16x16x32_bf16 v[208:211], v[148:151], v[140:143], v[208:211]
    v_mfma_f32_16x16x32_bf16 v[212:215], v[152:155], v[140:143], v[212:215]
    s_waitcnt lgkmcnt(8)
    v_mfma_f32_16x16x32_bf16 v[204:207], v[160:163], v[156:159], v[204:207]
    v_mfma_f32_16x16x32_bf16 v[208:211], v[164:167], v[156:159], v[208:211]
    v_mfma_f32_16x16x32_bf16 v[212:215], v[168:171], v[156:159], v[212:215]
    s_waitcnt lgkmcnt(4)
    v_mfma_f32_16x16x32_bf16 v[204:207], v[176:179], v[172:175], v[204:207]
    v_mfma_f32_16x16x32_bf16 v[208:211], v[180:183], v[172:175], v[208:211]
    v_mfma_f32_16x16x32_bf16 v[212:215], v[184:187], v[172:175], v[212:215]
    s_waitcnt lgkmcnt(0)
    v_mfma_f32_16x16x32_bf16 v[204:207], v[192:195], v[188:191], v[204:207]
    v_mfma_f32_16x16x32_bf16 v[208:211], v[196:199], v[188:191], v[208:211]
    s_add_u32 m0, s94, 4352
    v_mfma_f32_16x16x32_bf16 v[212:215], v[200:203], v[188:191], v[212:215]
    buffer_load_dwordx4 v252, s[16:19], s100 offen offset:1088  lds
    s_add_u32 m0, s94, 4352
    s_nop 0
    buffer_load_dwordx4 v249, s[16:19], s100 offen offset:2176  lds
    s_add_u32 m0, s94, 4352
    s_nop 0
    buffer_load_dwordx4 v248, s[16:19], s100 offen offset:3264  lds
    s_and_b32 s37, s30, 1
    s_cselect_b32 s37, 0, s39
    s_mov_b64 exec, 1
    v_add_f32 v204, s37, v204
    v_add_u32 v223, -4, v223
    ds_write_b32 v223, v5
    s_mov_b64 exec, -1
    ds_write_b128 v220, v[204:207]
    ds_write_b128 v221, v[208:211]
    s_mov_b32 exec_hi, 0xffff
    ds_write_b64 v222, v[212:213] offset:2048
    s_mov_b32 exec_hi, 0x0
    ds_write_b64 v222, v[214:215] offset:2176
    s_mov_b64 exec, -1
    s_waitcnt vmcnt(8)
    ds_read_b128 a[32:35], v251 offset:0
    ds_read_b128 a[36:39], v251 offset:64
    ds_read_b128 a[40:43], v251 offset:128
    ds_read_b128 a[44:47], v251 offset:192
    ds_read_b128 a[48:51], v251 offset:256
    ds_read_b128 a[52:55], v251 offset:320
    ds_read_b128 a[56:59], v251 offset:384
    ds_read_b128 a[60:63], v251 offset:448
    s_waitcnt lgkmcnt(0)
    s_barrier
    s_cmp_lg_u32 s30, 0
    s_cbranch_scc1 L_flg7
    s_lshl_b32 s79, s29, 5
    s_add_u32 s79, s79, s28
    s_lshl_b32 s79, s79, 7
    s_add_u32 s79, s79, 14680064
    v_mov_b32 v18, s31
    s_mov_b64 exec, 1
    buffer_store_dword v18, v5, s[20:23], s79 offen sc1
    s_mov_b64 exec, -1
L_flg7:
    buffer_load_dword v234, v233, s[20:23], s35 offen sc1
    v_add_u32 v200, 51200, v0
    ds_write_b128 v224, v[132:135] offset:55296
    ds_write_b128 v225, v[132:135]
    ds_read2st64_b32 v[40:41], v6 offset0:0 offset1:11
    s_lshr_b32 s32, s30, 1
    s_and_b32 s33, s30, 1
    s_lshl_b32 s37, s33, 8
    s_add_u32 m0, s95, 0
    s_add_u32 s100, s6, 0
    buffer_load_dwordx4 v253, s[16:19], s100 offen offset:0  lds
    ds_read2st64_b32 v[42:43], v7 offset0:0 offset1:11
    s_mul_i32 s36, s32, 8320
    s_add_u32 s36, s36, 51484
    s_sub_u32 s36, s36, s37
    ds_read2st64_b32 v[44:45], v8 offset0:0 offset1:11
    v_and_b32 v30, 1, v2
    v_mul_u32_u24 v30, 4160, v30
    v_lshrrev_b32 v31, 1, v2
    buffer_load_dwordx4 v252, s[16:19], s100 offen offset:1088  lds
    ds_read2st64_b32 v[46:47], v9 offset0:0 offset1:11
    v_lshlrev_b32 v31, 2, v31
    v_sub_u32 v30, v30, v31
    v_lshl_add_u32 v30, v3, 4, v30
    ds_read2st64_b32 v[48:49], v10 offset0:0 offset1:11
    v_add_u32 v30, s36, v30
    v_add_u32 v32, 1024, v30
    v_add_u32 v33, 2048, v30
    buffer_load_dwordx4 v249, s[16:19], s100 offen offset:2176  lds
    ds_read2st64_b32 v[50:51], v11 offset0:0 offset1:11
    v_add_u32 v38, 3072, v30
    s_mul_i32 s36, s32, 4608
    s_add_u32 s36, s36, 68128
    ds_read2st64_b32 v[52:53], v12 offset0:0 offset1:11
    s_sub_u32 s36, s36, s37
    v_lshlrev_b32 v31, 5, v2
    v_lshl_add_u32 v34, v3, 3, v31
    buffer_load_dwordx4 v248, s[16:19], s100 offen offset:3264  lds
    ds_read2st64_b32 v[54:55], v13 offset0:0 offset1:11
    v_lshl_add_u32 v31, v3, 4, v31
    v_add_u32 v31, s36, v31
    s_lshl_b32 s36, s29, 5
    ds_read2st64_b32 v[56:57], v14 offset0:0 offset1:11
    s_add_u32 s36, s36, s28
    s_lshl_b32 s36, s36, 13
    s_lshl_b32 s37, s30, 11
    s_add_u32 m0, s95, 4352
    s_add_u32 s100, s6, 65536
    buffer_load_dwordx4 v253, s[16:19], s100 offen offset:0  lds
    ds_read2st64_b32 v[64:65], v6 offset0:160 offset1:171
    s_add_u32 s36, s36, s37
    s_add_u32 s77, s36, 10485760
    s_add_u32 s36, s37, 93440
    buffer_load_dwordx4 v252, s[16:19], s100 offen offset:1088  lds
    ds_read2st64_b32 v[66:67], v7 offset0:160 offset1:171
    v_add_u32 v34, s36, v34
    v_add_u32 v35, s36, v4
    s_lshl_b32 s36, s30, 12
    ds_read2st64_b32 v[68:69], v8 offset0:160 offset1:171
    s_add_u32 s36, s36, 77056
    v_add_u32 v36, s36, v4
    s_xor_b32 s36, s30, 1
    buffer_load_dwordx4 v249, s[16:19], s100 offen offset:2176  lds
    ds_read2st64_b32 v[70:71], v9 offset0:160 offset1:171
    s_lshl_b32 s36, s36, 12
    s_add_u32 s36, s36, 77056
    v_add_u32 v37, s36, v4
    ds_read2st64_b32 v[72:73], v10 offset0:160 offset1:171
    buffer_load_dwordx4 v248, s[16:19], s100 offen offset:3264  lds
    ds_read2st64_b32 v[74:75], v11 offset0:160 offset1:171
    ds_read2st64_b32 v[76:77], v12 offset0:160 offset1:171
    s_waitcnt vmcnt(8)
    v_cmp_ne_u32 vcc, s31, v234
    s_nop 0
    s_cmp_eq_u64 vcc, 0
    s_cbranch_scc1 L_ok8
    s_mov_b32 s33, 0
L_poll9:
    buffer_load_dword v234, v233, s[20:23], s35 offen sc1
    s_add_u32 s33, s33, 1
    s_waitcnt vmcnt(0)
    v_cmp_ne_u32 vcc, s31, v234
    s_nop 0
    s_cmp_eq_u64 vcc, 0
    s_cbranch_scc1 L_polld10
    s_cmp_lt_u32 s33, 4000000
    s_cbranch_scc1 L_poll9
L_polld10:
L_ok8:
    s_lshl_b32 s40, s29, 5
    s_add_u32 s40, s40, s28
    s_lshl_b32 s40, s40, 13
    s_lshl_b32 s41, s30, 11
    s_add_u32 s40, s40, s41
    s_add_u32 s40, s40, 8388608
    s_lshr_b32 s42, s30, 1
    s_lshl_b32 s42, s42, 9
    s_add_u32 s41, s41, s42
    s_add_u32 m0, s41, 68352
    s_nop 0
    buffer_load_dwordx4 v4, s[20:23], s40 offen sc1 lds
    buffer_load_dwordx4 v4, s[20:23], s40 offen offset:1024 sc1 lds
    ds_read2st64_b32 v[78:79], v13 offset0:160 offset1:171
    ds_read2st64_b32 v[80:81], v14 offset0:160 offset1:171
    ds_read_b128 a[64:67], v250 offset:0
    ds_read_b128 a[68:71], v250 offset:64
    s_waitcnt lgkmcnt(11)
    v_add_f32 v40, v40, v41
    v_add_f32 v42, v42, v43
    v_add_f32 v44, v44, v45
    v_add_f32 v46, v46, v47
    v_add_f32 v48, v48, v49
    v_add_f32 v50, v50, v51
    v_add_f32 v52, v52, v53
    v_add_f32 v54, v54, v55
    v_add_f32 v56, v56, v57
    ds_read_b128 a[72:75], v250 offset:128
    ds_read_b128 a[76:79], v250 offset:192
    v_cvt_pk_bf16_f32 v104, v42, v44
    v_cvt_pk_bf16_f32 v105, v46, v48
    v_cvt_pk_bf16_f32 v106, v50, v52
    v_cvt_pk_bf16_f32 v107, v54, v56
    ds_read_b128 a[80:83], v250 offset:256
    ds_read_b128 a[84:87], v250 offset:320
    ds_write_b128 v200, v[104:107] offset:0
    v_cvt_pk_bf16_f32 v108, v40, v42
    v_cvt_pk_bf16_f32 v109, v44, v46
    v_cvt_pk_bf16_f32 v110, v48, v50
    v_cvt_pk_bf16_f32 v111, v52, v54
    ds_read_b128 a[88:91], v250 offset:384
    ds_read_b128 a[92:95], v250 offset:448
    ds_write_b128 v200, v[108:111] offset:4160
    s_waitcnt lgkmcnt(10)
    v_add_f32 v64, v64, v65
    v_add_f32 v66, v66, v67
    v_add_f32 v68, v68, v69
    v_add_f32 v70, v70, v71
    v_add_f32 v72, v72, v73
    v_add_f32 v74, v74, v75
    v_add_f32 v76, v76, v77
    v_add_f32 v78, v78, v79
    v_add_f32 v80, v80, v81
    v_cvt_pk_bf16_f32 v112, v66, v68
    v_cvt_pk_bf16_f32 v113, v70, v72
    v_cvt_pk_bf16_f32 v114, v74, v76
    v_cvt_pk_bf16_f32 v115, v78, v80
    ds_write_b128 v200, v[112:115] offset:8320
    v_cvt_pk_bf16_f32 v116, v64, v66
    v_cvt_pk_bf16_f32 v117, v68, v70
    v_cvt_pk_bf16_f32 v118, v72, v74
    v_cvt_pk_bf16_f32 v119, v76, v78
    ds_write_b128 v200, v[116:119] offset:12480
    s_waitcnt vmcnt(0)
    s_waitcnt lgkmcnt(0)
    s_barrier
    ds_read2_b32 v[80:81], v38 offset0:176 offset1:177
    ds_read2_b32 v[82:83], v38 offset0:178 offset1:179
    ds_read_b128 v[112:115], v31 offset:192
    ds_read_b128 v[116:119], v31 offset:704
    ds_read2_b32 v[84:85], v38 offset0:48 offset1:49
    ds_read2_b32 v[86:87], v38 offset0:50 offset1:51
    ds_read_b128 v[120:123], v31 offset:1216
    ds_read2_b32 v[88:89], v33 offset0:176 offset1:177
    ds_read2_b32 v[90:91], v33 offset0:178 offset1:179
    ds_read_b128 v[124:127], v31 offset:1728
    ds_read2_b32 v[92:93], v33 offset0:48 offset1:49
    ds_read2_b32 v[94:95], v33 offset0:50 offset1:51
    ds_read_b128 v[128:131], v31 offset:2240
    ds_read2_b32 v[96:97], v32 offset0:176 offset1:177
    ds_read2_b32 v[98:99], v32 offset0:178 offset1:179
    ds_read_b128 v[132:135], v31 offset:2752
    ds_read2_b32 v[100:101], v32 offset0:48 offset1:49
    ds_read2_b32 v[102:103], v32 offset0:50 offset1:51
    ds_read_b128 v[136:139], v31 offset:3264
    ds_read2_b32 v[104:105], v30 offset0:176 offset1:177
    ds_read2_b32 v[106:107], v30 offset0:178 offset1:179
    ds_read_b128 v[140:143], v31 offset:3776
    ds_read2_b32 v[108:109], v30 offset0:48 offset1:49
    ds_read2_b32 v[110:111], v30 offset0:50 offset1:51
    s_waitcnt lgkmcnt(15)
    v_mfma_f32_16x16x32_bf16 v[208:211], v[80:83], v[112:115], 0
    ds_read2_b32 v[144:145], v38 offset0:160 offset1:161
    s_mul_i32 s36, s30, 3072
    v_mfma_f32_16x16x32_bf16 v[212:215], v[80:83], v[116:119], 0
    ds_read2_b32 v[146:147], v38 offset0:162 offset1:163
    s_add_u32 m0, s94, 0
    s_add_u32 s100, s7, 0
    buffer_load_dwordx4 v253, s[16:19], s100 offen offset:0  lds
    v_mfma_f32_16x16x32_bf16 v[212:215], v[84:87], v[112:115], v[212:215]
    ds_read_b128 v[176:179], v31 offset:128
    s_add_u32 s36, s36, 16384
    v_mfma_f32_16x16x32_bf16 v[216:219], v[80:83], v[120:123], 0
    ds_read_b128 v[180:183], v31 offset:640
    buffer_load_dwordx4 v252, s[16:19], s100 offen offset:1088  lds
    v_mfma_f32_16x16x32_bf16 v[216:219], v[84:87], v[116:119], v[216:219]
    ds_read2_b32 v[148:149], v38 offset0:32 offset1:33
    v_add_u32 v20, s36, v4
    v_mfma_f32_16x16x32_bf16 v[216:219], v[88:91], v[112:115], v[216:219]
    ds_read2_b32 v[150:151], v38 offset0:34 offset1:35
    buffer_load_dwordx4 v249, s[16:19], s100 offen offset:2176  lds
    s_waitcnt lgkmcnt(15)
    v_mfma_f32_16x16x32_bf16 v[220:223], v[80:83], v[124:127], 0
    ds_read_b128 v[184:187], v31 offset:1152
    s_xor_b32 s36, s30, 1
    v_mfma_f32_16x16x32_bf16 v[220:223], v[84:87], v[120:123], v[220:223]
    ds_read2_b32 v[152:153], v33 offset0:160 offset1:161
    buffer_load_dwordx4 v248, s[16:19], s100 offen offset:3264  lds
    v_mfma_f32_16x16x32_bf16 v[220:223], v[88:91], v[116:119], v[220:223]
    ds_read2_b32 v[154:155], v33 offset0:162 offset1:163
    s_mul_i32 s36, s36, 3072
    v_mfma_f32_16x16x32_bf16 v[220:223], v[92:95], v[112:115], v[220:223]
    ds_read_b128 v[188:191], v31 offset:1664
    s_add_u32 m0, s94, 4352
    s_add_u32 s100, s7, 65536
    buffer_load_dwordx4 v253, s[16:19], s100 offen offset:0  lds
    v_mfma_f32_16x16x32_bf16 v[224:227], v[80:83], v[128:131], 0
    ds_read2_b32 v[156:157], v33 offset0:32 offset1:33
    s_add_u32 s36, s36, 16384
    v_mfma_f32_16x16x32_bf16 v[224:227], v[84:87], v[124:127], v[224:227]
    ds_read2_b32 v[158:159], v33 offset0:34 offset1:35
    buffer_load_dwordx4 v252, s[16:19], s100 offen offset:1088  lds
    v_mfma_f32_16x16x32_bf16 v[224:227], v[88:91], v[120:123], v[224:227]
    ds_read_b128 v[192:195], v31 offset:2176
    v_add_u32 v21, s36, v4
    v_mfma_f32_16x16x32_bf16 v[224:227], v[92:95], v[116:119], v[224:227]
    ds_read2_b32 v[160:161], v32 offset0:160 offset1:161
    buffer_load_dwordx4 v249, s[16:19], s100 offen offset:2176  lds
    v_mfma_f32_16x16x32_bf16 v[224:227], v[96:99], v[112:115], v[224:227]
    ds_read2_b32 v[162:163], v32 offset0:162 offset1:163
    s_xor_b32 s36, s30, 2
    s_waitcnt lgkmcnt(15)
    v_mfma_f32_16x16x32_bf16 v[228:231], v[80:83], v[132:135], 0
    ds_read_b128 v[196:199], v31 offset:2688
    buffer_load_dwordx4 v248, s[16:19], s100 offen offset:3264  lds
    v_mfma_f32_16x16x32_bf16 v[228:231], v[84:87], v[128:131], v[228:231]
    ds_read2_b32 v[164:165], v32 offset0:32 offset1:33
    s_mul_i32 s36, s36, 3072
    v_mfma_f32_16x16x32_bf16 v[228:231], v[88:91], v[124:127], v[228:231]
    ds_read2_b32 v[166:167], v32 offset0:34 offset1:35
    ds_read_b128 a[128:131], v251 offset:0
    ds_read_b128 a[132:135], v251 offset:64
    v_mfma_f32_16x16x32_bf16 v[228:231], v[92:95], v[120:123], v[228:231]
    ds_read_b128 v[200:203], v31 offset:3200
    s_add_u32 s36, s36, 17408
    v_mfma_f32_16x16x32_bf16 v[228:231], v[96:99], v[116:119], v[228:231]
    ds_read2_b32 v[168:169], v30 offset0:160 offset1:161
    ds_read_b128 a[136:139], v251 offset:128
    ds_read_b128 a[140:143], v251 offset:192
    v_mfma_f32_16x16x32_bf16 v[228:231], v[100:103], v[112:115], v[228:231]
    ds_read2_b32 v[170:171], v30 offset0:162 offset1:163
    v_add_u32 v22, s36, v4
    v_mfma_f32_16x16x32_bf16 v[232:235], v[80:83], v[136:139], 0
    ds_read_b128 v[204:207], v31 offset:3712
    ds_read_b128 a[144:147], v251 offset:256
    ds_read_b128 a[148:151], v251 offset:320
    v_mfma_f32_16x16x32_bf16 v[232:235], v[84:87], v[132:135], v[232:235]
    ds_read2_b32 v[172:173], v30 offset0:32 offset1:33
    s_xor_b32 s36, s30, 3
    v_mfma_f32_16x16x32_bf16 v[232:235], v[88:91], v[128:131], v[232:235]
    ds_read2_b32 v[174:175], v30 offset0:34 offset1:35
    ds_read_b128 a[152:155], v251 offset:384
    ds_read_b128 a[156:159], v251 offset:448
    v_mfma_f32_16x16x32_bf16 v[232:235], v[92:95], v[124:127], v[232:235]
    s_mul_i32 s36, s36, 3072
    s_add_u32 s36, s36, 18432
    v_mfma_f32_16x16x32_bf16 v[232:235], v[96:99], v[120:123], v[232:235]
    s_waitcnt lgkmcnt(0)
    s_add_u32 m0, s95, 0
    s_add_u32 s100, s5, 512
    buffer_load_dwordx4 v253, s[16:19], s100 offen offset:0  lds
    v_add_u32 v23, s36, v4
    s_lshl_b32 s36, s30, 9
    v_mfma_f32_16x16x32_bf16 v[232:235], v[100:103], v[116:119], v[232:235]
    buffer_load_dwordx4 v252, s[16:19], s100 offen offset:1088  lds
    v_lshl_add_u32 v24, v1, 3, s36
    v_lshlrev_b32 v17, 16, v17
    v_mfma_f32_16x16x32_bf16 v[232:235], v[104:107], v[112:115], v[232:235]
    buffer_load_dwordx4 v249, s[16:19], s100 offen offset:2176  lds
    v_lshrrev_b32 v25, 2, v1
    v_lshlrev_b32 v25, 7, v25
    v_mfma_f32_16x16x32_bf16 v[236:239], v[80:83], v[140:143], 0
    buffer_load_dwordx4 v248, s[16:19], s100 offen offset:3264  lds
    s_lshl_b32 s35, s29, 5
    s_lshl_b32 s36, s3, 3
    v_mfma_f32_16x16x32_bf16 v[236:239], v[84:87], v[136:139], v[236:239]
    s_add_u32 m0, s95, 4352
    s_add_u32 s100, s5, 66048
    buffer_load_dwordx4 v253, s[16:19], s100 offen offset:0  lds
    s_add_u32 s35, s35, s36
    s_lshl_b32 s35, s35, 7
    v_mfma_f32_16x16x32_bf16 v[236:239], v[88:91], v[132:135], v[236:239]
    buffer_load_dwordx4 v252, s[16:19], s100 offen offset:1088  lds
    s_add_u32 s35, s35, 14680064
    s_lshl_b32 s36, s30, 10
    v_mfma_f32_16x16x32_bf16 v[236:239], v[92:95], v[128:131], v[236:239]
    buffer_load_dwordx4 v249, s[16:19], s100 offen offset:2176  lds
    s_add_u32 s36, s36, 14793728
    s_add_u32 s80, s36, 1024
    v_mfma_f32_16x16x32_bf16 v[236:239], v[96:99], v[124:127], v[236:239]
    buffer_load_dwordx4 v248, s[16:19], s100 offen offset:3264  lds
    s_sub_u32 s36, s35, 1024
    v_mov_b32 v29, s35
    v_mfma_f32_16x16x32_bf16 v[236:239], v[100:103], v[120:123], v[236:239]
    s_waitcnt vmcnt(8)
    ds_read_b128 a[192:195], v250 offset:0
    ds_read_b128 a[196:199], v250 offset:64
    s_mov_b32 exec_lo, 0
    v_mov_b32 v29, s36
    s_mov_b32 exec_lo, -1
    v_add_u32 v25, v29, v25
    v_mfma_f32_16x16x32_bf16 v[236:239], v[104:107], v[116:119], v[236:239]
    ds_read_b128 a[200:203], v250 offset:128
    ds_read_b128 a[204:207], v250 offset:192
    s_lshl_b32 s72, s29, 9
    s_lshl_b32 s36, s3, 4
    v_mfma_f32_16x16x32_bf16 v[236:239], v[108:111], v[112:115], v[236:239]
    ds_read_b128 a[208:211], v250 offset:256
    ds_read_b128 a[212:215], v250 offset:320
    s_add_u32 s72, s72, s36
    s_lshl_b32 s72, s72, 10
    v_mfma_f32_16x16x32_bf16 v[208:211], v[144:147], v[176:179], v[208:211]
    ds_read2_b32 v[80:81], v38 offset0:144 offset1:145
    s_lshl_b32 s73, s28, 2
    v_mfma_f32_16x16x32_bf16 v[212:215], v[144:147], v[180:183], v[212:215]
    ds_read2_b32 v[82:83], v38 offset0:146 offset1:147
    ds_read_b128 a[216:219], v250 offset:384
    ds_read_b128 a[220:223], v250 offset:448
    v_mfma_f32_16x16x32_bf16 v[212:215], v[148:151], v[176:179], v[212:215]
    ds_read_b128 v[112:115], v31 offset:64
    s_add_u32 s73, s73, s30
    v_mfma_f32_16x16x32_bf16 v[216:219], v[144:147], v[184:187], v[216:219]
    ds_read_b128 v[116:119], v31 offset:576
    v_mfma_f32_16x16x32_bf16 v[216:219], v[148:151], v[180:183], v[216:219]
    ds_read2_b32 v[84:85], v38 offset0:16 offset1:17
    s_mul_i32 s73, s73, 28
    v_mfma_f32_16x16x32_bf16 v[216:219], v[152:155], v[176:179], v[216:219]
    ds_read2_b32 v[86:87], v38 offset0:18 offset1:19
    s_waitcnt lgkmcnt(4)
    s_add_u32 m0, s94, 0
    s_add_u32 s100, s6, 512
    buffer_load_dwordx4 v253, s[16:19], s100 offen offset:0  lds
    v_mfma_f32_16x16x32_bf16 v[220:223], v[144:147], v[188:191], v[220:223]
    ds_read_b128 v[120:123], v31 offset:1088
    s_lshl_b32 s36, s29, 2
    v_mfma_f32_16x16x32_bf16 v[220:223], v[148:151], v[184:187], v[220:223]
    ds_read2_b32 v[88:89], v33 offset0:144 offset1:145
    buffer_load_dwordx4 v252, s[16:19], s100 offen offset:1088  lds
    v_mfma_f32_16x16x32_bf16 v[220:223], v[152:155], v[180:183], v[220:223]
    ds_read2_b32 v[90:91], v33 offset0:146 offset1:147
    s_add_u32 s73, s73, s36
    v_mfma_f32_16x16x32_bf16 v[220:223], v[156:159], v[176:179], v[220:223]
    ds_read_b128 v[124:127], v31 offset:1600
    buffer_load_dwordx4 v249, s[16:19], s100 offen offset:2176  lds
    v_mfma_f32_16x16x32_bf16 v[224:227], v[144:147], v[192:195], v[224:227]
    ds_read2_b32 v[92:93], v33 offset0:16 offset1:17
    s_lshl_b32 s73, s73, 10
    v_mfma_f32_16x16x32_bf16 v[224:227], v[148:151], v[188:191], v[224:227]
    ds_read2_b32 v[94:95], v33 offset0:18 offset1:19
    buffer_load_dwordx4 v248, s[16:19], s100 offen offset:3264  lds
    v_mfma_f32_16x16x32_bf16 v[224:227], v[152:155], v[184:187], v[224:227]
    ds_read_b128 v[128:131], v31 offset:2112
    s_add_u32 s73, s73, 4194304
    v_mfma_f32_16x16x32_bf16 v[224:227], v[156:159], v[180:183], v[224:227]
    ds_read2_b32 v[96:97], v32 offset0:144 offset1:145
    s_add_u32 m0, s94, 4352
    s_add_u32 s100, s6, 66048
    buffer_load_dwordx4 v253, s[16:19], s100 offen offset:0  lds
    v_mfma_f32_16x16x32_bf16 v[224:227], v[160:163], v[176:179], v[224:227]
    ds_read2_b32 v[98:99], v32 offset0:146 offset1:147
    v_add_u32 v6, 4096, v4
    v_mfma_f32_16x16x32_bf16 v[228:231], v[144:147], v[196:199], v[228:231]
    ds_read_b128 v[132:135], v31 offset:2624
    buffer_load_dwordx4 v252, s[16:19], s100 offen offset:1088  lds
    v_mfma_f32_16x16x32_bf16 v[228:231], v[148:151], v[192:195], v[228:231]
    ds_read2_b32 v[100:101], v32 offset0:16 offset1:17
    v_add_u32 v7, 8192, v4
    v_mfma_f32_16x16x32_bf16 v[228:231], v[152:155], v[188:191], v[228:231]
    ds_read2_b32 v[102:103], v32 offset0:18 offset1:19
    buffer_load_dwordx4 v249, s[16:19], s100 offen offset:2176  lds
    v_mfma_f32_16x16x32_bf16 v[228:231], v[156:159], v[184:187], v[228:231]
    ds_read_b128 v[136:139], v31 offset:3136
    v_add_u32 v8, 12288, v4
    v_mfma_f32_16x16x32_bf16 v[228:231], v[160:163], v[180:183], v[228:231]
    ds_read2_b32 v[104:105], v30 offset0:144 offset1:145
    buffer_load_dwordx4 v248, s[16:19], s100 offen offset:3264  lds
    v_mfma_f32_16x16x32_bf16 v[228:231], v[164:167], v[176:179], v[228:231]
    ds_read2_b32 v[106:107], v30 offset0:146 offset1:147
    v_mov_b32 v12, v17
    v_mfma_f32_16x16x32_bf16 v[232:235], v[144:147], v[200:203], v[232:235]
    ds_read_b128 v[140:143], v31 offset:3648
    v_mfma_f32_16x16x32_bf16 v[232:235], v[148:151], v[196:199], v[232:235]
    ds_read2_b32 v[108:109], v30 offset0:16 offset1:17
    v_mov_b32 v13, v17
    v_mfma_f32_16x16x32_bf16 v[232:235], v[152:155], v[192:195], v[232:235]
    ds_read2_b32 v[110:111], v30 offset0:18 offset1:19
    v_mfma_f32_16x16x32_bf16 v[232:235], v[156:159], v[188:191], v[232:235]
    s_waitcnt vmcnt(8)
    ds_read_b128 a[96:99], v251 offset:0
    ds_read_b128 a[100:103], v251 offset:64
    v_mov_b32 v14, v17
    v_mov_b32 v15, v17
    v_mfma_f32_16x16x32_bf16 v[232:235], v[160:163], v[184:187], v[232:235]
    ds_read_b128 a[104:107], v251 offset:128
    ds_read_b128 a[108:111], v251 offset:192
    v_mfma_f32_16x16x32_bf16 v[232:235], v[164:167], v[180:183], v[232:235]
    ds_read_b128 a[112:115], v251 offset:256
    ds_read_b128 a[116:119], v251 offset:320
    v_mfma_f32_16x16x32_bf16 v[232:235], v[168:171], v[176:179], v[232:235]
    ds_read_b128 a[120:123], v251 offset:384
    ds_read_b128 a[124:127], v251 offset:448
    v_mfma_f32_16x16x32_bf16 v[236:239], v[144:147], v[204:207], v[236:239]
    v_mfma_f32_16x16x32_bf16 v[236:239], v[148:151], v[200:203], v[236:239]
    s_waitcnt lgkmcnt(0)
    s_add_u32 m0, s95, 0
    s_add_u32 s100, s7, 512
    buffer_load_dwordx4 v253, s[16:19], s100 offen offset:0  lds
    v_mfma_f32_16x16x32_bf16 v[236:239], v[152:155], v[196:199], v[236:239]
    buffer_load_dwordx4 v252, s[16:19], s100 offen offset:1088  lds
    v_mfma_f32_16x16x32_bf16 v[236:239], v[156:159], v[192:195], v[236:239]
    buffer_load_dwordx4 v249, s[16:19], s100 offen offset:2176  lds
    v_mfma_f32_16x16x32_bf16 v[236:239], v[160:163], v[188:191], v[236:239]
    buffer_load_dwordx4 v248, s[16:19], s100 offen offset:3264  lds
    v_mfma_f32_16x16x32_bf16 v[236:239], v[164:167], v[184:187], v[236:239]
    s_add_u32 m0, s95, 4352
    s_add_u32 s100, s7, 66048
    buffer_load_dwordx4 v253, s[16:19], s100 offen offset:0  lds
L_stub3:
    s_cbranch_execz L_ret3
    v_mfma_f32_16x16x32_bf16 v[236:239], v[168:171], v[180:183], v[236:239]
    buffer_load_dwordx4 v252, s[16:19], s100 offen offset:1088  lds
    v_mfma_f32_16x16x32_bf16 v[236:239], v[172:175], v[176:179], v[236:239]
    buffer_load_dwordx4 v249, s[16:19], s100 offen offset:2176  lds
    v_mfma_f32_16x16x32_bf16 v[208:211], v[80:83], v[112:115], v[208:211]
    ds_read2_b32 v[144:145], v38 offset0:128 offset1:129
    v_mfma_f32_16x16x32_bf16 v[212:215], v[80:83], v[116:119], v[212:215]
    ds_read2_b32 v[146:147], v38 offset0:130 offset1:131
    buffer_load_dwordx4 v248, s[16:19], s100 offen offset:3264  lds
    v_mfma_f32_16x16x32_bf16 v[212:215], v[84:87], v[112:115], v[212:215]
    ds_read_b128 v[176:179], v31 offset:0
    v_mfma_f32_16x16x32_bf16 v[216:219], v[80:83], v[120:123], v[216:219]
    ds_read_b128 v[180:183], v31 offset:512
    v_mfma_f32_16x16x32_bf16 v[216:219], v[84:87], v[116:119], v[216:219]
    ds_read2_b32 v[148:149], v38 offset0:0 offset1:1
    v_mfma_f32_16x16x32_bf16 v[216:219], v[88:91], v[112:115], v[216:219]
    ds_read2_b32 v[150:151], v38 offset0:2 offset1:3
    v_mfma_f32_16x16x32_bf16 v[220:223], v[80:83], v[124:127], v[220:223]
    ds_read_b128 v[184:187], v31 offset:1024
    v_mfma_f32_16x16x32_bf16 v[220:223], v[84:87], v[120:123], v[220:223]
    ds_read2_b32 v[152:153], v33 offset0:128 offset1:129
    v_mfma_f32_16x16x32_bf16 v[220:223], v[88:91], v[116:119], v[220:223]
    ds_read2_b32 v[154:155], v33 offset0:130 offset1:131
    v_mfma_f32_16x16x32_bf16 v[220:223], v[92:95], v[112:115], v[220:223]
    ds_read_b128 v[188:191], v31 offset:1536
    v_mfma_f32_16x16x32_bf16 v[224:227], v[80:83], v[128:131], v[224:227]
    ds_read2_b32 v[156:157], v33 offset0:0 offset1:1
    v_mfma_f32_16x16x32_bf16 v[224:227], v[84:87], v[124:127], v[224:227]
    ds_read2_b32 v[158:159], v33 offset0:2 offset1:3
    v_mfma_f32_16x16x32_bf16 v[224:227], v[88:91], v[120:123], v[224:227]
    ds_read_b128 v[192:195], v31 offset:2048
    v_mfma_f32_16x16x32_bf16 v[224:227], v[92:95], v[116:119], v[224:227]
    ds_read2_b32 v[160:161], v32 offset0:128 offset1:129
    v_mfma_f32_16x16x32_bf16 v[224:227], v[96:99], v[112:115], v[224:227]
    ds_read2_b32 v[162:163], v32 offset0:130 offset1:131
    v_mfma_f32_16x16x32_bf16 v[228:231], v[80:83], v[132:135], v[228:231]
    ds_read_b128 v[196:199], v31 offset:2560
    s_waitcnt vmcnt(8)
    ds_read_b128 a[160:163], v250 offset:0
    ds_read_b128 a[164:167], v250 offset:64
    v_mfma_f32_16x16x32_bf16 v[228:231], v[84:87], v[128:131], v[228:231]
    ds_read2_b32 v[164:165], v32 offset0:0 offset1:1
    v_mfma_f32_16x16x32_bf16 v[228:231], v[88:91], v[124:127], v[228:231]
    ds_read2_b32 v[166:167], v32 offset0:2 offset1:3
    ds_read_b128 a[168:171], v250 offset:128
    ds_read_b128 a[172:175], v250 offset:192
    v_mfma_f32_16x16x32_bf16 v[228:231], v[92:95], v[120:123], v[228:231]
    ds_read_b128 v[200:203], v31 offset:3072
    v_mfma_f32_16x16x32_bf16 v[228:231], v[96:99], v[116:119], v[228:231]
    ds_read2_b32 v[168:169], v30 offset0:128 offset1:129
    ds_read_b128 a[176:179], v250 offset:256
    ds_read_b128 a[180:183], v250 offset:320
    v_mfma_f32_16x16x32_bf16 v[228:231], v[100:103], v[112:115], v[228:231]
    ds_read2_b32 v[170:171], v30 offset0:130 offset1:131
    buffer_load_dword v29, v25, s[20:23], 0 offen sc1
    v_mfma_f32_16x16x32_bf16 v[232:235], v[80:83], v[136:139], v[232:235]
    ds_read_b128 v[204:207], v31 offset:3584
    ds_read_b128 a[184:187], v250 offset:384
    ds_read_b128 a[188:191], v250 offset:448
    v_mfma_f32_16x16x32_bf16 v[232:235], v[84:87], v[132:135], v[232:235]
    ds_read2_b32 v[172:173], v30 offset0:0 offset1:1
    v_mfma_f32_16x16x32_bf16 v[232:235], v[88:91], v[128:131], v[232:235]
    ds_read2_b32 v[174:175], v30 offset0:2 offset1:3
    v_mfma_f32_16x16x32_bf16 v[232:235], v[92:95], v[124:127], v[232:235]
    v_mfma_f32_16x16x32_bf16 v[232:235], v[96:99], v[120:123], v[232:235]
    v_mfma_f32_16x16x32_bf16 v[232:235], v[100:103], v[116:119], v[232:235]
    v_mfma_f32_16x16x32_bf16 v[232:235], v[104:107], v[112:115], v[232:235]
    v_mfma_f32_16x16x32_bf16 v[236:239], v[80:83], v[140:143], v[236:239]
    v_mfma_f32_16x16x32_bf16 v[236:239], v[84:87], v[136:139], v[236:239]
    v_mfma_f32_16x16x32_bf16 v[236:239], v[88:91], v[132:135], v[236:239]
    v_mfma_f32_16x16x32_bf16 v[236:239], v[92:95], v[128:131], v[236:239]
    v_mfma_f32_16x16x32_bf16 v[236:239], v[96:99], v[124:127], v[236:239]
    v_mfma_f32_16x16x32_bf16 v[236:239], v[100:103], v[120:123], v[236:239]
    v_mfma_f32_16x16x32_bf16 v[236:239], v[104:107], v[116:119], v[236:239]
    v_mfma_f32_16x16x32_bf16 v[236:239], v[108:111], v[112:115], v[236:239]
    s_waitcnt lgkmcnt(15)
    v_mfma_f32_16x16x32_bf16 v[208:211], v[144:147], v[176:179], v[208:211]
    v_mfma_f32_16x16x32_bf16 v[212:215], v[144:147], v[180:183], v[212:215]
    s_waitcnt vmcnt(0)
    v_cmp_ne_u32 vcc, s31, v29
    s_nop 0
    s_cmp_eq_u64 vcc, 0
    s_cbranch_scc1 L_ok11
    s_mov_b32 s33, 0
L_poll12:
    buffer_load_dword v29, v25, s[20:23], 0 offen sc1
    s_add_u32 s33, s33, 1
    s_waitcnt vmcnt(0)
    v_cmp_ne_u32 vcc, s31, v29
    s_nop 0
    s_cmp_eq_u64 vcc, 0
    s_cbranch_scc1 L_polld13
    s_cmp_lt_u32 s33, 4000000
    s_cbranch_scc1 L_poll12
L_polld13:
L_ok11:
    v_mfma_f32_16x16x32_bf16 v[212:215], v[148:151], v[176:179], v[212:215]
    buffer_load_dwordx4 v[80:83], v4, s[20:23], s72 offen offset:0 sc1
    v_mfma_f32_16x16x32_bf16 v[216:219], v[144:147], v[184:187], v[216:219]
    v_mfma_f32_16x16x32_bf16 v[216:219], v[148:151], v[180:183], v[216:219]
    buffer_load_dwordx4 v[84:87], v4, s[20:23], s72 offen offset:1024 sc1
    v_mfma_f32_16x16x32_bf16 v[216:219], v[152:155], v[176:179], v[216:219]
    v_mfma_f32_16x16x32_bf16 v[220:223], v[144:147], v[188:191], v[220:223]
    v_mfma_f32_16x16x32_bf16 v[220:223], v[148:151], v[184:187], v[220:223]
    buffer_load_dwordx4 v[88:91], v4, s[20:23], s72 offen offset:2048 sc1
    v_mfma_f32_16x16x32_bf16 v[220:223], v[152:155], v[180:183], v[220:223]
    v_mfma_f32_16x16x32_bf16 v[220:223], v[156:159], v[176:179], v[220:223]
    s_waitcnt lgkmcnt(0)
    v_mfma_f32_16x16x32_bf16 v[224:227], v[144:147], v[192:195], v[224:227]
    buffer_load_dwordx4 v[92:95], v4, s[20:23], s72 offen offset:3072 sc1
    v_mfma_f32_16x16x32_bf16 v[224:227], v[148:151], v[188:191], v[224:227]
    v_mfma_f32_16x16x32_bf16 v[224:227], v[152:155], v[184:187], v[224:227]
    v_mfma_f32_16x16x32_bf16 v[224:227], v[156:159], v[180:183], v[224:227]
    buffer_load_dwordx4 v[96:99], v6, s[20:23], s72 offen offset:0 sc1
    v_mfma_f32_16x16x32_bf16 v[224:227], v[160:163], v[176:179], v[224:227]
    v_mfma_f32_16x16x32_bf16 v[228:231], v[144:147], v[196:199], v[228:231]
    buffer_load_dwordx4 v[100:103], v6, s[20:23], s72 offen offset:1024 sc1
    v_mfma_f32_16x16x32_bf16 v[228:231], v[148:151], v[192:195], v[228:231]
    v_mfma_f32_16x16x32_bf16 v[228:231], v[152:155], v[188:191], v[228:231]
    v_mfma_f32_16x16x32_bf16 v[228:231], v[156:159], v[184:187], v[228:231]
    buffer_load_dwordx4 v[104:107], v6, s[20:23], s72 offen offset:2048 sc1
    v_mfma_f32_16x16x32_bf16 v[228:231], v[160:163], v[180:183], v[228:231]
    v_mfma_f32_16x16x32_bf16 v[228:231], v[164:167], v[176:179], v[228:231]
    v_mfma_f32_16x16x32_bf16 v[232:235], v[144:147], v[200:203], v[232:235]
    buffer_load_dwordx4 v[108:111], v6, s[20:23], s72 offen offset:3072 sc1
    v_mfma_f32_16x16x32_bf16 v[232:235], v[148:151], v[196:199], v[232:235]
    v_mfma_f32_16x16x32_bf16 v[232:235], v[152:155], v[192:195], v[232:235]
    v_mfma_f32_16x16x32_bf16 v[232:235], v[156:159], v[188:191], v[232:235]
    buffer_load_dwordx4 v[112:115], v7, s[20:23], s72 offen offset:0 sc1
    v_mfma_f32_16x16x32_bf16 v[232:235], v[160:163], v[184:187], v[232:235]
    v_mfma_f32_16x16x32_bf16 v[232:235], v[164:167], v[180:183], v[232:235]
    buffer_load_dwordx4 v[116:119], v7, s[20:23], s72 offen offset:1024 sc1
    v_mfma_f32_16x16x32_bf16 v[232:235], v[168:171], v[176:179], v[232:235]
    v_mfma_f32_16x16x32_bf16 v[236:239], v[144:147], v[204:207], v[236:239]
    v_mfma_f32_16x16x32_bf16 v[236:239], v[148:151], v[200:203], v[236:239]
    buffer_load_dwordx4 v[120:123], v7, s[20:23], s72 offen offset:2048 sc1
    v_mfma_f32_16x16x32_bf16 v[236:239], v[152:155], v[196:199], v[236:239]
    v_mfma_f32_16x16x32_bf16 v[236:239], v[156:159], v[192:195], v[236:239]
    v_mfma_f32_16x16x32_bf16 v[236:239], v[160:163], v[188:191], v[236:239]
    buffer_load_dwordx4 v[124:127], v7, s[20:23], s72 offen offset:3072 sc1
    v_mfma_f32_16x16x32_bf16 v[236:239], v[164:167], v[184:187], v[236:239]
    v_mfma_f32_16x16x32_bf16 v[236:239], v[168:171], v[180:183], v[236:239]
    v_mfma_f32_16x16x32_bf16 v[236:239], v[172:175], v[176:179], v[236:239]
    s_bitcmp0_b32 s30, 0
    s_cbranch_scc1 L_nsw14
    v_swap_b32 v208, v224
    v_swap_b32 v209, v225
    v_swap_b32 v210, v226
    v_swap_b32 v211, v227
    v_swap_b32 v212, v228
    v_swap_b32 v213, v229
    v_swap_b32 v214, v230
    v_swap_b32 v215, v231
    v_swap_b32 v216, v232
    v_swap_b32 v217, v233
    v_swap_b32 v218, v234
    v_swap_b32 v219, v235
    v_swap_b32 v220, v236
    v_swap_b32 v221, v237
    v_swap_b32 v222, v238
    v_swap_b32 v223, v239
L_nsw14:
    s_waitcnt lgkmcnt(0)
    v_mov_b32 v38, 0xbdd2d3e8
    s_waitcnt vmcnt(10)
    v_mfma_f32_16x16x32_bf16 v[40:43], v[80:83], a[0:3], v[12:15]
    buffer_load_dwordx4 v[128:131], v8, s[20:23], s72 offen offset:0 sc1
    v_mfma_f32_16x16x32_bf16 v[40:43], v[84:87], a[4:7], v[40:43]
    ds_read_b128 a[224:227], v251 offset:0
    ds_read_b128 a[228:231], v251 offset:64
    ds_read_b128 a[232:235], v251 offset:128
    ds_read_b128 a[236:239], v251 offset:192
    v_mfma_f32_16x16x32_bf16 v[44:47], v[80:83], a[64:67], 0
    ds_read_b128 a[240:243], v251 offset:256
    ds_read_b128 a[244:247], v251 offset:320
    v_mfma_f32_16x16x32_bf16 v[44:47], v[84:87], a[68:71], v[44:47]
    ds_read_b128 a[248:251], v251 offset:384
    ds_read_b128 a[252:255], v251 offset:448
    ds_read_b64 v[252:253], v24 offset:0
    v_mfma_f32_16x16x32_bf16 v[48:51], v[80:83], a[128:131], 0
    buffer_load_dwordx4 v[132:135], v8, s[20:23], s72 offen offset:1024 sc1
    v_mfma_f32_16x16x32_bf16 v[48:51], v[84:87], a[132:135], v[48:51]
    v_mfma_f32_16x16x32_bf16 v[52:55], v[80:83], a[192:195], 0
    s_waitcnt lgkmcnt(0)
    v_mfma_f32_16x16x32_bf16 v[52:55], v[84:87], a[196:199], v[52:55]
    v_lshlrev_b32 v240, 16, v252
    s_waitcnt vmcnt(10)
    v_mfma_f32_16x16x32_bf16 v[40:43], v[88:91], a[8:11], v[40:43]
    buffer_load_dwordx4 v[136:139], v8, s[20:23], s72 offen offset:2048 sc1
    v_mfma_f32_16x16x32_bf16 v[40:43], v[92:95], a[12:15], v[40:43]
    ds_write_b128 v37, v[224:227] offset:0
    ds_write_b128 v37, v[228:231] offset:1024
    v_mfma_f32_16x16x32_bf16 v[44:47], v[88:91], a[72:75], v[44:47]
    ds_write_b128 v37, v[232:235] offset:2048
    v_mfma_f32_16x16x32_bf16 v[44:47], v[92:95], a[76:79], v[44:47]
    ds_write_b128 v37, v[236:239] offset:3072
    v_and_b32 v241, 0xffff0000, v252
    v_mfma_f32_16x16x32_bf16 v[48:51], v[88:91], a[136:139], v[48:51]
    buffer_load_dwordx4 v[140:143], v8, s[20:23], s72 offen offset:3072 sc1
    v_lshlrev_b32 v242, 16, v253
    v_mfma_f32_16x16x32_bf16 v[48:51], v[92:95], a[140:143], v[48:51]
    v_and_b32 v243, 0xffff0000, v253
    v_mul_f32 v248, v240, v240
    v_mfma_f32_16x16x32_bf16 v[52:55], v[88:91], a[200:203], v[52:55]
    v_mul_f32 v249, v241, v241
    v_mfma_f32_16x16x32_bf16 v[52:55], v[92:95], a[204:207], v[52:55]
    v_mul_f32 v250, v242, v242
    s_waitcnt vmcnt(10)
    v_mfma_f32_16x16x32_bf16 v[40:43], v[96:99], a[16:19], v[40:43]
    s_add_u32 s72, s72, 0x10000
    buffer_load_dwordx4 v[80:83], v4, s[20:23], s72 offen offset:0 sc1
    v_mfma_f32_16x16x32_bf16 v[40:43], v[100:103], a[20:23], v[40:43]
    s_waitcnt lgkmcnt(0)
    s_barrier
    v_mfma_f32_16x16x32_bf16 v[44:47], v[96:99], a[80:83], v[44:47]
    ds_read_b128 v[144:147], v36 offset:0
    v_mfma_f32_16x16x32_bf16 v[44:47], v[100:103], a[84:87], v[44:47]
    ds_read_b128 v[148:151], v36 offset:1024
    ds_read_b128 v[152:155], v36 offset:2048
    v_mfma_f32_16x16x32_bf16 v[48:51], v[96:99], a[144:147], v[48:51]
    buffer_load_dwordx4 v[84:87], v4, s[20:23], s72 offen offset:1024 sc1
    ds_read_b128 v[156:159], v36 offset:3072
    v_mfma_f32_16x16x32_bf16 v[48:51], v[100:103], a[148:151], v[48:51]
    v_mul_f32 v251, v243, v243
    v_fmaak_f32 v248, v38, v248, 0xc0135761
    v_mfma_f32_16x16x32_bf16 v[52:55], v[96:99], a[208:211], v[52:55]
    v_fmaak_f32 v249, v38, v249, 0xc0135761
    v_mfma_f32_16x16x32_bf16 v[52:55], v[100:103], a[212:215], v[52:55]
    v_fmaak_f32 v250, v38, v250, 0xc0135761
    s_waitcnt vmcnt(10)
    v_mfma_f32_16x16x32_bf16 v[40:43], v[104:107], a[24:27], v[40:43]
    buffer_load_dwordx4 v[88:91], v4, s[20:23], s72 offen offset:2048 sc1
    v_mfma_f32_16x16x32_bf16 v[40:43], v[108:111], a[28:31], v[40:43]
    s_waitcnt lgkmcnt(0)
    v_add_f32 v208, v208, v144
    v_mfma_f32_16x16x32_bf16 v[44:47], v[104:107], a[88:91], v[44:47]
    v_add_f32 v209, v209, v145
    v_mfma_f32_16x16x32_bf16 v[44:47], v[108:111], a[92:95], v[44:47]
    v_add_f32 v210, v210, v146
    v_add_f32 v211, v211, v147
    v_mfma_f32_16x16x32_bf16 v[48:51], v[104:107], a[152:155], v[48:51]
    buffer_load_dwordx4 v[92:95], v4, s[20:23], s72 offen offset:3072 sc1
    v_add_f32 v212, v212, v148
    v_mfma_f32_16x16x32_bf16 v[48:51], v[108:111], a[156:159], v[48:51]
    v_add_f32 v213, v213, v149
    v_add_f32 v214, v214, v150
    v_mfma_f32_16x16x32_bf16 v[52:55], v[104:107], a[216:219], v[52:55]
    v_add_f32 v215, v215, v151
    v_mfma_f32_16x16x32_bf16 v[52:55], v[108:111], a[220:223], v[52:55]
    v_add_f32 v216, v216, v152
    s_waitcnt vmcnt(10)
    v_mfma_f32_16x16x32_bf16 v[40:43], v[112:115], a[32:35], v[40:43]
    buffer_load_dwordx4 v[96:99], v6, s[20:23], s72 offen offset:0 sc1
    v_mfma_f32_16x16x32_bf16 v[40:43], v[116:119], a[36:39], v[40:43]
    v_add_f32 v217, v217, v153
    v_add_f32 v218, v218, v154
    v_mfma_f32_16x16x32_bf16 v[44:47], v[112:115], a[96:99], v[44:47]
    v_add_f32 v219, v219, v155
    v_mfma_f32_16x16x32_bf16 v[44:47], v[116:119], a[100:103], v[44:47]
    v_add_f32 v220, v220, v156
    v_add_f32 v221, v221, v157
    v_mfma_f32_16x16x32_bf16 v[48:51], v[112:115], a[160:163], v[48:51]
    buffer_load_dwordx4 v[100:103], v6, s[20:23], s72 offen offset:1024 sc1
    v_add_f32 v222, v222, v158
    v_mfma_f32_16x16x32_bf16 v[48:51], v[116:119], a[164:167], v[48:51]
    v_add_f32 v223, v223, v159
    v_cvt_pk_bf16_f32 v208, v208, v209
    v_mfma_f32_16x16x32_bf16 v[52:55], v[112:115], a[224:227], v[52:55]
    v_cvt_pk_bf16_f32 v209, v210, v211
    v_mfma_f32_16x16x32_bf16 v[52:55], v[116:119], a[228:231], v[52:55]
    v_cvt_pk_bf16_f32 v212, v212, v213
    s_waitcnt vmcnt(10)
    v_mfma_f32_16x16x32_bf16 v[40:43], v[120:123], a[40:43], v[40:43]
    buffer_load_dwordx4 v[104:107], v6, s[20:23], s72 offen offset:2048 sc1
    v_mfma_f32_16x16x32_bf16 v[40:43], v[124:127], a[44:47], v[40:43]
    v_cvt_pk_bf16_f32 v213, v214, v215
    v_cvt_pk_bf16_f32 v216, v216, v217
    v_mfma_f32_16x16x32_bf16 v[44:47], v[120:123], a[104:107], v[44:47]
    v_cvt_pk_bf16_f32 v217, v218, v219
    v_mfma_f32_16x16x32_bf16 v[44:47], v[124:127], a[108:111], v[44:47]
    v_cvt_pk_bf16_f32 v220, v220, v221
    v_cvt_pk_bf16_f32 v221, v222, v223
    v_mfma_f32_16x16x32_bf16 v[48:51], v[120:123], a[168:171], v[48:51]
    buffer_load_dwordx4 v[108:111], v6, s[20:23], s72 offen offset:3072 sc1
    ds_write_b64 v34, v[208:209] offset:0
    v_mfma_f32_16x16x32_bf16 v[48:51], v[124:127], a[172:175], v[48:51]
    ds_write_b64 v34, v[212:213] offset:512
    ds_write_b64 v34, v[216:217] offset:1024
    v_mfma_f32_16x16x32_bf16 v[52:55], v[120:123], a[232:235], v[52:55]
    ds_write_b64 v34, v[220:221] offset:1536
    v_mfma_f32_16x16x32_bf16 v[52:55], v[124:127], a[236:239], v[52:55]
    v_fmaak_f32 v251, v38, v251, 0xc0135761
    s_waitcnt vmcnt(10)
    v_mfma_f32_16x16x32_bf16 v[40:43], v[128:131], a[48:51], v[40:43]
    buffer_load_dwordx4 v[112:115], v7, s[20:23], s72 offen offset:0 sc1
    v_mfma_f32_16x16x32_bf16 v[40:43], v[132:135], a[52:55], v[40:43]
    v_mul_f32 v248, v248, v240
    v_mul_f32 v249, v249, v241
    v_mfma_f32_16x16x32_bf16 v[44:47], v[128:131], a[112:115], v[44:47]
    v_mul_f32 v250, v250, v242
    v_mfma_f32_16x16x32_bf16 v[44:47], v[132:135], a[116:119], v[44:47]
    v_mul_f32 v251, v251, v243
    v_exp_f32 v248, v248
    v_mfma_f32_16x16x32_bf16 v[48:51], v[128:131], a[176:179], v[48:51]
    buffer_load_dwordx4 v[116:119], v7, s[20:23], s72 offen offset:1024 sc1
    v_exp_f32 v249, v249
    v_mfma_f32_16x16x32_bf16 v[48:51], v[132:135], a[180:183], v[48:51]
    v_exp_f32 v250, v250
    v_exp_f32 v251, v251
    v_mfma_f32_16x16x32_bf16 v[52:55], v[128:131], a[240:243], v[52:55]
    v_add_f32 v248, 1.0, v248
    v_mfma_f32_16x16x32_bf16 v[52:55], v[132:135], a[244:247], v[52:55]
    v_add_f32 v249, 1.0, v249
    s_waitcnt vmcnt(10)
    v_mfma_f32_16x16x32_bf16 v[40:43], v[136:139], a[56:59], v[40:43]
    buffer_load_dwordx4 v[120:123], v7, s[20:23], s72 offen offset:2048 sc1
    v_mfma_f32_16x16x32_bf16 v[40:43], v[140:143], a[60:63], v[40:43]
    v_add_f32 v250, 1.0, v250
    v_add_f32 v251, 1.0, v251
    v_mfma_f32_16x16x32_bf16 v[44:47], v[136:139], a[120:123], v[44:47]
    v_rcp_f32 v248, v248
    v_mfma_f32_16x16x32_bf16 v[44:47], v[140:143], a[124:127], v[44:47]
    v_rcp_f32 v249, v249
    v_rcp_f32 v250, v250
    v_mfma_f32_16x16x32_bf16 v[48:51], v[136:139], a[184:187], v[48:51]
    buffer_load_dwordx4 v[124:127], v7, s[20:23], s72 offen offset:3072 sc1
    s_waitcnt lgkmcnt(0)
    v_mfma_f32_16x16x32_bf16 v[48:51], v[140:143], a[188:191], v[48:51]
    ds_read_b128 v[160:163], v35
    ds_read_b128 v[164:167], v35 offset:1024
    v_mfma_f32_16x16x32_bf16 v[52:55], v[136:139], a[248:251], v[52:55]
    v_rcp_f32 v251, v251
    v_mfma_f32_16x16x32_bf16 v[52:55], v[140:143], a[252:255], v[52:55]
    v_mul_f32 v240, v240, v248
    v_mul_f32 v241, v241, v249
    v_mul_f32 v242, v242, v250
    v_mul_f32 v243, v243, v251
    s_waitcnt vmcnt(10)
    v_mfma_f32_16x16x32_bf16 v[56:59], v[80:83], a[0:3], v[12:15]
    buffer_load_dwordx4 v[128:131], v8, s[20:23], s72 offen offset:0 sc1
    v_mfma_f32_16x16x32_bf16 v[56:59], v[84:87], a[4:7], v[56:59]
    s_waitcnt lgkmcnt(0)
    buffer_store_dwordx4 v[160:163], v4, s[20:23], s77 offen sc1
    v_mfma_f32_16x16x32_bf16 v[60:63], v[80:83], a[64:67], 0
    buffer_store_dwordx4 v[164:167], v4, s[20:23], s77 offen offset:1024 sc1
    v_mfma_f32_16x16x32_bf16 v[60:63], v[84:87], a[68:71], v[60:63]
    ds_read_b64 v[252:253], v24 offset:2048
    v_mfma_f32_16x16x32_bf16 v[64:67], v[80:83], a[128:131], 0
    buffer_load_dwordx4 v[132:135], v8, s[20:23], s72 offen offset:1024 sc1
    ds_write_b128 v21, v[44:47] offset:0
    v_mfma_f32_16x16x32_bf16 v[64:67], v[84:87], a[132:135], v[64:67]
    ds_write_b128 v22, v[48:51] offset:0
    ds_write_b128 v23, v[52:55] offset:0
    v_mfma_f32_16x16x32_bf16 v[68:71], v[80:83], a[192:195], 0
    v_mfma_f32_16x16x32_bf16 v[68:71], v[84:87], a[196:199], v[68:71]
    s_waitcnt vmcnt(12)
    v_mfma_f32_16x16x32_bf16 v[56:59], v[88:91], a[8:11], v[56:59]
    buffer_load_dwordx4 v[136:139], v8, s[20:23], s72 offen offset:2048 sc1
    v_mfma_f32_16x16x32_bf16 v[56:59], v[92:95], a[12:15], v[56:59]
    s_waitcnt lgkmcnt(3)
    v_lshlrev_b32 v244, 16, v252
    v_mfma_f32_16x16x32_bf16 v[60:63], v[88:91], a[72:75], v[60:63]
    v_and_b32 v245, 0xffff0000, v252
    v_mfma_f32_16x16x32_bf16 v[60:63], v[92:95], a[76:79], v[60:63]
    v_lshlrev_b32 v246, 16, v253
    v_and_b32 v247, 0xffff0000, v253
    v_mfma_f32_16x16x32_bf16 v[64:67], v[88:91], a[136:139], v[64:67]
    buffer_load_dwordx4 v[140:143], v8, s[20:23], s72 offen offset:3072 sc1
    s_waitcnt lgkmcnt(0)
    v_mfma_f32_16x16x32_bf16 v[64:67], v[92:95], a[140:143], v[64:67]
    s_barrier
    v_mul_f32 v248, v244, v244
    v_mfma_f32_16x16x32_bf16 v[68:71], v[88:91], a[200:203], v[68:71]
    v_mul_f32 v249, v245, v245
    v_mfma_f32_16x16x32_bf16 v[68:71], v[92:95], a[204:207], v[68:71]
    v_mul_f32 v250, v246, v246
    s_waitcnt vmcnt(12)
    v_mfma_f32_16x16x32_bf16 v[56:59], v[96:99], a[16:19], v[56:59]
    s_add_u32 s72, s72, 0x10000
    buffer_load_dwordx4 v[80:83], v4, s[20:23], s72 offen offset:0 sc1
    v_mfma_f32_16x16x32_bf16 v[56:59], v[100:103], a[20:23], v[56:59]
    ds_read_b128 v[72:75], v20 offset:0
    ds_read_b128 v[76:79], v20 offset:1024
    v_mfma_f32_16x16x32_bf16 v[60:63], v[96:99], a[80:83], v[60:63]
    ds_read_b128 v[32:35], v20 offset:2048
    v_mfma_f32_16x16x32_bf16 v[60:63], v[100:103], a[84:87], v[60:63]
    v_mul_f32 v251, v247, v247
    v_fmaak_f32 v248, v38, v248, 0xc0135761
    v_mfma_f32_16x16x32_bf16 v[64:67], v[96:99], a[144:147], v[64:67]
    buffer_load_dwordx4 v[84:87], v4, s[20:23], s72 offen offset:1024 sc1
    v_fmaak_f32 v249, v38, v249, 0xc0135761
    v_mfma_f32_16x16x32_bf16 v[64:67], v[100:103], a[148:151], v[64:67]
    v_fmaak_f32 v250, v38, v250, 0xc0135761
    v_fmaak_f32 v251, v38, v251, 0xc0135761
    v_mfma_f32_16x16x32_bf16 v[68:71], v[96:99], a[208:211], v[68:71]
    v_mul_f32 v248, v248, v244
    v_mfma_f32_16x16x32_bf16 v[68:71], v[100:103], a[212:215], v[68:71]
    v_mul_f32 v249, v249, v245
    s_waitcnt vmcnt(12)
    v_mfma_f32_16x16x32_bf16 v[56:59], v[104:107], a[24:27], v[56:59]
    buffer_load_dwordx4 v[88:91], v4, s[20:23], s72 offen offset:2048 sc1
    v_mfma_f32_16x16x32_bf16 v[56:59], v[108:111], a[28:31], v[56:59]
    s_waitcnt lgkmcnt(0)
    v_add_f32 v72, v72, v76
    v_mfma_f32_16x16x32_bf16 v[60:63], v[104:107], a[88:91], v[60:63]
    v_add_f32 v73, v73, v77
    v_mfma_f32_16x16x32_bf16 v[60:63], v[108:111], a[92:95], v[60:63]
    v_add_f32 v74, v74, v78
    v_add_f32 v75, v75, v79
    v_mfma_f32_16x16x32_bf16 v[64:67], v[104:107], a[152:155], v[64:67]
    buffer_load_dwordx4 v[92:95], v4, s[20:23], s72 offen offset:3072 sc1
    v_add_f32 v32, v32, v40
    v_mfma_f32_16x16x32_bf16 v[64:67], v[108:111], a[156:159], v[64:67]
    v_add_f32 v33, v33, v41
    v_add_f32 v34, v34, v42
    v_mfma_f32_16x16x32_bf16 v[68:71], v[104:107], a[216:219], v[68:71]
    v_add_f32 v35, v35, v43
    v_mfma_f32_16x16x32_bf16 v[68:71], v[108:111], a[220:223], v[68:71]
    v_add_f32 v72, v72, v32
    s_waitcnt vmcnt(12)
    v_mfma_f32_16x16x32_bf16 v[56:59], v[112:115], a[32:35], v[56:59]
    buffer_load_dwordx4 v[96:99], v6, s[20:23], s72 offen offset:0 sc1
    v_mfma_f32_16x16x32_bf16 v[56:59], v[116:119], a[36:39], v[56:59]
    v_add_f32 v73, v73, v33
    v_add_f32 v74, v74, v34
    v_mfma_f32_16x16x32_bf16 v[60:63], v[112:115], a[96:99], v[60:63]
    v_add_f32 v75, v75, v35
    v_mfma_f32_16x16x32_bf16 v[60:63], v[116:119], a[100:103], v[60:63]
    v_mul_f32 v72, v72, v240
    v_mul_f32 v73, v73, v241
    v_mfma_f32_16x16x32_bf16 v[64:67], v[112:115], a[160:163], v[64:67]
    buffer_load_dwordx4 v[100:103], v6, s[20:23], s72 offen offset:1024 sc1
    v_mul_f32 v74, v74, v242
    v_mfma_f32_16x16x32_bf16 v[64:67], v[116:119], a[164:167], v[64:67]
    v_mul_f32 v75, v75, v243
    v_cvt_pk_bf16_f32 v28, v72, v73
    v_mfma_f32_16x16x32_bf16 v[68:71], v[112:115], a[224:227], v[68:71]
    v_cvt_pk_bf16_f32 v29, v74, v75
    v_mfma_f32_16x16x32_bf16 v[68:71], v[116:119], a[228:231], v[68:71]
    v_lshrrev_b32 v254, 3, v1
    s_waitcnt vmcnt(12)
    v_mfma_f32_16x16x32_bf16 v[56:59], v[120:123], a[40:43], v[56:59]
    buffer_load_dwordx4 v[104:107], v6, s[20:23], s72 offen offset:2048 sc1
    v_mfma_f32_16x16x32_bf16 v[56:59], v[124:127], a[44:47], v[56:59]
    v_lshlrev_b32 v254, 7, v254
    buffer_load_dword v255, v254, s[20:23], s80 offen sc1
    v_mfma_f32_16x16x32_bf16 v[60:63], v[120:123], a[104:107], v[60:63]
    v_mul_f32 v250, v250, v246
    v_mfma_f32_16x16x32_bf16 v[60:63], v[124:127], a[108:111], v[60:63]
    v_mul_f32 v251, v251, v247
    v_exp_f32 v248, v248
    v_mfma_f32_16x16x32_bf16 v[64:67], v[120:123], a[168:171], v[64:67]
    buffer_load_dwordx4 v[108:111], v6, s[20:23], s72 offen offset:3072 sc1
    v_exp_f32 v249, v249
    v_mfma_f32_16x16x32_bf16 v[64:67], v[124:127], a[172:175], v[64:67]
    v_exp_f32 v250, v250
    v_exp_f32 v251, v251
    v_mfma_f32_16x16x32_bf16 v[68:71], v[120:123], a[232:235], v[68:71]
    v_add_f32 v248, 1.0, v248
    v_mfma_f32_16x16x32_bf16 v[68:71], v[124:127], a[236:239], v[68:71]
    v_add_f32 v249, 1.0, v249
    s_waitcnt vmcnt(11)
    v_mfma_f32_16x16x32_bf16 v[56:59], v[128:131], a[48:51], v[56:59]
    buffer_load_dwordx4 v[112:115], v7, s[20:23], s72 offen offset:0 sc1
    v_mfma_f32_16x16x32_bf16 v[56:59], v[132:135], a[52:55], v[56:59]
    v_add_f32 v250, 1.0, v250
    v_add_f32 v251, 1.0, v251
    v_mfma_f32_16x16x32_bf16 v[60:63], v[128:131], a[112:115], v[60:63]
    v_rcp_f32 v248, v248
    v_mfma_f32_16x16x32_bf16 v[60:63], v[132:135], a[116:119], v[60:63]
    v_rcp_f32 v249, v249
    v_rcp_f32 v250, v250
    v_mfma_f32_16x16x32_bf16 v[64:67], v[128:131], a[176:179], v[64:67]
    buffer_load_dwordx4 v[116:119], v7, s[20:23], s72 offen offset:1024 sc1
    v_rcp_f32 v251, v251
    v_mfma_f32_16x16x32_bf16 v[64:67], v[132:135], a[180:183], v[64:67]
    v_mul_f32 v244, v244, v248
    v_mul_f32 v245, v245, v249
    v_mfma_f32_16x16x32_bf16 v[68:71], v[128:131], a[240:243], v[68:71]
    v_mul_f32 v246, v246, v250
    v_mfma_f32_16x16x32_bf16 v[68:71], v[132:135], a[244:247], v[68:71]
    v_mul_f32 v247, v247, v251
    s_waitcnt vmcnt(11)
    v_mfma_f32_16x16x32_bf16 v[56:59], v[136:139], a[56:59], v[56:59]
    buffer_load_dwordx4 v[120:123], v7, s[20:23], s72 offen offset:2048 sc1
    v_mfma_f32_16x16x32_bf16 v[56:59], v[140:143], a[60:63], v[56:59]
    s_sub_u32 s36, s2, 32
    s_lshr_b32 s37, s36, 3
    v_mfma_f32_16x16x32_bf16 v[60:63], v[136:139], a[120:123], v[60:63]
    s_bfe_u32 s91, s2, 0x10002
    v_mfma_f32_16x16x32_bf16 v[60:63], v[140:143], a[124:127], v[60:63]
    s_and_b32 s36, s2, 3
    s_lshl1_add_u32 s36, s36, s91
    v_mfma_f32_16x16x32_bf16 v[64:67], v[136:139], a[184:187], v[64:67]
    buffer_load_dwordx4 v[124:127], v7, s[20:23], s72 offen offset:3072 sc1
    s_lshl_b32 s36, s36, 2
    v_mfma_f32_16x16x32_bf16 v[64:67], v[140:143], a[188:191], v[64:67]
    s_lshr_b32 s91, s37, 2
    s_and_b32 s37, s37, 3
    v_mfma_f32_16x16x32_bf16 v[68:71], v[136:139], a[248:251], v[68:71]
    s_add_u32 s90, s36, s37
    v_mfma_f32_16x16x32_bf16 v[68:71], v[140:143], a[252:255], v[68:71]
    s_lshl_b32 s92, s91, 12
    s_add_u32 s36, s92, 4096
    s_cmp_eq_u32 s36, 28672
    s_cselect_b32 s93, 0, s36
    s_add_u32 s36, s93, 4096
    s_cmp_eq_u32 s36, 28672
    s_cselect_b32 s96, 0, s36
    s_add_u32 s36, s96, 4096
    s_cmp_eq_u32 s36, 28672
    s_cselect_b32 s97, 0, s36
    s_add_u32 s36, s97, 4096
    s_cmp_eq_u32 s36, 28672
    s_cselect_b32 s70, 0, s36
    s_add_u32 s36, s70, 4096
    s_cmp_eq_u32 s36, 28672
    s_cselect_b32 s71, 0, s36
    s_add_u32 s36, s71, 4096
    s_cmp_eq_u32 s36, 28672
    s_cselect_b32 s76, 0, s36
    s_mul_i32 s75, s30, 28
    s_mul_i32 s36, s91, 112
    s_add_u32 s75, s75, s36
    s_lshl_b32 s75, s75, 10
    s_add_u32 s75, s75, 12582912
    v_lshrrev_b32 v16, 2, v1
    v_min_u32 v9, 6, v16
    s_waitcnt vmcnt(11)
    v_mfma_f32_16x16x32_bf16 v[40:43], v[80:83], a[0:3], v[12:15]
    buffer_load_dwordx4 v[128:131], v8, s[20:23], s72 offen offset:0 sc1
    v_mfma_f32_16x16x32_bf16 v[40:43], v[84:87], a[4:7], v[40:43]
    ds_read_b64 v[252:253], v24 offset:4096
    v_mfma_f32_16x16x32_bf16 v[44:47], v[80:83], a[64:67], 0
    v_mfma_f32_16x16x32_bf16 v[44:47], v[84:87], a[68:71], v[44:47]
    s_waitcnt lgkmcnt(0)
    v_mfma_f32_16x16x32_bf16 v[48:51], v[80:83], a[128:131], 0
    buffer_load_dwordx4 v[132:135], v8, s[20:23], s72 offen offset:1024 sc1
    ds_write_b128 v21, v[60:63] offset:12288
    v_mfma_f32_16x16x32_bf16 v[48:51], v[84:87], a[132:135], v[48:51]
    ds_write_b128 v22, v[64:67] offset:12288
    ds_write_b128 v23, v[68:71] offset:12288
    v_mfma_f32_16x16x32_bf16 v[52:55], v[80:83], a[192:195], 0
    v_lshlrev_b32 v240, 16, v252
    v_mfma_f32_16x16x32_bf16 v[52:55], v[84:87], a[196:199], v[52:55]
    v_and_b32 v241, 0xffff0000, v252
    s_waitcnt vmcnt(11)
    v_mfma_f32_16x16x32_bf16 v[40:43], v[88:91], a[8:11], v[40:43]
    buffer_load_dwordx4 v[136:139], v8, s[20:23], s72 offen offset:2048 sc1
    v_mfma_f32_16x16x32_bf16 v[40:43], v[92:95], a[12:15], v[40:43]
    v_lshlrev_b32 v242, 16, v253
    v_and_b32 v243, 0xffff0000, v253
    v_mfma_f32_16x16x32_bf16 v[44:47], v[88:91], a[72:75], v[44:47]
    v_mul_f32 v248, v240, v240
    v_mfma_f32_16x16x32_bf16 v[44:47], v[92:95], a[76:79], v[44:47]
    v_mul_f32 v249, v241, v241
    v_mul_f32 v250, v242, v242
    v_mfma_f32_16x16x32_bf16 v[48:51], v[88:91], a[136:139], v[48:51]
    buffer_load_dwordx4 v[140:143], v8, s[20:23], s72 offen offset:3072 sc1
    s_waitcnt lgkmcnt(0)
    v_mfma_f32_16x16x32_bf16 v[48:51], v[92:95], a[140:143], v[48:51]
    s_barrier
    v_mul_f32 v251, v243, v243
    v_mfma_f32_16x16x32_bf16 v[52:55], v[88:91], a[200:203], v[52:55]
    v_fmaak_f32 v248, v38, v248, 0xc0135761
    v_mfma_f32_16x16x32_bf16 v[52:55], v[92:95], a[204:207], v[52:55]
    v_fmaak_f32 v249, v38, v249, 0xc0135761
    s_waitcnt vmcnt(11)
    v_mfma_f32_16x16x32_bf16 v[40:43], v[96:99], a[16:19], v[40:43]
    s_add_u32 s72, s72, 0x10000
    buffer_load_dwordx4 v[80:83], v4, s[20:23], s72 offen offset:0 sc1
    v_mfma_f32_16x16x32_bf16 v[40:43], v[100:103], a[20:23], v[40:43]
    ds_read_b128 v[72:75], v20 offset:12288
    ds_read_b128 v[76:79], v20 offset:13312
    v_mfma_f32_16x16x32_bf16 v[44:47], v[96:99], a[80:83], v[44:47]
    ds_read_b128 v[32:35], v20 offset:14336
    v_mfma_f32_16x16x32_bf16 v[44:47], v[100:103], a[84:87], v[44:47]
    v_fmaak_f32 v250, v38, v250, 0xc0135761
    v_fmaak_f32 v251, v38, v251, 0xc0135761
    v_mfma_f32_16x16x32_bf16 v[48:51], v[96:99], a[144:147], v[48:51]
    buffer_load_dwordx4 v[84:87], v4, s[20:23], s72 offen offset:1024 sc1
    v_mul_f32 v248, v248, v240
    v_mfma_f32_16x16x32_bf16 v[48:51], v[100:103], a[148:151], v[48:51]
    v_mul_f32 v249, v249, v241
    v_mul_f32 v250, v250, v242
    v_mfma_f32_16x16x32_bf16 v[52:55], v[96:99], a[208:211], v[52:55]
    v_mul_f32 v251, v251, v243
    v_mfma_f32_16x16x32_bf16 v[52:55], v[100:103], a[212:215], v[52:55]
    v_exp_f32 v248, v248
    s_waitcnt vmcnt(10)
    v_mfma_f32_16x16x32_bf16 v[40:43], v[104:107], a[24:27], v[40:43]
    buffer_load_dwordx4 v[88:91], v4, s[20:23], s72 offen offset:2048 sc1
    v_mfma_f32_16x16x32_bf16 v[40:43], v[108:111], a[28:31], v[40:43]
    s_waitcnt lgkmcnt(0)
    v_add_f32 v72, v72, v76
    v_mfma_f32_16x16x32_bf16 v[44:47], v[104:107], a[88:91], v[44:47]
    v_add_f32 v73, v73, v77
    v_mfma_f32_16x16x32_bf16 v[44:47], v[108:111], a[92:95], v[44:47]
    v_add_f32 v74, v74, v78
    v_add_f32 v75, v75, v79
    v_mfma_f32_16x16x32_bf16 v[48:51], v[104:107], a[152:155], v[48:51]
    buffer_load_dwordx4 v[92:95], v4, s[20:23], s72 offen offset:3072 sc1
    v_add_f32 v32, v32, v56
    v_mfma_f32_16x16x32_bf16 v[48:51], v[108:111], a[156:159], v[48:51]
    v_add_f32 v33, v33, v57
    v_add_f32 v34, v34, v58
    v_mfma_f32_16x16x32_bf16 v[52:55], v[104:107], a[216:219], v[52:55]
    v_add_f32 v35, v35, v59
    v_mfma_f32_16x16x32_bf16 v[52:55], v[108:111], a[220:223], v[52:55]
    v_add_f32 v72, v72, v32
    s_waitcnt vmcnt(10)
    v_mfma_f32_16x16x32_bf16 v[40:43], v[112:115], a[32:35], v[40:43]
    buffer_load_dwordx4 v[96:99], v6, s[20:23], s72 offen offset:0 sc1
    v_mfma_f32_16x16x32_bf16 v[40:43], v[116:119], a[36:39], v[40:43]
L_stub4:
    s_cbranch_execz L_ret4
    v_add_f32 v73, v73, v33
    v_add_f32 v74, v74, v34
    v_mfma_f32_16x16x32_bf16 v[44:47], v[112:115], a[96:99], v[44:47]
    v_add_f32 v75, v75, v35
    v_mfma_f32_16x16x32_bf16 v[44:47], v[116:119], a[100:103], v[44:47]
    v_mul_f32 v72, v72, v244
    v_mul_f32 v73, v73, v245
    v_mfma_f32_16x16x32_bf16 v[48:51], v[112:115], a[160:163], v[48:51]
    buffer_load_dwordx4 v[100:103], v6, s[20:23], s72 offen offset:1024 sc1
    v_mul_f32 v74, v74, v246
    v_mfma_f32_16x16x32_bf16 v[48:51], v[116:119], a[164:167], v[48:51]
    v_mul_f32 v75, v75, v247
    v_cvt_pk_bf16_f32 v30, v72, v73
    v_mfma_f32_16x16x32_bf16 v[52:55], v[112:115], a[224:227], v[52:55]
    v_cvt_pk_bf16_f32 v31, v74, v75
    v_mfma_f32_16x16x32_bf16 v[52:55], v[116:119], a[228:231], v[52:55]
    buffer_store_dwordx4 v[28:31], v4, s[20:23], s73 offen offset:0 sc1
    s_waitcnt vmcnt(11)
    v_mfma_f32_16x16x32_bf16 v[40:43], v[120:123], a[40:43], v[40:43]
    buffer_load_dwordx4 v[104:107], v6, s[20:23], s72 offen offset:2048 sc1
    v_mfma_f32_16x16x32_bf16 v[40:43], v[124:127], a[44:47], v[40:43]
    s_cmp_lg_u32 s30, 0
    s_cbranch_scc1 L_flg15
    s_lshl_b32 s79, s29, 5
    s_add_u32 s79, s79, s28
    s_lshl_b32 s79, s79, 7
    s_add_u32 s79, s79, 14745600
    v_mov_b32 v18, s31
    s_mov_b64 exec, 1
    buffer_store_dword v18, v5, s[20:23], s79 offen sc1
    s_mov_b64 exec, -1
L_flg15:
    v_exp_f32 v249, v249
    v_mfma_f32_16x16x32_bf16 v[44:47], v[120:123], a[104:107], v[44:47]
    v_exp_f32 v250, v250
    v_mfma_f32_16x16x32_bf16 v[44:47], v[124:127], a[108:111], v[44:47]
    v_exp_f32 v251, v251
    v_add_f32 v248, 1.0, v248
    v_mfma_f32_16x16x32_bf16 v[48:51], v[120:123], a[168:171], v[48:51]
    buffer_load_dwordx4 v[108:111], v6, s[20:23], s72 offen offset:3072 sc1
    v_add_f32 v249, 1.0, v249
    v_mfma_f32_16x16x32_bf16 v[48:51], v[124:127], a[172:175], v[48:51]
    v_add_f32 v250, 1.0, v250
    v_add_f32 v251, 1.0, v251
    v_mfma_f32_16x16x32_bf16 v[52:55], v[120:123], a[232:235], v[52:55]
    v_rcp_f32 v248, v248
    v_mfma_f32_16x16x32_bf16 v[52:55], v[124:127], a[236:239], v[52:55]
    v_rcp_f32 v249, v249
    s_waitcnt vmcnt(11)
    v_mfma_f32_16x16x32_bf16 v[40:43], v[128:131], a[48:51], v[40:43]
    buffer_load_dwordx4 v[112:115], v7, s[20:23], s72 offen offset:0 sc1
    v_mfma_f32_16x16x32_bf16 v[40:43], v[132:135], a[52:55], v[40:43]
    v_rcp_f32 v250, v250
    v_rcp_f32 v251, v251
    v_mfma_f32_16x16x32_bf16 v[44:47], v[128:131], a[112:115], v[44:47]
    v_mul_f32 v240, v240, v248
    v_mfma_f32_16x16x32_bf16 v[44:47], v[132:135], a[116:119], v[44:47]
    v_mul_f32 v241, v241, v249
    v_mul_f32 v242, v242, v250
    v_mfma_f32_16x16x32_bf16 v[48:51], v[128:131], a[176:179], v[48:51]
    buffer_load_dwordx4 v[116:119], v7, s[20:23], s72 offen offset:1024 sc1
    v_mul_f32 v243, v243, v251
    v_mfma_f32_16x16x32_bf16 v[48:51], v[132:135], a[180:183], v[48:51]
    v_lshlrev_b32 v9, 7, v9
    v_lshlrev_b32 v16, 7, v16
    v_mfma_f32_16x16x32_bf16 v[52:55], v[128:131], a[240:243], v[52:55]
    s_lshl_b32 s81, s90, 10
    v_mfma_f32_16x16x32_bf16 v[52:55], v[132:135], a[244:247], v[52:55]
    s_add_u32 s81, s81, 14712832
    s_waitcnt vmcnt(11)
    v_mfma_f32_16x16x32_bf16 v[40:43], v[136:139], a[56:59], v[40:43]
    buffer_load_dwordx4 v[120:123], v7, s[20:23], s72 offen offset:2048 sc1
    v_mfma_f32_16x16x32_bf16 v[40:43], v[140:143], a[60:63], v[40:43]
    s_lshl_b32 s87, s30, 10
    s_add_u32 s87, s87, 49152
    v_mfma_f32_16x16x32_bf16 v[44:47], v[136:139], a[120:123], v[44:47]
    s_mul_i32 s82, s90, 112
    v_mfma_f32_16x16x32_bf16 v[44:47], v[140:143], a[124:127], v[44:47]
    s_mul_i32 s36, s30, 28
    s_add_u32 s82, s82, s36
    v_mfma_f32_16x16x32_bf16 v[48:51], v[136:139], a[184:187], v[48:51]
    buffer_load_dwordx4 v[124:127], v7, s[20:23], s72 offen offset:3072 sc1
    s_lshl_b32 s82, s82, 10
    v_mfma_f32_16x16x32_bf16 v[48:51], v[140:143], a[188:191], v[48:51]
    s_add_u32 s82, s82, 4194304
    s_lshl_b32 s83, s90, 8
    v_mfma_f32_16x16x32_bf16 v[52:55], v[136:139], a[248:251], v[52:55]
    s_add_u32 s83, s83, 13631488
    v_mfma_f32_16x16x32_bf16 v[52:55], v[140:143], a[252:255], v[52:55]
    v_and_b32 v17, 1, v2
    v_lshlrev_b32 v17, 4, v17
    v_mov_b32 v39, 0xffff
    v_lshlrev_b32 v17, v17, v39
    v_lshrrev_b32 v39, 2, v2
    v_cmp_eq_u32 vcc, v39, v3
    s_nop 1
    v_cndmask_b32 v17, 0, v17, vcc
    v_and_b32 v39, 2, v2
    v_cmp_eq_u32 vcc, 0, v39
    s_nop 1
    v_cndmask_b32 v39, v17, v5, vcc
    v_cndmask_b32 v17, v5, v17, vcc
    v_mul_u32_u24 v10, 896, v19
    v_lshl_add_u32 v10, v3, 3, v10
    s_mul_i32 s84, s90, 57344
    s_lshl_b32 s36, s91, 7
    s_add_u32 s84, s84, s36
    s_lshl_b32 s36, s30, 5
    s_add_u32 s84, s84, s36
    v_lshrrev_b32 v11, 3, v1
    s_waitcnt vmcnt(11)
    v_mfma_f32_16x16x32_bf16 v[56:59], v[80:83], a[0:3], v[12:15]
    buffer_load_dwordx4 v[128:131], v8, s[20:23], s72 offen offset:0 sc1
    v_mfma_f32_16x16x32_bf16 v[56:59], v[84:87], a[4:7], v[56:59]
    v_cmp_ne_u32 vcc, s31, v255
    s_nop 0
    s_cmp_eq_u64 vcc, 0
    s_cbranch_scc1 L_ok16
    s_mov_b32 s33, 0
L_poll17:
    buffer_load_dword v255, v254, s[20:23], s80 offen sc1
    s_add_u32 s33, s33, 1
    s_waitcnt vmcnt(0)
    v_cmp_ne_u32 vcc, s31, v255
    s_nop 0
    s_cmp_eq_u64 vcc, 0
    s_cbranch_scc1 L_polld18
    s_cmp_lt_u32 s33, 4000000
    s_cbranch_scc1 L_poll17
L_polld18:
L_ok16:
    ds_read_b64 v[252:253], v24 offset:6144
    v_mfma_f32_16x16x32_bf16 v[60:63], v[80:83], a[64:67], 0
    v_mfma_f32_16x16x32_bf16 v[60:63], v[84:87], a[68:71], v[60:63]
    v_mfma_f32_16x16x32_bf16 v[64:67], v[80:83], a[128:131], 0
    buffer_load_dwordx4 v[132:135], v8, s[20:23], s72 offen offset:1024 sc1
    ds_write_b128 v21, v[44:47] offset:0
    v_mfma_f32_16x16x32_bf16 v[64:67], v[84:87], a[132:135], v[64:67]
    ds_write_b128 v22, v[48:51] offset:0
    ds_write_b128 v23, v[52:55] offset:0
    v_mfma_f32_16x16x32_bf16 v[68:71], v[80:83], a[192:195], 0
    s_waitcnt lgkmcnt(3)
    v_mfma_f32_16x16x32_bf16 v[68:71], v[84:87], a[196:199], v[68:71]
    v_lshlrev_b32 v244, 16, v252
    s_waitcnt vmcnt(11)
    v_mfma_f32_16x16x32_bf16 v[56:59], v[88:91], a[8:11], v[56:59]
    buffer_load_dwordx4 v[136:139], v8, s[20:23], s72 offen offset:2048 sc1
    v_mfma_f32_16x16x32_bf16 v[56:59], v[92:95], a[12:15], v[56:59]
    v_and_b32 v245, 0xffff0000, v252
    v_lshlrev_b32 v246, 16, v253
    v_mfma_f32_16x16x32_bf16 v[60:63], v[88:91], a[72:75], v[60:63]
    v_and_b32 v247, 0xffff0000, v253
    v_mfma_f32_16x16x32_bf16 v[60:63], v[92:95], a[76:79], v[60:63]
    v_mul_f32 v248, v244, v244
    v_mul_f32 v249, v245, v245
    v_mfma_f32_16x16x32_bf16 v[64:67], v[88:91], a[136:139], v[64:67]
    buffer_load_dwordx4 v[140:143], v8, s[20:23], s72 offen offset:3072 sc1
    s_waitcnt lgkmcnt(0)
    v_mfma_f32_16x16x32_bf16 v[64:67], v[92:95], a[140:143], v[64:67]
    s_barrier
    v_mul_f32 v250, v246, v246
    v_mfma_f32_16x16x32_bf16 v[68:71], v[88:91], a[200:203], v[68:71]
    v_mul_f32 v251, v247, v247
    v_mfma_f32_16x16x32_bf16 v[68:71], v[92:95], a[204:207], v[68:71]
    v_fmaak_f32 v248, v38, v248, 0xc0135761
    s_waitcnt vmcnt(11)
    v_mfma_f32_16x16x32_bf16 v[56:59], v[96:99], a[16:19], v[56:59]
    s_add_u32 s72, s72, 0x10000
    buffer_load_dwordx4 v[80:83], v4, s[20:23], s72 offen offset:0 sc1
    v_mfma_f32_16x16x32_bf16 v[56:59], v[100:103], a[20:23], v[56:59]
    ds_read_b128 v[72:75], v20 offset:0
    ds_read_b128 v[76:79], v20 offset:1024
    v_mfma_f32_16x16x32_bf16 v[60:63], v[96:99], a[80:83], v[60:63]
    ds_read_b128 v[32:35], v20 offset:2048
    v_mfma_f32_16x16x32_bf16 v[60:63], v[100:103], a[84:87], v[60:63]
    v_fmaak_f32 v249, v38, v249, 0xc0135761
    v_fmaak_f32 v250, v38, v250, 0xc0135761
    v_mfma_f32_16x16x32_bf16 v[64:67], v[96:99], a[144:147], v[64:67]
    buffer_load_dwordx4 v[84:87], v4, s[20:23], s72 offen offset:1024 sc1
    v_fmaak_f32 v251, v38, v251, 0xc0135761
    v_mfma_f32_16x16x32_bf16 v[64:67], v[100:103], a[148:151], v[64:67]
    v_mul_f32 v248, v248, v244
    v_mul_f32 v249, v249, v245
    v_mfma_f32_16x16x32_bf16 v[68:71], v[96:99], a[208:211], v[68:71]
    v_mul_f32 v250, v250, v246
    v_mfma_f32_16x16x32_bf16 v[68:71], v[100:103], a[212:215], v[68:71]
    v_mul_f32 v251, v251, v247
    s_waitcnt vmcnt(10)
    v_mfma_f32_16x16x32_bf16 v[56:59], v[104:107], a[24:27], v[56:59]
    buffer_load_dwordx4 v[88:91], v4, s[20:23], s72 offen offset:2048 sc1
    v_mfma_f32_16x16x32_bf16 v[56:59], v[108:111], a[28:31], v[56:59]
    s_waitcnt lgkmcnt(0)
    v_add_f32 v72, v72, v76
    v_mfma_f32_16x16x32_bf16 v[60:63], v[104:107], a[88:91], v[60:63]
    v_add_f32 v73, v73, v77
    v_mfma_f32_16x16x32_bf16 v[60:63], v[108:111], a[92:95], v[60:63]
    v_add_f32 v74, v74, v78
    v_add_f32 v75, v75, v79
    v_mfma_f32_16x16x32_bf16 v[64:67], v[104:107], a[152:155], v[64:67]
    buffer_load_dwordx4 v[92:95], v4, s[20:23], s72 offen offset:3072 sc1
    v_add_f32 v32, v32, v40
    v_mfma_f32_16x16x32_bf16 v[64:67], v[108:111], a[156:159], v[64:67]
    v_add_f32 v33, v33, v41
    v_add_f32 v34, v34, v42
    v_mfma_f32_16x16x32_bf16 v[68:71], v[104:107], a[216:219], v[68:71]
    v_add_f32 v35, v35, v43
    v_mfma_f32_16x16x32_bf16 v[68:71], v[108:111], a[220:223], v[68:71]
    v_add_f32 v72, v72, v32
    s_waitcnt vmcnt(10)
    v_mfma_f32_16x16x32_bf16 v[56:59], v[112:115], a[32:35], v[56:59]
    buffer_load_dwordx4 v[96:99], v6, s[20:23], s72 offen offset:0 sc1
    v_mfma_f32_16x16x32_bf16 v[56:59], v[116:119], a[36:39], v[56:59]
    v_add_f32 v73, v73, v33
    v_add_f32 v74, v74, v34
    v_mfma_f32_16x16x32_bf16 v[60:63], v[112:115], a[96:99], v[60:63]
    v_add_f32 v75, v75, v35
    v_mfma_f32_16x16x32_bf16 v[60:63], v[116:119], a[100:103], v[60:63]
    v_mul_f32 v72, v72, v240
    v_mul_f32 v73, v73, v241
    v_mfma_f32_16x16x32_bf16 v[64:67], v[112:115], a[160:163], v[64:67]
    buffer_load_dwordx4 v[100:103], v6, s[20:23], s72 offen offset:1024 sc1
    v_mul_f32 v74, v74, v242
    v_mfma_f32_16x16x32_bf16 v[64:67], v[116:119], a[164:167], v[64:67]
    v_mul_f32 v75, v75, v243
    v_cvt_pk_bf16_f32 v28, v72, v73
    v_mfma_f32_16x16x32_bf16 v[68:71], v[112:115], a[224:227], v[68:71]
    v_cvt_pk_bf16_f32 v29, v74, v75
    v_mfma_f32_16x16x32_bf16 v[68:71], v[116:119], a[228:231], v[68:71]
    v_exp_f32 v248, v248
    s_waitcnt vmcnt(10)
    v_mfma_f32_16x16x32_bf16 v[56:59], v[120:123], a[40:43], v[56:59]
    buffer_load_dwordx4 v[104:107], v6, s[20:23], s72 offen offset:2048 sc1
    v_mfma_f32_16x16x32_bf16 v[56:59], v[124:127], a[44:47], v[56:59]
    v_exp_f32 v249, v249
    v_exp_f32 v250, v250
    v_mfma_f32_16x16x32_bf16 v[60:63], v[120:123], a[104:107], v[60:63]
    v_exp_f32 v251, v251
    v_mfma_f32_16x16x32_bf16 v[60:63], v[124:127], a[108:111], v[60:63]
    v_add_f32 v248, 1.0, v248
    v_add_f32 v249, 1.0, v249
    v_mfma_f32_16x16x32_bf16 v[64:67], v[120:123], a[168:171], v[64:67]
    buffer_load_dwordx4 v[108:111], v6, s[20:23], s72 offen offset:3072 sc1
    v_add_f32 v250, 1.0, v250
    v_mfma_f32_16x16x32_bf16 v[64:67], v[124:127], a[172:175], v[64:67]
    v_add_f32 v251, 1.0, v251
    v_rcp_f32 v248, v248
    v_mfma_f32_16x16x32_bf16 v[68:71], v[120:123], a[232:235], v[68:71]
    v_rcp_f32 v249, v249
    v_mfma_f32_16x16x32_bf16 v[68:71], v[124:127], a[236:239], v[68:71]
    v_rcp_f32 v250, v250
    s_waitcnt vmcnt(10)
    v_mfma_f32_16x16x32_bf16 v[56:59], v[128:131], a[48:51], v[56:59]
    buffer_load_dwordx4 v[112:115], v7, s[20:23], s72 offen offset:0 sc1
    v_mfma_f32_16x16x32_bf16 v[56:59], v[132:135], a[52:55], v[56:59]
    v_rcp_f32 v251, v251
    v_mul_f32 v244, v244, v248
    v_mfma_f32_16x16x32_bf16 v[60:63], v[128:131], a[112:115], v[60:63]
    v_mul_f32 v245, v245, v249
    v_mfma_f32_16x16x32_bf16 v[60:63], v[132:135], a[116:119], v[60:63]
    v_mul_f32 v246, v246, v250
    v_mul_f32 v247, v247, v251
    v_mfma_f32_16x16x32_bf16 v[64:67], v[128:131], a[176:179], v[64:67]
    buffer_load_dwordx4 v[116:119], v7, s[20:23], s72 offen offset:1024 sc1
    v_xor_b32 v36, v11, v1
    v_mfma_f32_16x16x32_bf16 v[64:67], v[132:135], a[180:183], v[64:67]
    v_and_b32 v36, 7, v36
    v_lshlrev_b32 v36, 4, v36
    v_mfma_f32_16x16x32_bf16 v[68:71], v[128:131], a[240:243], v[68:71]
    v_lshl_add_u32 v11, v11, 12, v36
    v_mfma_f32_16x16x32_bf16 v[68:71], v[132:135], a[244:247], v[68:71]
    v_and_b32 v36, 7, v2
    s_waitcnt vmcnt(10)
    v_mfma_f32_16x16x32_bf16 v[56:59], v[136:139], a[56:59], v[56:59]
    buffer_load_dwordx4 v[120:123], v7, s[20:23], s72 offen offset:2048 sc1
    v_mfma_f32_16x16x32_bf16 v[56:59], v[140:143], a[60:63], v[56:59]
    v_xor_b32 v36, v36, v3
    v_lshlrev_b32 v36, 4, v36
    v_mfma_f32_16x16x32_bf16 v[60:63], v[136:139], a[120:123], v[60:63]
    v_lshl_add_u32 v36, v2, 7, v36
    v_mfma_f32_16x16x32_bf16 v[60:63], v[140:143], a[124:127], v[60:63]
    s_lshl_b32 s77, s30, 11
    v_add_u32 v36, s77, v36
    v_mfma_f32_16x16x32_bf16 v[64:67], v[136:139], a[184:187], v[64:67]
    buffer_load_dwordx4 v[124:127], v7, s[20:23], s72 offen offset:3072 sc1
    v_xor_b32 v37, 64, v36
    v_mfma_f32_16x16x32_bf16 v[64:67], v[140:143], a[188:191], v[64:67]
    s_lshl_b32 s85, s91, 2
    s_add_u32 s85, s85, s30
    v_mfma_f32_16x16x32_bf16 v[68:71], v[136:139], a[248:251], v[68:71]
    s_lshl_b32 s85, s85, 16
    v_mfma_f32_16x16x32_bf16 v[68:71], v[140:143], a[252:255], v[68:71]
    s_lshl_b32 s36, s90, 7
    s_add_u32 s85, s85, s36
    s_add_u32 s85, s85, 10485760
    s_lshl_b32 s86, s91, 12
    s_lshl_b32 s36, s30, 10
    s_add_u32 s86, s86, s36
    s_add_u32 s86, s86, 14744576
    v_add_u32 v16, s86, v16
    s_lshl_b32 s36, s90, 7
    s_add_u32 s36, s36, 14802944
    s_mov_b32 exec_hi, 0
    v_add_u32 v16, s81, v9
    s_mov_b32 exec_lo, 0xf0000000
    v_mov_b32 v16, s36
    s_mov_b64 exec, -1
    v_lshlrev_b32 v0, 4, v2
    s_waitcnt vmcnt(10)
    v_mfma_f32_16x16x32_bf16 v[40:43], v[80:83], a[0:3], v[12:15]
    buffer_load_dwordx4 v[128:131], v8, s[20:23], s72 offen offset:0 sc1
    v_mfma_f32_16x16x32_bf16 v[40:43], v[84:87], a[4:7], v[40:43]
    ds_read_b64 v[252:253], v24 offset:8192
    v_mfma_f32_16x16x32_bf16 v[44:47], v[80:83], a[64:67], 0
    s_add_u32 s74, s75, s92
    buffer_load_dwordx4 v[144:147], v4, s[20:23], s74 offen offset:0 sc1
    v_mfma_f32_16x16x32_bf16 v[44:47], v[84:87], a[68:71], v[44:47]
    s_waitcnt lgkmcnt(0)
    v_mfma_f32_16x16x32_bf16 v[48:51], v[80:83], a[128:131], 0
    buffer_load_dwordx4 v[132:135], v8, s[20:23], s72 offen offset:1024 sc1
    ds_write_b128 v21, v[60:63] offset:12288
    v_mfma_f32_16x16x32_bf16 v[48:51], v[84:87], a[132:135], v[48:51]
    ds_write_b128 v22, v[64:67] offset:12288
    ds_write_b128 v23, v[68:71] offset:12288
    v_mfma_f32_16x16x32_bf16 v[52:55], v[80:83], a[192:195], 0
    v_lshlrev_b32 v240, 16, v252
    v_mfma_f32_16x16x32_bf16 v[52:55], v[84:87], a[196:199], v[52:55]
    v_and_b32 v241, 0xffff0000, v252
    s_waitcnt vmcnt(11)
    v_mfma_f32_16x16x32_bf16 v[40:43], v[88:91], a[8:11], v[40:43]
    buffer_load_dwordx4 v[136:139], v8, s[20:23], s72 offen offset:2048 sc1
    v_mfma_f32_16x16x32_bf16 v[40:43], v[92:95], a[12:15], v[40:43]
    v_lshlrev_b32 v242, 16, v253
    v_and_b32 v243, 0xffff0000, v253
    v_mfma_f32_16x16x32_bf16 v[44:47], v[88:91], a[72:75], v[44:47]
    s_add_u32 s74, s75, s93
    buffer_load_dwordx4 v[148:151], v4, s[20:23], s74 offen offset:0 sc1
    v_mul_f32 v248, v240, v240
    v_mfma_f32_16x16x32_bf16 v[44:47], v[92:95], a[76:79], v[44:47]
    v_mul_f32 v249, v241, v241
    v_mul_f32 v250, v242, v242
    v_mfma_f32_16x16x32_bf16 v[48:51], v[88:91], a[136:139], v[48:51]
    buffer_load_dwordx4 v[140:143], v8, s[20:23], s72 offen offset:3072 sc1
    s_waitcnt lgkmcnt(0)
    v_mfma_f32_16x16x32_bf16 v[48:51], v[92:95], a[140:143], v[48:51]
    s_barrier
    v_mul_f32 v251, v243, v243
    v_mfma_f32_16x16x32_bf16 v[52:55], v[88:91], a[200:203], v[52:55]
    v_fmaak_f32 v248, v38, v248, 0xc0135761
    v_mfma_f32_16x16x32_bf16 v[52:55], v[92:95], a[204:207], v[52:55]
    v_fmaak_f32 v249, v38, v249, 0xc0135761
    s_waitcnt vmcnt(12)
    v_mfma_f32_16x16x32_bf16 v[40:43], v[96:99], a[16:19], v[40:43]
    s_add_u32 s72, s72, 0x10000
    buffer_load_dwordx4 v[80:83], v4, s[20:23], s72 offen offset:0 sc1
    v_mfma_f32_16x16x32_bf16 v[40:43], v[100:103], a[20:23], v[40:43]
    ds_read_b128 v[72:75], v20 offset:12288
    ds_read_b128 v[76:79], v20 offset:13312
    v_mfma_f32_16x16x32_bf16 v[44:47], v[96:99], a[80:83], v[44:47]
    ds_read_b128 v[32:35], v20 offset:14336
    v_mfma_f32_16x16x32_bf16 v[44:47], v[100:103], a[84:87], v[44:47]
    v_fmaak_f32 v250, v38, v250, 0xc0135761
    v_fmaak_f32 v251, v38, v251, 0xc0135761
    v_mfma_f32_16x16x32_bf16 v[48:51], v[96:99], a[144:147], v[48:51]
    buffer_load_dwordx4 v[84:87], v4, s[20:23], s72 offen offset:1024 sc1
    v_mul_f32 v248, v248, v240
    v_mfma_f32_16x16x32_bf16 v[48:51], v[100:103], a[148:151], v[48:51]
    v_mul_f32 v249, v249, v241
    v_mul_f32 v250, v250, v242
    v_mfma_f32_16x16x32_bf16 v[52:55], v[96:99], a[208:211], v[52:55]
    v_mul_f32 v251, v251, v243
    v_mfma_f32_16x16x32_bf16 v[52:55], v[100:103], a[212:215], v[52:55]
    v_exp_f32 v248, v248
    s_waitcnt vmcnt(12)
    v_mfma_f32_16x16x32_bf16 v[40:43], v[104:107], a[24:27], v[40:43]
    buffer_load_dwordx4 v[88:91], v4, s[20:23], s72 offen offset:2048 sc1
    v_mfma_f32_16x16x32_bf16 v[40:43], v[108:111], a[28:31], v[40:43]
    s_waitcnt lgkmcnt(0)
    v_add_f32 v72, v72, v76
    v_mfma_f32_16x16x32_bf16 v[44:47], v[104:107], a[88:91], v[44:47]
    v_add_f32 v73, v73, v77
    v_mfma_f32_16x16x32_bf16 v[44:47], v[108:111], a[92:95], v[44:47]
    v_add_f32 v74, v74, v78
    v_add_f32 v75, v75, v79
    v_mfma_f32_16x16x32_bf16 v[48:51], v[104:107], a[152:155], v[48:51]
    buffer_load_dwordx4 v[92:95], v4, s[20:23], s72 offen offset:3072 sc1
    v_add_f32 v32, v32, v56
    v_mfma_f32_16x16x32_bf16 v[48:51], v[108:111], a[156:159], v[48:51]
    v_add_f32 v33, v33, v57
    v_add_f32 v34, v34, v58
    v_mfma_f32_16x16x32_bf16 v[52:55], v[104:107], a[216:219], v[52:55]
    v_add_f32 v35, v35, v59
    v_mfma_f32_16x16x32_bf16 v[52:55], v[108:111], a[220:223], v[52:55]
    v_add_f32 v72, v72, v32
    s_waitcnt vmcnt(12)
    v_mfma_f32_16x16x32_bf16 v[40:43], v[112:115], a[32:35], v[40:43]
    buffer_load_dwordx4 v[96:99], v6, s[20:23], s72 offen offset:0 sc1
    v_mfma_f32_16x16x32_bf16 v[40:43], v[116:119], a[36:39], v[40:43]
    v_add_f32 v73, v73, v33
    v_add_f32 v74, v74, v34
    v_mfma_f32_16x16x32_bf16 v[44:47], v[112:115], a[96:99], v[44:47]
    v_add_f32 v75, v75, v35
    v_mfma_f32_16x16x32_bf16 v[44:47], v[116:119], a[100:103], v[44:47]
    v_mul_f32 v72, v72, v244
    v_mul_f32 v73, v73, v245
    v_mfma_f32_16x16x32_bf16 v[48:51], v[112:115], a[160:163], v[48:51]
    buffer_load_dwordx4 v[100:103], v6, s[20:23], s72 offen offset:1024 sc1
    v_mul_f32 v74, v74, v246
    v_mfma_f32_16x16x32_bf16 v[48:51], v[116:119], a[164:167], v[48:51]
    v_mul_f32 v75, v75, v247
    v_cvt_pk_bf16_f32 v30, v72, v73
    v_mfma_f32_16x16x32_bf16 v[52:55], v[112:115], a[224:227], v[52:55]
    v_cvt_pk_bf16_f32 v31, v74, v75
    v_mfma_f32_16x16x32_bf16 v[52:55], v[116:119], a[228:231], v[52:55]
    buffer_store_dwordx4 v[28:31], v4, s[20:23], s73 offen offset:1024 sc1
    s_waitcnt vmcnt(13)
    v_mfma_f32_16x16x32_bf16 v[40:43], v[120:123], a[40:43], v[40:43]
    buffer_load_dwordx4 v[104:107], v6, s[20:23], s72 offen offset:2048 sc1
    v_mfma_f32_16x16x32_bf16 v[40:43], v[124:127], a[44:47], v[40:43]
    v_exp_f32 v249, v249
    v_exp_f32 v250, v250
    v_mfma_f32_16x16x32_bf16 v[44:47], v[120:123], a[104:107], v[44:47]
    v_exp_f32 v251, v251
    v_mfma_f32_16x16x32_bf16 v[44:47], v[124:127], a[108:111], v[44:47]
    v_add_f32 v248, 1.0, v248
    v_add_f32 v249, 1.0, v249
    v_mfma_f32_16x16x32_bf16 v[48:51], v[120:123], a[168:171], v[48:51]
    buffer_load_dwordx4 v[108:111], v6, s[20:23], s72 offen offset:3072 sc1
    v_add_f32 v250, 1.0, v250
    v_mfma_f32_16x16x32_bf16 v[48:51], v[124:127], a[172:175], v[48:51]
    v_add_f32 v251, 1.0, v251
    v_rcp_f32 v248, v248
    v_mfma_f32_16x16x32_bf16 v[52:55], v[120:123], a[232:235], v[52:55]
    v_rcp_f32 v249, v249
    v_mfma_f32_16x16x32_bf16 v[52:55], v[124:127], a[236:239], v[52:55]
    v_rcp_f32 v250, v250
    s_waitcnt vmcnt(12)
    v_mfma_f32_16x16x32_bf16 v[40:43], v[128:131], a[48:51], v[40:43]
    buffer_load_dwordx4 v[112:115], v7, s[20:23], s72 offen offset:0 sc1
    v_mfma_f32_16x16x32_bf16 v[40:43], v[132:135], a[52:55], v[40:43]
    v_rcp_f32 v251, v251
    v_mul_f32 v240, v240, v248
    v_mfma_f32_16x16x32_bf16 v[44:47], v[128:131], a[112:115], v[44:47]
    v_mul_f32 v241, v241, v249
    v_mfma_f32_16x16x32_bf16 v[44:47], v[132:135], a[116:119], v[44:47]
    v_mul_f32 v242, v242, v250
    v_mul_f32 v243, v243, v251
    v_mfma_f32_16x16x32_bf16 v[48:51], v[128:131], a[176:179], v[48:51]
    buffer_load_dwordx4 v[116:119], v7, s[20:23], s72 offen offset:1024 sc1
    v_mfma_f32_16x16x32_bf16 v[48:51], v[132:135], a[180:183], v[48:51]
    v_mfma_f32_16x16x32_bf16 v[52:55], v[128:131], a[240:243], v[52:55]
    v_mfma_f32_16x16x32_bf16 v[52:55], v[132:135], a[244:247], v[52:55]
    s_waitcnt vmcnt(11)
    v_mfma_f32_16x16x32_bf16 v[40:43], v[136:139], a[56:59], v[40:43]
    buffer_load_dwordx4 v[120:123], v7, s[20:23], s72 offen offset:2048 sc1
    v_mfma_f32_16x16x32_bf16 v[40:43], v[140:143], a[60:63], v[40:43]
    v_mfma_f32_16x16x32_bf16 v[44:47], v[136:139], a[120:123], v[44:47]
    v_mfma_f32_16x16x32_bf16 v[44:47], v[140:143], a[124:127], v[44:47]
    v_mfma_f32_16x16x32_bf16 v[48:51], v[136:139], a[184:187], v[48:51]
    buffer_load_dwordx4 v[124:127], v7, s[20:23], s72 offen offset:3072 sc1
    v_mfma_f32_16x16x32_bf16 v[48:51], v[140:143], a[188:191], v[48:51]
    v_mfma_f32_16x16x32_bf16 v[52:55], v[136:139], a[248:251], v[52:55]
    v_mfma_f32_16x16x32_bf16 v[52:55], v[140:143], a[252:255], v[52:55]
    s_waitcnt vmcnt(11)
    v_mfma_f32_16x16x32_bf16 v[56:59], v[80:83], a[0:3], v[12:15]
    buffer_load_dwordx4 v[128:131], v8, s[20:23], s72 offen offset:0 sc1
    v_mfma_f32_16x16x32_bf16 v[56:59], v[84:87], a[4:7], v[56:59]
    ds_read_b64 v[252:253], v24 offset:10240
    v_mfma_f32_16x16x32_bf16 v[60:63], v[80:83], a[64:67], 0
    s_add_u32 s74, s75, s96
    buffer_load_dwordx4 v[152:155], v4, s[20:23], s74 offen offset:0 sc1
    v_mfma_f32_16x16x32_bf16 v[60:63], v[84:87], a[68:71], v[60:63]
    s_waitcnt lgkmcnt(0)
    v_mfma_f32_16x16x32_bf16 v[64:67], v[80:83], a[128:131], 0
    buffer_load_dwordx4 v[132:135], v8, s[20:23], s72 offen offset:1024 sc1
    ds_write_b128 v21, v[44:47] offset:0
    v_mfma_f32_16x16x32_bf16 v[64:67], v[84:87], a[132:135], v[64:67]
    ds_write_b128 v22, v[48:51] offset:0
    ds_write_b128 v23, v[52:55] offset:0
    v_mfma_f32_16x16x32_bf16 v[68:71], v[80:83], a[192:195], 0
    v_lshlrev_b32 v244, 16, v252
    v_mfma_f32_16x16x32_bf16 v[68:71], v[84:87], a[196:199], v[68:71]
    v_and_b32 v245, 0xffff0000, v252
    s_waitcnt vmcnt(12)
    v_mfma_f32_16x16x32_bf16 v[56:59], v[88:91], a[8:11], v[56:59]
    buffer_load_dwordx4 v[136:139], v8, s[20:23], s72 offen offset:2048 sc1
    v_mfma_f32_16x16x32_bf16 v[56:59], v[92:95], a[12:15], v[56:59]
    v_lshlrev_b32 v246, 16, v253
    v_and_b32 v247, 0xffff0000, v253
    v_mfma_f32_16x16x32_bf16 v[60:63], v[88:91], a[72:75], v[60:63]
    s_add_u32 s74, s75, s97
    buffer_load_dwordx4 v[156:159], v4, s[20:23], s74 offen offset:0 sc1
    v_mul_f32 v248, v244, v244
    v_mfma_f32_16x16x32_bf16 v[60:63], v[92:95], a[76:79], v[60:63]
    v_mul_f32 v249, v245, v245
    v_mul_f32 v250, v246, v246
    v_mfma_f32_16x16x32_bf16 v[64:67], v[88:91], a[136:139], v[64:67]
    buffer_load_dwordx4 v[140:143], v8, s[20:23], s72 offen offset:3072 sc1
    s_waitcnt lgkmcnt(0)
    v_mfma_f32_16x16x32_bf16 v[64:67], v[92:95], a[140:143], v[64:67]
    s_barrier
    v_mul_f32 v251, v247, v247
    v_mfma_f32_16x16x32_bf16 v[68:71], v[88:91], a[200:203], v[68:71]
    v_fmaak_f32 v248, v38, v248, 0xc0135761
    v_mfma_f32_16x16x32_bf16 v[68:71], v[92:95], a[204:207], v[68:71]
    v_fmaak_f32 v249, v38, v249, 0xc0135761
    s_waitcnt vmcnt(13)
    v_mfma_f32_16x16x32_bf16 v[56:59], v[96:99], a[16:19], v[56:59]
    s_add_u32 s72, s72, 0x10000
    buffer_load_dwordx4 v[80:83], v4, s[20:23], s72 offen offset:0 sc1
    v_mfma_f32_16x16x32_bf16 v[56:59], v[100:103], a[20:23], v[56:59]
    ds_read_b128 v[72:75], v20 offset:0
    ds_read_b128 v[76:79], v20 offset:1024
    v_mfma_f32_16x16x32_bf16 v[60:63], v[96:99], a[80:83], v[60:63]
    ds_read_b128 v[32:35], v20 offset:2048
    v_mfma_f32_16x16x32_bf16 v[60:63], v[100:103], a[84:87], v[60:63]
    v_fmaak_f32 v250, v38, v250, 0xc0135761
    v_fmaak_f32 v251, v38, v251, 0xc0135761
    v_mfma_f32_16x16x32_bf16 v[64:67], v[96:99], a[144:147], v[64:67]
    buffer_load_dwordx4 v[84:87], v4, s[20:23], s72 offen offset:1024 sc1
    v_mul_f32 v248, v248, v244
    v_mfma_f32_16x16x32_bf16 v[64:67], v[100:103], a[148:151], v[64:67]
    v_mul_f32 v249, v249, v245
    v_mul_f32 v250, v250, v246
    v_mfma_f32_16x16x32_bf16 v[68:71], v[96:99], a[208:211], v[68:71]
    v_mul_f32 v251, v251, v247
    v_mfma_f32_16x16x32_bf16 v[68:71], v[100:103], a[212:215], v[68:71]
    v_exp_f32 v248, v248
    s_waitcnt vmcnt(12)
    v_mfma_f32_16x16x32_bf16 v[56:59], v[104:107], a[24:27], v[56:59]
    buffer_load_dwordx4 v[88:91], v4, s[20:23], s72 offen offset:2048 sc1
    v_mfma_f32_16x16x32_bf16 v[56:59], v[108:111], a[28:31], v[56:59]
    s_waitcnt lgkmcnt(0)
    v_add_f32 v72, v72, v76
    v_mfma_f32_16x16x32_bf16 v[60:63], v[104:107], a[88:91], v[60:63]
    v_add_f32 v73, v73, v77
    v_mfma_f32_16x16x32_bf16 v[60:63], v[108:111], a[92:95], v[60:63]
    v_add_f32 v74, v74, v78
    v_add_f32 v75, v75, v79
    v_mfma_f32_16x16x32_bf16 v[64:67], v[104:107], a[152:155], v[64:67]
    buffer_load_dwordx4 v[92:95], v4, s[20:23], s72 offen offset:3072 sc1
    v_add_f32 v32, v32, v40
    v_mfma_f32_16x16x32_bf16 v[64:67], v[108:111], a[156:159], v[64:67]
    v_add_f32 v33, v33, v41
    v_add_f32 v34, v34, v42
    v_mfma_f32_16x16x32_bf16 v[68:71], v[104:107], a[216:219], v[68:71]
    v_add_f32 v35, v35, v43
    v_mfma_f32_16x16x32_bf16 v[68:71], v[108:111], a[220:223], v[68:71]
    v_add_f32 v72, v72, v32
    s_waitcnt vmcnt(12)
    v_mfma_f32_16x16x32_bf16 v[56:59], v[112:115], a[32:35], v[56:59]
    buffer_load_dwordx4 v[96:99], v6, s[20:23], s72 offen offset:0 sc1
    v_mfma_f32_16x16x32_bf16 v[56:59], v[116:119], a[36:39], v[56:59]
    v_add_f32 v73, v73, v33
    v_add_f32 v74, v74, v34
    v_mfma_f32_16x16x32_bf16 v[60:63], v[112:115], a[96:99], v[60:63]
    v_add_f32 v75, v75, v35
    v_mfma_f32_16x16x32_bf16 v[60:63], v[116:119], a[100:103], v[60:63]
    v_mul_f32 v72, v72, v240
    v_mul_f32 v73, v73, v241
    v_mfma_f32_16x16x32_bf16 v[64:67], v[112:115], a[160:163], v[64:67]
    buffer_load_dwordx4 v[100:103], v6, s[20:23], s72 offen offset:1024 sc1
    v_mul_f32 v74, v74, v242
    v_mfma_f32_16x16x32_bf16 v[64:67], v[116:119], a[164:167], v[64:67]
    v_mul_f32 v75, v75, v243
    v_cvt_pk_bf16_f32 v28, v72, v73
    v_mfma_f32_16x16x32_bf16 v[68:71], v[112:115], a[224:227], v[68:71]
    v_cvt_pk_bf16_f32 v29, v74, v75
    v_mfma_f32_16x16x32_bf16 v[68:71], v[116:119], a[228:231], v[68:71]
    v_exp_f32 v249, v249
    s_waitcnt vmcnt(12)
    v_mfma_f32_16x16x32_bf16 v[56:59], v[120:123], a[40:43], v[56:59]
    buffer_load_dwordx4 v[104:107], v6, s[20:23], s72 offen offset:2048 sc1
    v_mfma_f32_16x16x32_bf16 v[56:59], v[124:127], a[44:47], v[56:59]
    v_exp_f32 v250, v250
    v_exp_f32 v251, v251
    v_mfma_f32_16x16x32_bf16 v[60:63], v[120:123], a[104:107], v[60:63]
    v_add_f32 v248, 1.0, v248
    v_mfma_f32_16x16x32_bf16 v[60:63], v[124:127], a[108:111], v[60:63]
    v_add_f32 v249, 1.0, v249
    v_add_f32 v250, 1.0, v250
    v_mfma_f32_16x16x32_bf16 v[64:67], v[120:123], a[168:171], v[64:67]
    buffer_load_dwordx4 v[108:111], v6, s[20:23], s72 offen offset:3072 sc1
    v_add_f32 v251, 1.0, v251
    v_mfma_f32_16x16x32_bf16 v[64:67], v[124:127], a[172:175], v[64:67]
    v_rcp_f32 v248, v248
    v_rcp_f32 v249, v249
    v_mfma_f32_16x16x32_bf16 v[68:71], v[120:123], a[232:235], v[68:71]
    v_rcp_f32 v250, v250
    v_mfma_f32_16x16x32_bf16 v[68:71], v[124:127], a[236:239], v[68:71]
    v_rcp_f32 v251, v251
    s_waitcnt vmcnt(11)
    v_mfma_f32_16x16x32_bf16 v[56:59], v[128:131], a[48:51], v[56:59]
    buffer_load_dwordx4 v[112:115], v7, s[20:23], s72 offen offset:0 sc1
    v_mfma_f32_16x16x32_bf16 v[56:59], v[132:135], a[52:55], v[56:59]
    v_mul_f32 v244, v244, v248
    v_mul_f32 v245, v245, v249
    v_mfma_f32_16x16x32_bf16 v[60:63], v[128:131], a[112:115], v[60:63]
    v_mul_f32 v246, v246, v250
    v_mfma_f32_16x16x32_bf16 v[60:63], v[132:135], a[116:119], v[60:63]
    v_mul_f32 v247, v247, v251
    v_mfma_f32_16x16x32_bf16 v[64:67], v[128:131], a[176:179], v[64:67]
    buffer_load_dwordx4 v[116:119], v7, s[20:23], s72 offen offset:1024 sc1
    v_mfma_f32_16x16x32_bf16 v[64:67], v[132:135], a[180:183], v[64:67]
    v_mfma_f32_16x16x32_bf16 v[68:71], v[128:131], a[240:243], v[68:71]
    v_mfma_f32_16x16x32_bf16 v[68:71], v[132:135], a[244:247], v[68:71]
    s_waitcnt vmcnt(10)
    v_mfma_f32_16x16x32_bf16 v[56:59], v[136:139], a[56:59], v[56:59]
    buffer_load_dwordx4 v[120:123], v7, s[20:23], s72 offen offset:2048 sc1
    v_mfma_f32_16x16x32_bf16 v[56:59], v[140:143], a[60:63], v[56:59]
    v_mfma_f32_16x16x32_bf16 v[60:63], v[136:139], a[120:123], v[60:63]
    v_mfma_f32_16x16x32_bf16 v[60:63], v[140:143], a[124:127], v[60:63]
    v_mfma_f32_16x16x32_bf16 v[64:67], v[136:139], a[184:187], v[64:67]
    buffer_load_dwordx4 v[124:127], v7, s[20:23], s72 offen offset:3072 sc1
    v_mfma_f32_16x16x32_bf16 v[64:67], v[140:143], a[188:191], v[64:67]
    v_mfma_f32_16x16x32_bf16 v[68:71], v[136:139], a[248:251], v[68:71]
    v_mfma_f32_16x16x32_bf16 v[68:71], v[140:143], a[252:255], v[68:71]
    s_waitcnt vmcnt(10)
    v_mfma_f32_16x16x32_bf16 v[40:43], v[80:83], a[0:3], v[12:15]
    buffer_load_dwordx4 v[128:131], v8, s[20:23], s72 offen offset:0 sc1
    v_mfma_f32_16x16x32_bf16 v[40:43], v[84:87], a[4:7], v[40:43]
    ds_read_b64 v[252:253], v24 offset:12288
    v_mfma_f32_16x16x32_bf16 v[44:47], v[80:83], a[64:67], 0
    s_add_u32 s74, s75, s70
    buffer_load_dwordx4 v[160:163], v4, s[20:23], s74 offen offset:0 sc1
    v_mfma_f32_16x16x32_bf16 v[44:47], v[84:87], a[68:71], v[44:47]
    s_waitcnt lgkmcnt(0)
    v_mfma_f32_16x16x32_bf16 v[48:51], v[80:83], a[128:131], 0
    buffer_load_dwordx4 v[132:135], v8, s[20:23], s72 offen offset:1024 sc1
    ds_write_b128 v21, v[60:63] offset:12288
    v_mfma_f32_16x16x32_bf16 v[48:51], v[84:87], a[132:135], v[48:51]
    ds_write_b128 v22, v[64:67] offset:12288
    ds_write_b128 v23, v[68:71] offset:12288
    v_mfma_f32_16x16x32_bf16 v[52:55], v[80:83], a[192:195], 0
    v_lshlrev_b32 v240, 16, v252
    v_mfma_f32_16x16x32_bf16 v[52:55], v[84:87], a[196:199], v[52:55]
    v_and_b32 v241, 0xffff0000, v252
    s_waitcnt vmcnt(11)
    v_mfma_f32_16x16x32_bf16 v[40:43], v[88:91], a[8:11], v[40:43]
    buffer_load_dwordx4 v[136:139], v8, s[20:23], s72 offen offset:2048 sc1
    v_mfma_f32_16x16x32_bf16 v[40:43], v[92:95], a[12:15], v[40:43]
    v_lshlrev_b32 v242, 16, v253
    v_and_b32 v243, 0xffff0000, v253
    v_mfma_f32_16x16x32_bf16 v[44:47], v[88:91], a[72:75], v[44:47]
    s_add_u32 s74, s75, s71
    buffer_load_dwordx4 v[164:167], v4, s[20:23], s74 offen offset:0 sc1
    v_mul_f32 v248, v240, v240
    v_mfma_f32_16x16x32_bf16 v[44:47], v[92:95], a[76:79], v[44:47]
    v_mul_f32 v249, v241, v241
    v_mul_f32 v250, v242, v242
    v_mfma_f32_16x16x32_bf16 v[48:51], v[88:91], a[136:139], v[48:51]
L_stub5:
    s_cbranch_execz L_ret5
    buffer_load_dwordx4 v[140:143], v8, s[20:23], s72 offen offset:3072 sc1
    s_waitcnt lgkmcnt(0)
    v_mfma_f32_16x16x32_bf16 v[48:51], v[92:95], a[140:143], v[48:51]
    s_barrier
    v_mul_f32 v251, v243, v243
    v_mfma_f32_16x16x32_bf16 v[52:55], v[88:91], a[200:203], v[52:55]
    v_fmaak_f32 v248, v38, v248, 0xc0135761
    v_mfma_f32_16x16x32_bf16 v[52:55], v[92:95], a[204:207], v[52:55]
    v_fmaak_f32 v249, v38, v249, 0xc0135761
    s_waitcnt vmcnt(12)
    v_mfma_f32_16x16x32_bf16 v[40:43], v[96:99], a[16:19], v[40:43]
    s_add_u32 s72, s72, 0x10000
    buffer_load_dwordx4 v[80:83], v4, s[20:23], s72 offen offset:0 sc1
    v_mfma_f32_16x16x32_bf16 v[40:43], v[100:103], a[20:23], v[40:43]
    ds_read_b128 v[72:75], v20 offset:12288
    ds_read_b128 v[76:79], v20 offset:13312
    v_mfma_f32_16x16x32_bf16 v[44:47], v[96:99], a[80:83], v[44:47]
    ds_read_b128 v[32:35], v20 offset:14336
    v_mfma_f32_16x16x32_bf16 v[44:47], v[100:103], a[84:87], v[44:47]
    v_fmaak_f32 v250, v38, v250, 0xc0135761
    v_fmaak_f32 v251, v38, v251, 0xc0135761
    v_mfma_f32_16x16x32_bf16 v[48:51], v[96:99], a[144:147], v[48:51]
    buffer_load_dwordx4 v[84:87], v4, s[20:23], s72 offen offset:1024 sc1
    v_mul_f32 v248, v248, v240
    v_mfma_f32_16x16x32_bf16 v[48:51], v[100:103], a[148:151], v[48:51]
    v_mul_f32 v249, v249, v241
    v_mul_f32 v250, v250, v242
    v_mfma_f32_16x16x32_bf16 v[52:55], v[96:99], a[208:211], v[52:55]
    v_mul_f32 v251, v251, v243
    v_mfma_f32_16x16x32_bf16 v[52:55], v[100:103], a[212:215], v[52:55]
    v_exp_f32 v248, v248
    s_waitcnt vmcnt(12)
    v_mfma_f32_16x16x32_bf16 v[40:43], v[104:107], a[24:27], v[40:43]
    buffer_load_dwordx4 v[88:91], v4, s[20:23], s72 offen offset:2048 sc1
    v_mfma_f32_16x16x32_bf16 v[40:43], v[108:111], a[28:31], v[40:43]
    s_waitcnt lgkmcnt(0)
    v_add_f32 v72, v72, v76
    v_mfma_f32_16x16x32_bf16 v[44:47], v[104:107], a[88:91], v[44:47]
    v_add_f32 v73, v73, v77
    v_mfma_f32_16x16x32_bf16 v[44:47], v[108:111], a[92:95], v[44:47]
    v_add_f32 v74, v74, v78
    v_add_f32 v75, v75, v79
    v_mfma_f32_16x16x32_bf16 v[48:51], v[104:107], a[152:155], v[48:51]
    buffer_load_dwordx4 v[92:95], v4, s[20:23], s72 offen offset:3072 sc1
    v_add_f32 v32, v32, v56
    v_mfma_f32_16x16x32_bf16 v[48:51], v[108:111], a[156:159], v[48:51]
    v_add_f32 v33, v33, v57
    v_add_f32 v34, v34, v58
    v_mfma_f32_16x16x32_bf16 v[52:55], v[104:107], a[216:219], v[52:55]
    v_add_f32 v35, v35, v59
    v_mfma_f32_16x16x32_bf16 v[52:55], v[108:111], a[220:223], v[52:55]
    v_add_f32 v72, v72, v32
    s_waitcnt vmcnt(12)
    v_mfma_f32_16x16x32_bf16 v[40:43], v[112:115], a[32:35], v[40:43]
    buffer_load_dwordx4 v[96:99], v6, s[20:23], s72 offen offset:0 sc1
    v_mfma_f32_16x16x32_bf16 v[40:43], v[116:119], a[36:39], v[40:43]
    v_add_f32 v73, v73, v33
    v_add_f32 v74, v74, v34
    v_mfma_f32_16x16x32_bf16 v[44:47], v[112:115], a[96:99], v[44:47]
    v_add_f32 v75, v75, v35
    v_mfma_f32_16x16x32_bf16 v[44:47], v[116:119], a[100:103], v[44:47]
    v_mul_f32 v72, v72, v244
    v_mul_f32 v73, v73, v245
    v_mfma_f32_16x16x32_bf16 v[48:51], v[112:115], a[160:163], v[48:51]
    buffer_load_dwordx4 v[100:103], v6, s[20:23], s72 offen offset:1024 sc1
    v_mul_f32 v74, v74, v246
    v_mfma_f32_16x16x32_bf16 v[48:51], v[116:119], a[164:167], v[48:51]
    v_mul_f32 v75, v75, v247
    v_cvt_pk_bf16_f32 v30, v72, v73
    v_mfma_f32_16x16x32_bf16 v[52:55], v[112:115], a[224:227], v[52:55]
    v_cvt_pk_bf16_f32 v31, v74, v75
    v_mfma_f32_16x16x32_bf16 v[52:55], v[116:119], a[228:231], v[52:55]
    buffer_store_dwordx4 v[28:31], v4, s[20:23], s73 offen offset:2048 sc1
    s_waitcnt vmcnt(13)
    v_mfma_f32_16x16x32_bf16 v[40:43], v[120:123], a[40:43], v[40:43]
    buffer_load_dwordx4 v[104:107], v6, s[20:23], s72 offen offset:2048 sc1
    v_mfma_f32_16x16x32_bf16 v[40:43], v[124:127], a[44:47], v[40:43]
    s_cmp_lg_u32 s30, 0
    s_cbranch_scc1 L_flg19
    s_lshl_b32 s79, s28, 3
    s_add_u32 s79, s79, s29
    s_lshl_b32 s79, s79, 7
    s_add_u32 s79, s79, 14712832
    v_mov_b32 v18, s31
    s_mov_b64 exec, 1
    buffer_store_dword v18, v5, s[20:23], s79 offen sc1
    s_mov_b64 exec, -1
L_flg19:
    v_exp_f32 v249, v249
    v_mfma_f32_16x16x32_bf16 v[44:47], v[120:123], a[104:107], v[44:47]
    v_exp_f32 v250, v250
    v_mfma_f32_16x16x32_bf16 v[44:47], v[124:127], a[108:111], v[44:47]
    v_exp_f32 v251, v251
    v_add_f32 v248, 1.0, v248
    v_mfma_f32_16x16x32_bf16 v[48:51], v[120:123], a[168:171], v[48:51]
    buffer_load_dwordx4 v[108:111], v6, s[20:23], s72 offen offset:3072 sc1
    v_add_f32 v249, 1.0, v249
    v_mfma_f32_16x16x32_bf16 v[48:51], v[124:127], a[172:175], v[48:51]
    v_add_f32 v250, 1.0, v250
    v_add_f32 v251, 1.0, v251
    v_mfma_f32_16x16x32_bf16 v[52:55], v[120:123], a[232:235], v[52:55]
    v_rcp_f32 v248, v248
    v_mfma_f32_16x16x32_bf16 v[52:55], v[124:127], a[236:239], v[52:55]
    v_rcp_f32 v249, v249
    s_waitcnt vmcnt(12)
    v_mfma_f32_16x16x32_bf16 v[40:43], v[128:131], a[48:51], v[40:43]
    buffer_load_dwordx4 v[112:115], v7, s[20:23], s72 offen offset:0 sc1
    v_mfma_f32_16x16x32_bf16 v[40:43], v[132:135], a[52:55], v[40:43]
    v_rcp_f32 v250, v250
    v_rcp_f32 v251, v251
    v_mfma_f32_16x16x32_bf16 v[44:47], v[128:131], a[112:115], v[44:47]
    v_mul_f32 v240, v240, v248
    v_mfma_f32_16x16x32_bf16 v[44:47], v[132:135], a[116:119], v[44:47]
    v_mul_f32 v241, v241, v249
    v_mul_f32 v242, v242, v250
    v_mfma_f32_16x16x32_bf16 v[48:51], v[128:131], a[176:179], v[48:51]
    buffer_load_dwordx4 v[116:119], v7, s[20:23], s72 offen offset:1024 sc1
    v_mul_f32 v243, v243, v251
    v_mfma_f32_16x16x32_bf16 v[48:51], v[132:135], a[180:183], v[48:51]
    v_mfma_f32_16x16x32_bf16 v[52:55], v[128:131], a[240:243], v[52:55]
    v_mfma_f32_16x16x32_bf16 v[52:55], v[132:135], a[244:247], v[52:55]
    s_waitcnt vmcnt(11)
    v_mfma_f32_16x16x32_bf16 v[40:43], v[136:139], a[56:59], v[40:43]
    buffer_load_dwordx4 v[120:123], v7, s[20:23], s72 offen offset:2048 sc1
    v_mfma_f32_16x16x32_bf16 v[40:43], v[140:143], a[60:63], v[40:43]
    v_mfma_f32_16x16x32_bf16 v[44:47], v[136:139], a[120:123], v[44:47]
    v_mfma_f32_16x16x32_bf16 v[44:47], v[140:143], a[124:127], v[44:47]
    v_mfma_f32_16x16x32_bf16 v[48:51], v[136:139], a[184:187], v[48:51]
    buffer_load_dwordx4 v[124:127], v7, s[20:23], s72 offen offset:3072 sc1
    v_mfma_f32_16x16x32_bf16 v[48:51], v[140:143], a[188:191], v[48:51]
    v_mfma_f32_16x16x32_bf16 v[52:55], v[136:139], a[248:251], v[52:55]
    v_mfma_f32_16x16x32_bf16 v[52:55], v[140:143], a[252:255], v[52:55]
    s_waitcnt vmcnt(11)
    v_mfma_f32_16x16x32_bf16 v[56:59], v[80:83], a[0:3], v[12:15]
    buffer_load_dwordx4 v[128:131], v8, s[20:23], s72 offen offset:0 sc1
    v_mfma_f32_16x16x32_bf16 v[56:59], v[84:87], a[4:7], v[56:59]
    ds_read_b64 v[252:253], v24 offset:14336
    v_mfma_f32_16x16x32_bf16 v[60:63], v[80:83], a[64:67], 0
    v_mfma_f32_16x16x32_bf16 v[60:63], v[84:87], a[68:71], v[60:63]
    s_waitcnt lgkmcnt(0)
    v_mfma_f32_16x16x32_bf16 v[64:67], v[80:83], a[128:131], 0
    buffer_load_dwordx4 v[132:135], v8, s[20:23], s72 offen offset:1024 sc1
    ds_write_b128 v21, v[44:47] offset:0
    v_mfma_f32_16x16x32_bf16 v[64:67], v[84:87], a[132:135], v[64:67]
    ds_write_b128 v22, v[48:51] offset:0
    ds_write_b128 v23, v[52:55] offset:0
    v_mfma_f32_16x16x32_bf16 v[68:71], v[80:83], a[192:195], 0
    v_lshlrev_b32 v244, 16, v252
    v_mfma_f32_16x16x32_bf16 v[68:71], v[84:87], a[196:199], v[68:71]
    v_and_b32 v245, 0xffff0000, v252
    s_waitcnt vmcnt(11)
    v_mfma_f32_16x16x32_bf16 v[56:59], v[88:91], a[8:11], v[56:59]
    buffer_load_dwordx4 v[136:139], v8, s[20:23], s72 offen offset:2048 sc1
    v_mfma_f32_16x16x32_bf16 v[56:59], v[92:95], a[12:15], v[56:59]
    v_lshlrev_b32 v246, 16, v253
    v_and_b32 v247, 0xffff0000, v253
    v_mfma_f32_16x16x32_bf16 v[60:63], v[88:91], a[72:75], v[60:63]
    v_mul_f32 v248, v244, v244
    v_mfma_f32_16x16x32_bf16 v[60:63], v[92:95], a[76:79], v[60:63]
    v_mul_f32 v249, v245, v245
    v_mul_f32 v250, v246, v246
    v_mfma_f32_16x16x32_bf16 v[64:67], v[88:91], a[136:139], v[64:67]
    buffer_load_dwordx4 v[140:143], v8, s[20:23], s72 offen offset:3072 sc1
    s_waitcnt lgkmcnt(0)
    v_mfma_f32_16x16x32_bf16 v[64:67], v[92:95], a[140:143], v[64:67]
    s_barrier
    v_mul_f32 v251, v247, v247
    v_mfma_f32_16x16x32_bf16 v[68:71], v[88:91], a[200:203], v[68:71]
    v_fmaak_f32 v248, v38, v248, 0xc0135761
    v_mfma_f32_16x16x32_bf16 v[68:71], v[92:95], a[204:207], v[68:71]
    v_fmaak_f32 v249, v38, v249, 0xc0135761
    s_waitcnt vmcnt(11)
    v_mfma_f32_16x16x32_bf16 v[56:59], v[96:99], a[16:19], v[56:59]
    s_add_u32 s74, s75, s76
    buffer_load_dwordx4 v[168:171], v4, s[20:23], s74 offen offset:0 sc1
    v_mfma_f32_16x16x32_bf16 v[56:59], v[100:103], a[20:23], v[56:59]
    ds_read_b128 v[72:75], v20 offset:0
    ds_read_b128 v[76:79], v20 offset:1024
    v_mfma_f32_16x16x32_bf16 v[60:63], v[96:99], a[80:83], v[60:63]
    ds_read_b128 v[32:35], v20 offset:2048
    v_mfma_f32_16x16x32_bf16 v[60:63], v[100:103], a[84:87], v[60:63]
    v_fmaak_f32 v250, v38, v250, 0xc0135761
    v_fmaak_f32 v251, v38, v251, 0xc0135761
    v_mfma_f32_16x16x32_bf16 v[64:67], v[96:99], a[144:147], v[64:67]
    s_add_u32 s74, s75, s92
    buffer_load_dwordx4 v[172:175], v4, s[20:23], s74 offen offset:1024 sc1
    v_mul_f32 v248, v248, v244
    v_mfma_f32_16x16x32_bf16 v[64:67], v[100:103], a[148:151], v[64:67]
    v_mul_f32 v249, v249, v245
    v_mul_f32 v250, v250, v246
    v_mfma_f32_16x16x32_bf16 v[68:71], v[96:99], a[208:211], v[68:71]
    v_mul_f32 v251, v251, v247
    v_mfma_f32_16x16x32_bf16 v[68:71], v[100:103], a[212:215], v[68:71]
    v_exp_f32 v248, v248
    s_waitcnt vmcnt(10)
    v_mfma_f32_16x16x32_bf16 v[56:59], v[104:107], a[24:27], v[56:59]
    s_add_u32 s74, s75, s93
    buffer_load_dwordx4 v[176:179], v4, s[20:23], s74 offen offset:1024 sc1
    v_mfma_f32_16x16x32_bf16 v[56:59], v[108:111], a[28:31], v[56:59]
    s_waitcnt lgkmcnt(0)
    v_add_f32 v72, v72, v76
    v_mfma_f32_16x16x32_bf16 v[60:63], v[104:107], a[88:91], v[60:63]
    v_add_f32 v73, v73, v77
    v_mfma_f32_16x16x32_bf16 v[60:63], v[108:111], a[92:95], v[60:63]
    v_add_f32 v74, v74, v78
    v_add_f32 v75, v75, v79
    v_mfma_f32_16x16x32_bf16 v[64:67], v[104:107], a[152:155], v[64:67]
    s_add_u32 s74, s75, s96
    buffer_load_dwordx4 v[180:183], v4, s[20:23], s74 offen offset:1024 sc1
    v_add_f32 v32, v32, v40
    v_mfma_f32_16x16x32_bf16 v[64:67], v[108:111], a[156:159], v[64:67]
    v_add_f32 v33, v33, v41
    v_add_f32 v34, v34, v42
    v_mfma_f32_16x16x32_bf16 v[68:71], v[104:107], a[216:219], v[68:71]
    v_add_f32 v35, v35, v43
    v_mfma_f32_16x16x32_bf16 v[68:71], v[108:111], a[220:223], v[68:71]
    v_add_f32 v72, v72, v32
    s_waitcnt vmcnt(10)
    v_mfma_f32_16x16x32_bf16 v[56:59], v[112:115], a[32:35], v[56:59]
    s_add_u32 s74, s75, s97
    buffer_load_dwordx4 v[184:187], v4, s[20:23], s74 offen offset:1024 sc1
    v_mfma_f32_16x16x32_bf16 v[56:59], v[116:119], a[36:39], v[56:59]
    v_add_f32 v73, v73, v33
    v_add_f32 v74, v74, v34
    v_mfma_f32_16x16x32_bf16 v[60:63], v[112:115], a[96:99], v[60:63]
    v_add_f32 v75, v75, v35
    v_mfma_f32_16x16x32_bf16 v[60:63], v[116:119], a[100:103], v[60:63]
    v_mul_f32 v72, v72, v240
    v_mul_f32 v73, v73, v241
    v_mfma_f32_16x16x32_bf16 v[64:67], v[112:115], a[160:163], v[64:67]
    s_add_u32 s74, s75, s70
    buffer_load_dwordx4 v[188:191], v4, s[20:23], s74 offen offset:1024 sc1
    v_mul_f32 v74, v74, v242
    v_mfma_f32_16x16x32_bf16 v[64:67], v[116:119], a[164:167], v[64:67]
    v_mul_f32 v75, v75, v243
    v_cvt_pk_bf16_f32 v28, v72, v73
    v_mfma_f32_16x16x32_bf16 v[68:71], v[112:115], a[224:227], v[68:71]
    v_cvt_pk_bf16_f32 v29, v74, v75
    v_mfma_f32_16x16x32_bf16 v[68:71], v[116:119], a[228:231], v[68:71]
    v_exp_f32 v249, v249
    s_waitcnt vmcnt(10)
    v_mfma_f32_16x16x32_bf16 v[56:59], v[120:123], a[40:43], v[56:59]
    s_add_u32 s74, s75, s71
    buffer_load_dwordx4 v[192:195], v4, s[20:23], s74 offen offset:1024 sc1
    v_mfma_f32_16x16x32_bf16 v[56:59], v[124:127], a[44:47], v[56:59]
    v_exp_f32 v250, v250
    v_exp_f32 v251, v251
    v_mfma_f32_16x16x32_bf16 v[60:63], v[120:123], a[104:107], v[60:63]
    v_add_f32 v248, 1.0, v248
    v_mfma_f32_16x16x32_bf16 v[60:63], v[124:127], a[108:111], v[60:63]
    v_add_f32 v249, 1.0, v249
    v_add_f32 v250, 1.0, v250
    v_mfma_f32_16x16x32_bf16 v[64:67], v[120:123], a[168:171], v[64:67]
    s_add_u32 s74, s75, s76
    buffer_load_dwordx4 v[196:199], v4, s[20:23], s74 offen offset:1024 sc1
    v_add_f32 v251, 1.0, v251
    v_mfma_f32_16x16x32_bf16 v[64:67], v[124:127], a[172:175], v[64:67]
    v_rcp_f32 v248, v248
    v_rcp_f32 v249, v249
    v_mfma_f32_16x16x32_bf16 v[68:71], v[120:123], a[232:235], v[68:71]
    v_rcp_f32 v250, v250
    v_mfma_f32_16x16x32_bf16 v[68:71], v[124:127], a[236:239], v[68:71]
    v_rcp_f32 v251, v251
    s_waitcnt vmcnt(10)
    v_mfma_f32_16x16x32_bf16 v[56:59], v[128:131], a[48:51], v[56:59]
    s_add_u32 s74, s75, s92
    buffer_load_dwordx4 v[200:203], v4, s[20:23], s74 offen offset:2048 sc1
    v_mfma_f32_16x16x32_bf16 v[56:59], v[132:135], a[52:55], v[56:59]
    v_mul_f32 v244, v244, v248
    v_mul_f32 v245, v245, v249
    v_mfma_f32_16x16x32_bf16 v[60:63], v[128:131], a[112:115], v[60:63]
    v_mul_f32 v246, v246, v250
    v_mfma_f32_16x16x32_bf16 v[60:63], v[132:135], a[116:119], v[60:63]
    v_mul_f32 v247, v247, v251
    v_mfma_f32_16x16x32_bf16 v[64:67], v[128:131], a[176:179], v[64:67]
    s_add_u32 s74, s75, s93
    buffer_load_dwordx4 v[204:207], v4, s[20:23], s74 offen offset:2048 sc1
    v_mfma_f32_16x16x32_bf16 v[64:67], v[132:135], a[180:183], v[64:67]
    v_mfma_f32_16x16x32_bf16 v[68:71], v[128:131], a[240:243], v[68:71]
    v_mfma_f32_16x16x32_bf16 v[68:71], v[132:135], a[244:247], v[68:71]
    s_waitcnt vmcnt(10)
    v_mfma_f32_16x16x32_bf16 v[56:59], v[136:139], a[56:59], v[56:59]
    s_add_u32 s74, s75, s96
    buffer_load_dwordx4 v[208:211], v4, s[20:23], s74 offen offset:2048 sc1
    v_mfma_f32_16x16x32_bf16 v[56:59], v[140:143], a[60:63], v[56:59]
    v_mfma_f32_16x16x32_bf16 v[60:63], v[136:139], a[120:123], v[60:63]
    v_mfma_f32_16x16x32_bf16 v[60:63], v[140:143], a[124:127], v[60:63]
    v_mfma_f32_16x16x32_bf16 v[64:67], v[136:139], a[184:187], v[64:67]
    s_add_u32 s74, s75, s97
    buffer_load_dwordx4 v[212:215], v4, s[20:23], s74 offen offset:2048 sc1
    v_mfma_f32_16x16x32_bf16 v[64:67], v[140:143], a[188:191], v[64:67]
    v_mfma_f32_16x16x32_bf16 v[68:71], v[136:139], a[248:251], v[68:71]
    v_mfma_f32_16x16x32_bf16 v[68:71], v[140:143], a[252:255], v[68:71]
    s_nop 1
    ds_write_b128 v21, v[60:63] offset:12288
    s_nop 2
    ds_write_b128 v22, v[64:67] offset:12288
    s_nop 0
    ds_write_b128 v23, v[68:71] offset:12288
    buffer_load_dword v25, v16, s[20:23], 0 offen sc1
    s_add_u32 s74, s75, s70
    buffer_load_dwordx4 v[216:219], v4, s[20:23], s74 offen offset:2048 sc1
    s_add_u32 s74, s75, s71
    buffer_load_dwordx4 v[220:223], v4, s[20:23], s74 offen offset:2048 sc1
    s_add_u32 s74, s75, s76
    buffer_load_dwordx4 v[224:227], v4, s[20:23], s74 offen offset:2048 sc1
    s_waitcnt lgkmcnt(0)
    s_barrier
    ds_read_b128 v[72:75], v20 offset:12288
    ds_read_b128 v[76:79], v20 offset:13312
    ds_read_b128 v[32:35], v20 offset:14336
    s_cmp_lg_u32 s30, 0
    s_cbranch_scc1 L_flg20
    s_lshl_b32 s79, s28, 3
    s_add_u32 s79, s79, s29
    s_lshl_b32 s79, s79, 7
    s_add_u32 s79, s79, 14811136
    v_mov_b32 v18, s31
    s_mov_b64 exec, 1
    buffer_store_dword v18, v5, s[20:23], s79 offen sc1
    s_mov_b64 exec, -1
L_flg20:
    s_add_u32 s74, s75, s92
    buffer_load_dwordx4 v[228:231], v4, s[20:23], s74 offen offset:3072 sc1
    s_add_u32 s74, s75, s93
    buffer_load_dwordx4 v[232:235], v4, s[20:23], s74 offen offset:3072 sc1
    s_add_u32 s74, s75, s96
    buffer_load_dwordx4 v[236:239], v4, s[20:23], s74 offen offset:3072 sc1
    s_waitcnt lgkmcnt(0)
    v_add_f32 v72, v72, v76
    v_add_f32 v73, v73, v77
    v_add_f32 v74, v74, v78
    v_add_f32 v75, v75, v79
    v_add_f32 v32, v32, v56
    v_add_f32 v33, v33, v57
    v_add_f32 v34, v34, v58
    v_add_f32 v35, v35, v59
    v_add_f32 v72, v72, v32
    v_add_f32 v73, v73, v33
    v_add_f32 v74, v74, v34
    v_add_f32 v75, v75, v35
    v_mul_f32 v72, v72, v244
    v_mul_f32 v73, v73, v245
    v_mul_f32 v74, v74, v246
    v_mul_f32 v75, v75, v247
    v_cvt_pk_bf16_f32 v30, v72, v73
    v_cvt_pk_bf16_f32 v31, v74, v75
    buffer_store_dwordx4 v[28:31], v4, s[20:23], s73 offen offset:3072 sc1
    v_add_u32 v6, 49152, v4
    v_add_u32 v7, 106496, v4
    v_mov_b32 v120, 0
    v_mov_b32 v121, 0
    v_mov_b32 v124, 0
    v_mov_b32 v125, 0
    v_mov_b32 v126, 0
    v_mov_b32 v127, 0
    v_mov_b32 v130, 0
    v_mov_b32 v131, 0
    v_mov_b32 v132, 0
    v_mov_b32 v133, 0
    v_mov_b32 v136, 0
    v_mov_b32 v137, 0
    v_mov_b32 v138, 0
    v_mov_b32 v139, 0
    v_mov_b32 v142, 0
    v_mov_b32 v143, 0
    s_add_u32 s88, s81, 98304
    s_add_u32 s89, s81, 131072
    s_waitcnt vmcnt(7)
    v_cmp_ne_u32 vcc, s31, v25
    s_nop 0
    s_cmp_eq_u64 vcc, 0
    s_cbranch_scc0 L_slow21
    s_add_u32 m0, s87, 0
    s_add_u32 s74, s82, s92
    buffer_load_dwordx4 v4, s[20:23], s74 offen offset:0 sc1 lds
    s_add_u32 m0, s87, 4096
    s_add_u32 s74, s82, s93
    buffer_load_dwordx4 v4, s[20:23], s74 offen offset:0 sc1 lds
    s_add_u32 m0, s87, 8192
    s_add_u32 s74, s82, s96
    buffer_load_dwordx4 v4, s[20:23], s74 offen offset:0 sc1 lds
    s_add_u32 m0, s87, 12288
    s_add_u32 s74, s82, s97
    buffer_load_dwordx4 v4, s[20:23], s74 offen offset:0 sc1 lds
    s_add_u32 m0, s87, 16384
    s_add_u32 s74, s82, s70
    buffer_load_dwordx4 v4, s[20:23], s74 offen offset:0 sc1 lds
    s_add_u32 m0, s87, 20480
    s_add_u32 s74, s82, s71
    buffer_load_dwordx4 v4, s[20:23], s74 offen offset:0 sc1 lds
    s_add_u32 m0, s87, 24576
    s_add_u32 s74, s82, s76
    buffer_load_dwordx4 v4, s[20:23], s74 offen offset:0 sc1 lds
    s_add_u32 m0, s87, 27648
    s_add_u32 s74, s82, s92
    buffer_load_dwordx4 v4, s[20:23], s74 offen offset:1024 sc1 lds
    s_add_u32 m0, s87, 31744
    s_add_u32 s74, s82, s93
    buffer_load_dwordx4 v4, s[20:23], s74 offen offset:1024 sc1 lds
    s_add_u32 m0, s87, 35840
    s_add_u32 s74, s82, s96
    buffer_load_dwordx4 v4, s[20:23], s74 offen offset:1024 sc1 lds
    s_add_u32 m0, s87, 39936
    s_add_u32 s74, s82, s97
    buffer_load_dwordx4 v4, s[20:23], s74 offen offset:1024 sc1 lds
    s_waitcnt vmcnt(11)
    buffer_load_dword v25, v9, s[20:23], s88 offen sc1
    s_barrier
    s_add_u32 m0, s87, 44032
    s_add_u32 s74, s82, s70
    buffer_load_dwordx4 v4, s[20:23], s74 offen offset:1024 sc1 lds
    s_add_u32 m0, s87, 48128
    s_add_u32 s74, s82, s71
    buffer_load_dwordx4 v4, s[20:23], s74 offen offset:1024 sc1 lds
    s_add_u32 m0, s87, 52224
    s_add_u32 s74, s82, s76
    buffer_load_dwordx4 v4, s[20:23], s74 offen offset:1024 sc1 lds
    s_cmp_lg_u32 s30, 0
    s_cbranch_scc1 L_flg23
    s_lshl_b32 s79, s28, 3
    s_add_u32 s79, s79, s29
    s_lshl_b32 s79, s79, 7
    s_add_u32 s79, s79, 14843904
    v_mov_b32 v18, s31
    s_mov_b64 exec, 1
    buffer_store_dword v18, v5, s[20:23], s79 offen sc1
    s_mov_b64 exec, -1
L_flg23:
    s_branch L_join22
L_slow21:
    s_waitcnt vmcnt(0)
    s_barrier
    s_cmp_lg_u32 s30, 0
    s_cbranch_scc1 L_flg24
    s_lshl_b32 s79, s28, 3
    s_add_u32 s79, s79, s29
    s_lshl_b32 s79, s79, 7
    s_add_u32 s79, s79, 14843904
    v_mov_b32 v18, s31
    s_mov_b64 exec, 1
    buffer_store_dword v18, v5, s[20:23], s79 offen sc1
    s_mov_b64 exec, -1
L_flg24:
    s_mov_b32 s33, 0
L_poll25:
    buffer_load_dword v25, v16, s[20:23], 0 offen sc1
    s_add_u32 s33, s33, 1
    s_waitcnt vmcnt(0)
    v_cmp_ne_u32 vcc, s31, v25
    s_nop 0
    s_cmp_eq_u64 vcc, 0
    s_cbranch_scc1 L_polld26
    s_cmp_lt_u32 s33, 4000000
    s_cbranch_scc1 L_poll25
L_polld26:
    s_add_u32 m0, s87, 0
    s_add_u32 s74, s82, s92
    buffer_load_dwordx4 v4, s[20:23], s74 offen offset:0 sc1 lds
    s_add_u32 m0, s87, 4096
    s_add_u32 s74, s82, s93
    buffer_load_dwordx4 v4, s[20:23], s74 offen offset:0 sc1 lds
    s_add_u32 m0, s87, 8192
    s_add_u32 s74, s82, s96
    buffer_load_dwordx4 v4, s[20:23], s74 offen offset:0 sc1 lds
    s_add_u32 m0, s87, 12288
    s_add_u32 s74, s82, s97
    buffer_load_dwordx4 v4, s[20:23], s74 offen offset:0 sc1 lds
    s_add_u32 m0, s87, 16384
    s_add_u32 s74, s82, s70
    buffer_load_dwordx4 v4, s[20:23], s74 offen offset:0 sc1 lds
    s_add_u32 m0, s87, 20480
    s_add_u32 s74, s82, s71
    buffer_load_dwordx4 v4, s[20:23], s74 offen offset:0 sc1 lds
    s_add_u32 m0, s87, 24576
    s_add_u32 s74, s82, s76
    buffer_load_dwordx4 v4, s[20:23], s74 offen offset:0 sc1 lds
    s_add_u32 m0, s87, 27648
    s_add_u32 s74, s82, s92
    buffer_load_dwordx4 v4, s[20:23], s74 offen offset:1024 sc1 lds
    s_add_u32 m0, s87, 31744
    s_add_u32 s74, s82, s93
    buffer_load_dwordx4 v4, s[20:23], s74 offen offset:1024 sc1 lds
    s_add_u32 m0, s87, 35840
    s_add_u32 s74, s82, s96
    buffer_load_dwordx4 v4, s[20:23], s74 offen offset:1024 sc1 lds
    s_add_u32 m0, s87, 39936
    s_add_u32 s74, s82, s97
    buffer_load_dwordx4 v4, s[20:23], s74 offen offset:1024 sc1 lds
    buffer_load_dword v25, v9, s[20:23], s88 offen sc1
    s_add_u32 m0, s87, 44032
    s_add_u32 s74, s82, s70
    buffer_load_dwordx4 v4, s[20:23], s74 offen offset:1024 sc1 lds
    s_add_u32 m0, s87, 48128
    s_add_u32 s74, s82, s71
    buffer_load_dwordx4 v4, s[20:23], s74 offen offset:1024 sc1 lds
    s_add_u32 m0, s87, 52224
    s_add_u32 s74, s82, s76
    buffer_load_dwordx4 v4, s[20:23], s74 offen offset:1024 sc1 lds
L_join22:
    s_waitcnt vmcnt(8)
    s_barrier
    ds_read_b128 v[80:83], v6 offset:0
    ds_read_b128 v[84:87], v6 offset:4096
    ds_read_b128 v[88:91], v6 offset:1024
    ds_read_b128 v[92:95], v6 offset:5120
    ds_read_b128 v[96:99], v6 offset:2048
    ds_read_b128 v[100:103], v6 offset:6144
    s_waitcnt lgkmcnt(4)
    v_mfma_f32_16x16x32_bf16 v[40:43], v[144:147], v[80:83], 0
    ds_read_b128 v[104:107], v6 offset:3072
    v_mfma_f32_16x16x32_bf16 v[40:43], v[148:151], v[84:87], v[40:43]
    ds_read_b128 v[108:111], v6 offset:7168
    s_add_u32 s74, s75, s97
    buffer_load_dwordx4 v[240:243], v4, s[20:23], s74 offen offset:3072 sc1
    s_waitcnt lgkmcnt(4)
    v_mfma_f32_16x16x32_bf16 v[44:47], v[144:147], v[88:91], 0
    ds_read_b128 v[80:83], v6 offset:8192
    v_mfma_f32_16x16x32_bf16 v[44:47], v[148:151], v[92:95], v[44:47]
    ds_read_b128 v[84:87], v6 offset:12288
    s_add_u32 s74, s75, s70
    buffer_load_dwordx4 v[244:247], v4, s[20:23], s74 offen offset:3072 sc1
    s_waitcnt lgkmcnt(4)
    v_mfma_f32_16x16x32_bf16 v[48:51], v[144:147], v[96:99], 0
    ds_read_b128 v[88:91], v6 offset:9216
    v_mfma_f32_16x16x32_bf16 v[48:51], v[148:151], v[100:103], v[48:51]
    ds_read_b128 v[92:95], v6 offset:13312
    s_add_u32 s74, s75, s71
    buffer_load_dwordx4 v[248:251], v4, s[20:23], s74 offen offset:3072 sc1
    s_waitcnt lgkmcnt(4)
    v_mfma_f32_16x16x32_bf16 v[52:55], v[144:147], v[104:107], 0
    ds_read_b128 v[96:99], v6 offset:10240
    v_mfma_f32_16x16x32_bf16 v[52:55], v[148:151], v[108:111], v[52:55]
    ds_read_b128 v[100:103], v6 offset:14336
    s_add_u32 s74, s75, s76
    buffer_load_dwordx4 v[252:255], v4, s[20:23], s74 offen offset:3072 sc1
    s_waitcnt lgkmcnt(4)
    v_mfma_f32_16x16x32_bf16 v[40:43], v[152:155], v[80:83], v[40:43]
    ds_read_b128 v[104:107], v6 offset:11264
    v_mfma_f32_16x16x32_bf16 v[40:43], v[156:159], v[84:87], v[40:43]
    ds_read_b128 v[108:111], v6 offset:15360
    buffer_load_dwordx4 v[56:59], v0, s[20:23], s83 offen sc1
    s_mov_b32 m0, s77
    s_add_u32 s74, s85, 31744
    buffer_load_dwordx4 v11, s[20:23], s85 offen sc1 lds
    buffer_load_dwordx4 v11, s[20:23], s74 offen offset:1024 sc1 lds
    s_waitcnt lgkmcnt(4)
    v_mfma_f32_16x16x32_bf16 v[44:47], v[152:155], v[88:91], v[44:47]
    ds_read_b128 v[80:83], v6 offset:16384
    v_mfma_f32_16x16x32_bf16 v[44:47], v[156:159], v[92:95], v[44:47]
    ds_read_b128 v[84:87], v6 offset:20480
    buffer_load_dword v29, v9, s[20:23], s89 offen sc1
    s_waitcnt lgkmcnt(4)
    v_mfma_f32_16x16x32_bf16 v[48:51], v[152:155], v[96:99], v[48:51]
    ds_read_b128 v[88:91], v6 offset:17408
    v_mfma_f32_16x16x32_bf16 v[48:51], v[156:159], v[100:103], v[48:51]
    ds_read_b128 v[92:95], v6 offset:21504
    s_waitcnt lgkmcnt(4)
    v_mfma_f32_16x16x32_bf16 v[52:55], v[152:155], v[104:107], v[52:55]
    ds_read_b128 v[96:99], v6 offset:18432
    v_mfma_f32_16x16x32_bf16 v[52:55], v[156:159], v[108:111], v[52:55]
    ds_read_b128 v[100:103], v6 offset:22528
    s_waitcnt lgkmcnt(4)
    v_mfma_f32_16x16x32_bf16 v[40:43], v[160:163], v[80:83], v[40:43]
    ds_read_b128 v[104:107], v6 offset:19456
    v_mfma_f32_16x16x32_bf16 v[40:43], v[164:167], v[84:87], v[40:43]
    ds_read_b128 v[108:111], v6 offset:23552
    s_waitcnt lgkmcnt(4)
    v_mfma_f32_16x16x32_bf16 v[44:47], v[160:163], v[88:91], v[44:47]
    ds_read_b128 v[80:83], v6 offset:24576
    v_mfma_f32_16x16x32_bf16 v[44:47], v[164:167], v[92:95], v[44:47]
    ds_read_b128 v[84:87], v6 offset:25600
    s_waitcnt lgkmcnt(4)
    v_mfma_f32_16x16x32_bf16 v[48:51], v[160:163], v[96:99], v[48:51]
    ds_read_b128 v[88:91], v6 offset:26624
    v_mfma_f32_16x16x32_bf16 v[48:51], v[164:167], v[100:103], v[48:51]
    ds_read_b128 v[92:95], v6 offset:27648
    s_waitcnt lgkmcnt(4)
    v_mfma_f32_16x16x32_bf16 v[52:55], v[160:163], v[104:107], v[52:55]
    v_mfma_f32_16x16x32_bf16 v[52:55], v[164:167], v[108:111], v[52:55]
    s_waitcnt lgkmcnt(2)
    v_mfma_f32_16x16x32_bf16 v[40:43], v[168:171], v[80:83], v[40:43]
    v_mfma_f32_16x16x32_bf16 v[44:47], v[168:171], v[84:87], v[44:47]
    s_waitcnt lgkmcnt(0)
    v_mfma_f32_16x16x32_bf16 v[48:51], v[168:171], v[88:91], v[48:51]
    v_mfma_f32_16x16x32_bf16 v[52:55], v[168:171], v[92:95], v[52:55]
    s_waitcnt vmcnt(11)
    v_cmp_ne_u32 vcc, s31, v25
    s_nop 0
    s_cmp_eq_u64 vcc, 0
    s_cbranch_scc1 L_ok27
    s_mov_b32 s33, 0
L_poll28:
    buffer_load_dword v25, v9, s[20:23], s88 offen sc1
    s_add_u32 s33, s33, 1
    s_waitcnt vmcnt(0)
    v_cmp_ne_u32 vcc, s31, v25
    s_nop 0
    s_cmp_eq_u64 vcc, 0
    s_cbranch_scc1 L_polld29
    s_cmp_lt_u32 s33, 4000000
    s_cbranch_scc1 L_poll28
L_polld29:
L_ok27:
    s_waitcnt vmcnt(8)
    s_barrier
    ds_read_b128 v[80:83], v6 offset:28672
    ds_read_b128 v[84:87], v6 offset:32768
    ds_read_b128 v[88:91], v6 offset:29696
    ds_read_b128 v[92:95], v6 offset:33792
    ds_read_b128 v[96:99], v6 offset:30720
    ds_read_b128 v[100:103], v6 offset:34816
    s_waitcnt lgkmcnt(4)
    v_mfma_f32_16x16x32_bf16 v[40:43], v[172:175], v[80:83], v[40:43]
    ds_read_b128 v[104:107], v6 offset:31744
    v_mfma_f32_16x16x32_bf16 v[40:43], v[176:179], v[84:87], v[40:43]
    ds_read_b128 v[108:111], v6 offset:35840
    s_add_u32 m0, s87, 55296
    s_add_u32 s74, s82, s92
    buffer_load_dwordx4 v4, s[20:23], s74 offen offset:2048 sc1 lds
    s_waitcnt lgkmcnt(4)
    v_mfma_f32_16x16x32_bf16 v[44:47], v[172:175], v[88:91], v[44:47]
    ds_read_b128 v[80:83], v6 offset:36864
    v_mfma_f32_16x16x32_bf16 v[44:47], v[176:179], v[92:95], v[44:47]
    ds_read_b128 v[84:87], v6 offset:40960
    s_add_u32 m0, s87, 59392
    s_add_u32 s74, s82, s93
    buffer_load_dwordx4 v4, s[20:23], s74 offen offset:2048 sc1 lds
    s_waitcnt lgkmcnt(4)
    v_mfma_f32_16x16x32_bf16 v[48:51], v[172:175], v[96:99], v[48:51]
    ds_read_b128 v[88:91], v6 offset:37888
    v_mfma_f32_16x16x32_bf16 v[48:51], v[176:179], v[100:103], v[48:51]
    ds_read_b128 v[92:95], v6 offset:41984
    s_add_u32 m0, s87, 63488
    s_add_u32 s74, s82, s96
    buffer_load_dwordx4 v4, s[20:23], s74 offen offset:2048 sc1 lds
    s_waitcnt lgkmcnt(4)
    v_mfma_f32_16x16x32_bf16 v[52:55], v[172:175], v[104:107], v[52:55]
    ds_read_b128 v[96:99], v6 offset:38912
    v_mfma_f32_16x16x32_bf16 v[52:55], v[176:179], v[108:111], v[52:55]
    ds_read_b128 v[100:103], v6 offset:43008
    s_add_u32 m0, s87, 67584
    s_add_u32 s74, s82, s97
    buffer_load_dwordx4 v4, s[20:23], s74 offen offset:2048 sc1 lds
    s_waitcnt lgkmcnt(4)
    v_mfma_f32_16x16x32_bf16 v[40:43], v[180:183], v[80:83], v[40:43]
    ds_read_b128 v[104:107], v6 offset:39936
    v_mfma_f32_16x16x32_bf16 v[40:43], v[184:187], v[84:87], v[40:43]
    ds_read_b128 v[108:111], v6 offset:44032
    s_add_u32 m0, s87, 71680
    s_add_u32 s74, s82, s70
    buffer_load_dwordx4 v4, s[20:23], s74 offen offset:2048 sc1 lds
    s_waitcnt lgkmcnt(4)
    v_mfma_f32_16x16x32_bf16 v[44:47], v[180:183], v[88:91], v[44:47]
    ds_read_b128 v[80:83], v6 offset:45056
    v_mfma_f32_16x16x32_bf16 v[44:47], v[184:187], v[92:95], v[44:47]
    ds_read_b128 v[84:87], v6 offset:49152
    s_add_u32 m0, s87, 75776
    s_add_u32 s74, s82, s71
    buffer_load_dwordx4 v4, s[20:23], s74 offen offset:2048 sc1 lds
    s_waitcnt lgkmcnt(4)
    v_mfma_f32_16x16x32_bf16 v[48:51], v[180:183], v[96:99], v[48:51]
    ds_read_b128 v[88:91], v6 offset:46080
    v_mfma_f32_16x16x32_bf16 v[48:51], v[184:187], v[100:103], v[48:51]
    ds_read_b128 v[92:95], v6 offset:50176
L_stub6:
    s_cbranch_execz L_ret6
    s_add_u32 m0, s87, 79872
    s_add_u32 s74, s82, s76
    buffer_load_dwordx4 v4, s[20:23], s74 offen offset:2048 sc1 lds
    s_waitcnt lgkmcnt(4)
    v_mfma_f32_16x16x32_bf16 v[52:55], v[180:183], v[104:107], v[52:55]
    ds_read_b128 v[96:99], v6 offset:47104
    v_mfma_f32_16x16x32_bf16 v[52:55], v[184:187], v[108:111], v[52:55]
    ds_read_b128 v[100:103], v6 offset:51200
    s_waitcnt vmcnt(7)
    v_cmp_ne_u32 vcc, s31, v29
    s_nop 0
    s_cmp_eq_u64 vcc, 0
    s_cbranch_scc1 L_ok30
    s_mov_b32 s33, 0
L_poll31:
    buffer_load_dword v29, v9, s[20:23], s89 offen sc1
    s_add_u32 s33, s33, 1
    s_waitcnt vmcnt(0)
    v_cmp_ne_u32 vcc, s31, v29
    s_nop 0
    s_cmp_eq_u64 vcc, 0
    s_cbranch_scc1 L_polld32
    s_cmp_lt_u32 s33, 4000000
    s_cbranch_scc1 L_poll31
L_polld32:
L_ok30:
    s_add_u32 m0, s87, 82944
    s_add_u32 s74, s82, s92
    buffer_load_dwordx4 v4, s[20:23], s74 offen offset:3072 sc1 lds
    s_waitcnt lgkmcnt(4)
    v_mfma_f32_16x16x32_bf16 v[40:43], v[188:191], v[80:83], v[40:43]
    ds_read_b128 v[104:107], v6 offset:48128
    v_mfma_f32_16x16x32_bf16 v[40:43], v[192:195], v[84:87], v[40:43]
    ds_read_b128 v[108:111], v6 offset:52224
    s_add_u32 m0, s87, 87040
    s_add_u32 s74, s82, s93
    buffer_load_dwordx4 v4, s[20:23], s74 offen offset:3072 sc1 lds
    s_waitcnt lgkmcnt(4)
    v_mfma_f32_16x16x32_bf16 v[44:47], v[188:191], v[88:91], v[44:47]
    ds_read_b128 v[80:83], v6 offset:53248
    v_mfma_f32_16x16x32_bf16 v[44:47], v[192:195], v[92:95], v[44:47]
    ds_read_b128 v[84:87], v6 offset:54272
    s_add_u32 m0, s87, 91136
    s_add_u32 s74, s82, s96
    buffer_load_dwordx4 v4, s[20:23], s74 offen offset:3072 sc1 lds
    s_waitcnt lgkmcnt(4)
    v_mfma_f32_16x16x32_bf16 v[48:51], v[188:191], v[96:99], v[48:51]
    ds_read_b128 v[88:91], v6 offset:55296
    v_mfma_f32_16x16x32_bf16 v[48:51], v[192:195], v[100:103], v[48:51]
    ds_read_b128 v[92:95], v6 offset:56320
    s_add_u32 m0, s87, 95232
    s_add_u32 s74, s82, s97
    buffer_load_dwordx4 v4, s[20:23], s74 offen offset:3072 sc1 lds
    s_waitcnt lgkmcnt(4)
    v_mfma_f32_16x16x32_bf16 v[52:55], v[188:191], v[104:107], v[52:55]
    v_mfma_f32_16x16x32_bf16 v[52:55], v[192:195], v[108:111], v[52:55]
    s_add_u32 m0, s87, 99328
    s_add_u32 s74, s82, s70
    buffer_load_dwordx4 v4, s[20:23], s74 offen offset:3072 sc1 lds
    s_waitcnt lgkmcnt(2)
    v_mfma_f32_16x16x32_bf16 v[40:43], v[196:199], v[80:83], v[40:43]
    v_mfma_f32_16x16x32_bf16 v[44:47], v[196:199], v[84:87], v[44:47]
    s_add_u32 m0, s87, 103424
    s_add_u32 s74, s82, s71
    buffer_load_dwordx4 v4, s[20:23], s74 offen offset:3072 sc1 lds
    s_waitcnt lgkmcnt(0)
    v_mfma_f32_16x16x32_bf16 v[48:51], v[196:199], v[88:91], v[48:51]
    v_mfma_f32_16x16x32_bf16 v[52:55], v[196:199], v[92:95], v[52:55]
    s_add_u32 m0, s87, 107520
    s_add_u32 s74, s82, s76
    buffer_load_dwordx4 v4, s[20:23], s74 offen offset:3072 sc1 lds
    s_waitcnt vmcnt(7)
    s_barrier
    ds_read_b128 v[80:83], v7 offset:0
    ds_read_b128 v[84:87], v7 offset:4096
    ds_read_b128 v[88:91], v7 offset:1024
    ds_read_b128 v[92:95], v7 offset:5120
    ds_read_b128 v[96:99], v7 offset:2048
    ds_read_b128 v[100:103], v7 offset:6144
    s_waitcnt lgkmcnt(4)
    v_mfma_f32_16x16x32_bf16 v[40:43], v[200:203], v[80:83], v[40:43]
    ds_read_b128 v[104:107], v7 offset:3072
    v_mfma_f32_16x16x32_bf16 v[40:43], v[204:207], v[84:87], v[40:43]
    ds_read_b128 v[108:111], v7 offset:7168
    ds_read_b128 v[60:63], v36
    ds_read_b128 v[64:67], v37
    s_waitcnt lgkmcnt(6)
    v_mfma_f32_16x16x32_bf16 v[44:47], v[200:203], v[88:91], v[44:47]
    ds_read_b128 v[80:83], v7 offset:8192
    v_mfma_f32_16x16x32_bf16 v[44:47], v[204:207], v[92:95], v[44:47]
    ds_read_b128 v[84:87], v7 offset:12288
    v_cvt_pk_bf16_f32 v68, v56, v56
    v_and_b32 v122, v68, v17
    s_waitcnt lgkmcnt(6)
    v_mfma_f32_16x16x32_bf16 v[48:51], v[200:203], v[96:99], v[48:51]
    ds_read_b128 v[88:91], v7 offset:9216
    v_mfma_f32_16x16x32_bf16 v[48:51], v[204:207], v[100:103], v[48:51]
    ds_read_b128 v[92:95], v7 offset:13312
    v_and_b32 v123, v68, v39
    v_sub_f32 v56, 1.0, v56
    s_waitcnt lgkmcnt(6)
    v_mfma_f32_16x16x32_bf16 v[52:55], v[200:203], v[104:107], v[52:55]
    ds_read_b128 v[96:99], v7 offset:10240
    v_mfma_f32_16x16x32_bf16 v[52:55], v[204:207], v[108:111], v[52:55]
    ds_read_b128 v[100:103], v7 offset:14336
    v_cvt_pk_bf16_f32 v68, v57, v57
    v_and_b32 v128, v68, v17
    s_waitcnt lgkmcnt(4)
    v_mfma_f32_16x16x32_bf16 v[40:43], v[208:211], v[80:83], v[40:43]
    ds_read_b128 v[104:107], v7 offset:11264
    v_mfma_f32_16x16x32_bf16 v[40:43], v[212:215], v[84:87], v[40:43]
    ds_read_b128 v[108:111], v7 offset:15360
    v_and_b32 v129, v68, v39
    v_sub_f32 v57, 1.0, v57
    s_waitcnt lgkmcnt(4)
    v_mfma_f32_16x16x32_bf16 v[44:47], v[208:211], v[88:91], v[44:47]
    ds_read_b128 v[80:83], v7 offset:16384
    v_mfma_f32_16x16x32_bf16 v[44:47], v[212:215], v[92:95], v[44:47]
    ds_read_b128 v[84:87], v7 offset:20480
    v_cvt_pk_bf16_f32 v68, v58, v58
    v_and_b32 v134, v68, v17
    s_waitcnt lgkmcnt(4)
    v_mfma_f32_16x16x32_bf16 v[48:51], v[208:211], v[96:99], v[48:51]
    ds_read_b128 v[88:91], v7 offset:17408
    v_mfma_f32_16x16x32_bf16 v[48:51], v[212:215], v[100:103], v[48:51]
    ds_read_b128 v[92:95], v7 offset:21504
    v_and_b32 v135, v68, v39
    v_sub_f32 v58, 1.0, v58
    s_waitcnt lgkmcnt(4)
    v_mfma_f32_16x16x32_bf16 v[52:55], v[208:211], v[104:107], v[52:55]
    ds_read_b128 v[96:99], v7 offset:18432
    v_mfma_f32_16x16x32_bf16 v[52:55], v[212:215], v[108:111], v[52:55]
    ds_read_b128 v[100:103], v7 offset:22528
    v_cvt_pk_bf16_f32 v68, v59, v59
    v_and_b32 v140, v68, v17
    s_waitcnt lgkmcnt(4)
    v_mfma_f32_16x16x32_bf16 v[40:43], v[216:219], v[80:83], v[40:43]
    ds_read_b128 v[104:107], v7 offset:19456
    v_mfma_f32_16x16x32_bf16 v[40:43], v[220:223], v[84:87], v[40:43]
    ds_read_b128 v[108:111], v7 offset:23552
    v_and_b32 v141, v68, v39
    v_sub_f32 v59, 1.0, v59
    s_waitcnt lgkmcnt(4)
    v_mfma_f32_16x16x32_bf16 v[44:47], v[216:219], v[88:91], v[44:47]
    ds_read_b128 v[80:83], v7 offset:24576
    v_mfma_f32_16x16x32_bf16 v[44:47], v[220:223], v[92:95], v[44:47]
    ds_read_b128 v[84:87], v7 offset:25600
    v_mul_u32_u24 v70, 144, v19
    v_lshl_add_u32 v70, v3, 3, v70
    s_lshl_b32 s36, s30, 5
    s_waitcnt lgkmcnt(4)
    v_mfma_f32_16x16x32_bf16 v[48:51], v[216:219], v[96:99], v[48:51]
    ds_read_b128 v[88:91], v7 offset:26624
    v_mfma_f32_16x16x32_bf16 v[48:51], v[220:223], v[100:103], v[48:51]
    ds_read_b128 v[92:95], v7 offset:27648
    s_add_u32 s36, s36, 16384
    v_add_u32 v70, s36, v70
    v_lshrrev_b32 v72, 3, v1
    s_waitcnt lgkmcnt(4)
    v_mfma_f32_16x16x32_bf16 v[52:55], v[216:219], v[104:107], v[52:55]
    v_mfma_f32_16x16x32_bf16 v[52:55], v[220:223], v[108:111], v[52:55]
    v_and_b32 v73, 7, v1
    s_lshl_b32 s36, s30, 4
    v_add_u32 v72, s36, v72
    s_waitcnt lgkmcnt(2)
    v_mfma_f32_16x16x32_bf16 v[40:43], v[224:227], v[80:83], v[40:43]
    v_mfma_f32_16x16x32_bf16 v[44:47], v[224:227], v[84:87], v[44:47]
    v_mul_u32_u24 v71, 144, v72
    v_lshl_add_u32 v71, v73, 4, v71
    v_mul_u32_u24 v72, 896, v72
    s_waitcnt lgkmcnt(0)
    v_mfma_f32_16x16x32_bf16 v[48:51], v[224:227], v[88:91], v[48:51]
    v_mfma_f32_16x16x32_bf16 v[52:55], v[224:227], v[92:95], v[52:55]
    v_lshl_add_u32 v72, v73, 4, v72
    s_lshl_b32 s36, s30, 5
    s_sub_u32 s84, s84, s36
    v_mfma_f32_16x16x32_bf16 v[144:147], v[60:63], v[122:125], 0
    v_mfma_f32_16x16x32_bf16 v[148:151], v[60:63], v[126:129], 0
    v_mfma_f32_16x16x32_bf16 v[152:155], v[64:67], v[134:137], 0
    v_mfma_f32_16x16x32_bf16 v[156:159], v[64:67], v[138:141], 0
    s_waitcnt vmcnt(0)
    s_barrier
    ds_read_b128 v[80:83], v7 offset:28672
    ds_read_b128 v[84:87], v7 offset:32768
    ds_read_b128 v[88:91], v7 offset:29696
    ds_read_b128 v[92:95], v7 offset:33792
    ds_read_b128 v[96:99], v7 offset:30720
    ds_read_b128 v[100:103], v7 offset:34816
    s_waitcnt lgkmcnt(4)
    v_mfma_f32_16x16x32_bf16 v[40:43], v[228:231], v[80:83], v[40:43]
    ds_read_b128 v[104:107], v7 offset:31744
    v_mfma_f32_16x16x32_bf16 v[40:43], v[232:235], v[84:87], v[40:43]
    ds_read_b128 v[108:111], v7 offset:35840
    s_waitcnt lgkmcnt(4)
    v_mfma_f32_16x16x32_bf16 v[44:47], v[228:231], v[88:91], v[44:47]
    ds_read_b128 v[80:83], v7 offset:36864
    v_mfma_f32_16x16x32_bf16 v[44:47], v[232:235], v[92:95], v[44:47]
    ds_read_b128 v[84:87], v7 offset:40960
    s_waitcnt lgkmcnt(4)
    v_mfma_f32_16x16x32_bf16 v[48:51], v[228:231], v[96:99], v[48:51]
    ds_read_b128 v[88:91], v7 offset:37888
    v_mfma_f32_16x16x32_bf16 v[48:51], v[232:235], v[100:103], v[48:51]
    ds_read_b128 v[92:95], v7 offset:41984
    s_waitcnt lgkmcnt(4)
    v_mfma_f32_16x16x32_bf16 v[52:55], v[228:231], v[104:107], v[52:55]
    ds_read_b128 v[96:99], v7 offset:38912
    v_mfma_f32_16x16x32_bf16 v[52:55], v[232:235], v[108:111], v[52:55]
    ds_read_b128 v[100:103], v7 offset:43008
    s_waitcnt lgkmcnt(4)
    v_mfma_f32_16x16x32_bf16 v[40:43], v[236:239], v[80:83], v[40:43]
    ds_read_b128 v[104:107], v7 offset:39936
    v_mfma_f32_16x16x32_bf16 v[40:43], v[240:243], v[84:87], v[40:43]
    ds_read_b128 v[108:111], v7 offset:44032
    s_waitcnt lgkmcnt(4)
    v_mfma_f32_16x16x32_bf16 v[44:47], v[236:239], v[88:91], v[44:47]
    ds_read_b128 v[80:83], v7 offset:45056
    v_mfma_f32_16x16x32_bf16 v[44:47], v[240:243], v[92:95], v[44:47]
    ds_read_b128 v[84:87], v7 offset:49152
    s_waitcnt lgkmcnt(4)
    v_mfma_f32_16x16x32_bf16 v[48:51], v[236:239], v[96:99], v[48:51]
    ds_read_b128 v[88:91], v7 offset:46080
    v_mfma_f32_16x16x32_bf16 v[48:51], v[240:243], v[100:103], v[48:51]
    ds_read_b128 v[92:95], v7 offset:50176
    s_waitcnt lgkmcnt(4)
    v_mfma_f32_16x16x32_bf16 v[52:55], v[236:239], v[104:107], v[52:55]
    ds_read_b128 v[96:99], v7 offset:47104
    v_mfma_f32_16x16x32_bf16 v[52:55], v[240:243], v[108:111], v[52:55]
    ds_read_b128 v[100:103], v7 offset:51200
    s_waitcnt lgkmcnt(4)
    v_mfma_f32_16x16x32_bf16 v[40:43], v[244:247], v[80:83], v[40:43]
    ds_read_b128 v[104:107], v7 offset:48128
    v_mfma_f32_16x16x32_bf16 v[40:43], v[248:251], v[84:87], v[40:43]
    ds_read_b128 v[108:111], v7 offset:52224
    s_waitcnt lgkmcnt(4)
    v_mfma_f32_16x16x32_bf16 v[44:47], v[244:247], v[88:91], v[44:47]
    ds_read_b128 v[80:83], v7 offset:53248
    v_mfma_f32_16x16x32_bf16 v[44:47], v[248:251], v[92:95], v[44:47]
    ds_read_b128 v[84:87], v7 offset:54272
    s_waitcnt lgkmcnt(4)
    v_mfma_f32_16x16x32_bf16 v[48:51], v[244:247], v[96:99], v[48:51]
    ds_read_b128 v[88:91], v7 offset:55296
    v_mfma_f32_16x16x32_bf16 v[48:51], v[248:251], v[100:103], v[48:51]
    ds_read_b128 v[92:95], v7 offset:56320
    s_waitcnt lgkmcnt(4)
    v_mfma_f32_16x16x32_bf16 v[52:55], v[244:247], v[104:107], v[52:55]
    v_mfma_f32_16x16x32_bf16 v[52:55], v[248:251], v[108:111], v[52:55]
    s_waitcnt lgkmcnt(2)
    v_mfma_f32_16x16x32_bf16 v[40:43], v[252:255], v[80:83], v[40:43]
    v_mfma_f32_16x16x32_bf16 v[44:47], v[252:255], v[84:87], v[44:47]
    s_waitcnt lgkmcnt(0)
    v_mfma_f32_16x16x32_bf16 v[48:51], v[252:255], v[88:91], v[48:51]
    v_mfma_f32_16x16x32_bf16 v[52:55], v[252:255], v[92:95], v[52:55]
    s_nop 3
    v_fma_f32 v40, v40, v56, v144
    v_fma_f32 v41, v41, v56, v145
    v_fma_f32 v42, v42, v56, v146
    v_fma_f32 v43, v43, v56, v147
    v_fma_f32 v44, v44, v57, v148
    v_fma_f32 v45, v45, v57, v149
    v_fma_f32 v46, v46, v57, v150
    v_fma_f32 v47, v47, v57, v151
    v_fma_f32 v48, v48, v58, v152
    v_fma_f32 v49, v49, v58, v153
    v_fma_f32 v50, v50, v58, v154
    v_fma_f32 v51, v51, v58, v155
    v_fma_f32 v52, v52, v59, v156
    v_fma_f32 v53, v53, v59, v157
    v_fma_f32 v54, v54, v59, v158
    v_fma_f32 v55, v55, v59, v159
    v_cvt_pk_bf16_f32 v40, v40, v41
    v_cvt_pk_bf16_f32 v41, v42, v43
    ds_write_b64 v70, v[40:41] offset:0
    v_cvt_pk_bf16_f32 v44, v44, v45
    v_cvt_pk_bf16_f32 v45, v46, v47
    ds_write_b64 v70, v[44:45] offset:576
    v_cvt_pk_bf16_f32 v48, v48, v49
    v_cvt_pk_bf16_f32 v49, v50, v51
    ds_write_b64 v70, v[48:49] offset:4608
    v_cvt_pk_bf16_f32 v52, v52, v53
    v_cvt_pk_bf16_f32 v53, v54, v55
    ds_write_b64 v70, v[52:53] offset:5184
    s_add_u32 s36, s84, 7168
    s_waitcnt lgkmcnt(0)
    s_barrier
    ds_read_b128 v[40:43], v71 offset:16384
    ds_read_b128 v[44:47], v71 offset:17536
    s_waitcnt lgkmcnt(1)
    buffer_store_dwordx4 v[40:43], v72, s[24:27], s84 offen
    s_waitcnt lgkmcnt(0)
    buffer_store_dwordx4 v[44:47], v72, s[24:27], s36 offen
L_end:
    s_endpgm
L_auxb:
    s_waitcnt vmcnt(4)
    s_barrier
    s_mul_i32 s34, s30, 16128
    s_add_u32 s34, s34, 86016
    v_mul_u32_u24 v14, 144, v2
    v_lshl_add_u32 v14, v3, 4, v14
    v_add_u32 v14, s34, v14
    v_lshrrev_b32 v15, 3, v1
    v_and_b32 v16, 7, v1
    v_mul_u32_u24 v13, 144, v15
    v_lshl_add_u32 v13, v16, 4, v13
    v_add_u32 v13, s34, v13
    v_lshlrev_b32 v15, 12, v15
    v_lshl_add_u32 v15, v16, 4, v15
    ds_read_b64_tr_b16 v[48:49], v11 offset:0
    ds_read_b64_tr_b16 v[50:51], v11 offset:3584
    ds_read_b64_tr_b16 v[52:53], v11 offset:28672
    ds_read_b64_tr_b16 v[54:55], v11 offset:32256
    s_waitcnt lgkmcnt(0)
    ds_write_b128 v14, v[48:51] offset:0
    ds_write_b128 v14, v[52:55] offset:64
    ds_read_b64_tr_b16 v[56:57], v11 offset:32
    ds_read_b64_tr_b16 v[58:59], v11 offset:3616
    ds_read_b64_tr_b16 v[60:61], v11 offset:28704
    ds_read_b64_tr_b16 v[62:63], v11 offset:32288
    s_waitcnt lgkmcnt(0)
    ds_write_b128 v14, v[56:59] offset:2304
    ds_write_b128 v14, v[60:63] offset:2368
    ds_read_b64_tr_b16 v[48:49], v11 offset:64
    ds_read_b64_tr_b16 v[50:51], v11 offset:3648
    ds_read_b64_tr_b16 v[52:53], v11 offset:28736
    ds_read_b64_tr_b16 v[54:55], v11 offset:32320
    s_waitcnt lgkmcnt(0)
    ds_write_b128 v14, v[48:51] offset:4608
    ds_write_b128 v14, v[52:55] offset:4672
    ds_read_b64_tr_b16 v[56:57], v11 offset:96
    ds_read_b64_tr_b16 v[58:59], v11 offset:3680
    ds_read_b64_tr_b16 v[60:61], v11 offset:28768
    ds_read_b64_tr_b16 v[62:63], v11 offset:32352
    s_waitcnt lgkmcnt(0)
    ds_write_b128 v14, v[56:59] offset:6912
    ds_write_b128 v14, v[60:63] offset:6976
    ds_read_b64_tr_b16 v[48:49], v11 offset:128
    ds_read_b64_tr_b16 v[50:51], v11 offset:3712
    ds_read_b64_tr_b16 v[52:53], v11 offset:28800
    ds_read_b64_tr_b16 v[54:55], v11 offset:32384
    s_waitcnt lgkmcnt(0)
    ds_write_b128 v14, v[48:51] offset:9216
    ds_write_b128 v14, v[52:55] offset:9280
    ds_read_b64_tr_b16 v[56:57], v11 offset:160
    ds_read_b64_tr_b16 v[58:59], v11 offset:3744
    ds_read_b64_tr_b16 v[60:61], v11 offset:28832
    ds_read_b64_tr_b16 v[62:63], v11 offset:32416
    s_waitcnt lgkmcnt(0)
    ds_write_b128 v14, v[56:59] offset:11520
    ds_write_b128 v14, v[60:63] offset:11584
    ds_read_b64_tr_b16 v[48:49], v11 offset:192
    ds_read_b64_tr_b16 v[50:51], v11 offset:3776
    ds_read_b64_tr_b16 v[52:53], v11 offset:28864
    ds_read_b64_tr_b16 v[54:55], v11 offset:32448
    s_waitcnt lgkmcnt(0)
    ds_write_b128 v14, v[48:51] offset:13824
    ds_write_b128 v14, v[52:55] offset:13888
    s_mul_i32 s34, s30, 458752
    s_lshl_b32 s35, s28, 7
    s_add_u32 s34, s34, s35
    s_add_u32 s34, s34, 8388608
    s_waitcnt lgkmcnt(0)
    ds_read_b128 v[184:187], v13 offset:0
    ds_read_b128 v[188:191], v13 offset:1152
    ds_read_b128 v[192:195], v13 offset:2304
    ds_read_b128 v[196:199], v13 offset:3456
    ds_read_b128 v[200:203], v13 offset:4608
    ds_read_b128 v[204:207], v13 offset:5760
    ds_read_b128 v[208:211], v13 offset:6912
    ds_read_b128 v[212:215], v13 offset:8064
    ds_read_b128 v[216:219], v13 offset:9216
    ds_read_b128 v[220:223], v13 offset:10368
    ds_read_b128 v[224:227], v13 offset:11520
    ds_read_b128 v[228:231], v13 offset:12672
    ds_read_b128 v[232:235], v13 offset:13824
    ds_read_b128 v[236:239], v13 offset:14976
    s_waitcnt lgkmcnt(0)
    buffer_store_dwordx4 v[184:187], v15, s[20:23], s34 offen sc1
    s_add_u32 s34, s34, 32768
    buffer_store_dwordx4 v[188:191], v15, s[20:23], s34 offen sc1
    s_add_u32 s34, s34, 32768
    buffer_store_dwordx4 v[192:195], v15, s[20:23], s34 offen sc1
    s_add_u32 s34, s34, 32768
    buffer_store_dwordx4 v[196:199], v15, s[20:23], s34 offen sc1
    s_add_u32 s34, s34, 32768
    buffer_store_dwordx4 v[200:203], v15, s[20:23], s34 offen sc1
    s_add_u32 s34, s34, 32768
    buffer_store_dwordx4 v[204:207], v15, s[20:23], s34 offen sc1
    s_add_u32 s34, s34, 32768
    buffer_store_dwordx4 v[208:211], v15, s[20:23], s34 offen sc1
    s_add_u32 s34, s34, 32768
    buffer_store_dwordx4 v[212:215], v15, s[20:23], s34 offen sc1
    s_add_u32 s34, s34, 32768
    buffer_store_dwordx4 v[216:219], v15, s[20:23], s34 offen sc1
    s_add_u32 s34, s34, 32768
    buffer_store_dwordx4 v[220:223], v15, s[20:23], s34 offen sc1
    s_add_u32 s34, s34, 32768
    buffer_store_dwordx4 v[224:227], v15, s[20:23], s34 offen sc1
    s_add_u32 s34, s34, 32768
    buffer_store_dwordx4 v[228:231], v15, s[20:23], s34 offen sc1
    s_add_u32 s34, s34, 32768
    buffer_store_dwordx4 v[232:235], v15, s[20:23], s34 offen sc1
    s_add_u32 s34, s34, 32768
    buffer_store_dwordx4 v[236:239], v15, s[20:23], s34 offen sc1
    s_add_u32 s34, s34, 32768
    s_mov_b32 s33, 0
L_nn33:
    global_load_dword v18, v5, s[68:69] sc1
    s_add_u32 s33, s33, 1
    s_waitcnt vmcnt(0)
    v_readfirstlane_b32 s31, v18
    s_cmp_gt_u32 s33, 4000000
    s_cbranch_scc1 L_nnd34
    s_cmp_eq_u32 s31, 0
    s_cbranch_scc1 L_nn33
L_nnd34:
    s_mul_i32 s34, s28, 28672
    s_mul_i32 s35, s30, 7168
    s_add_u32 s34, s34, s35
    s_add_u32 s35, s35, 57344
    s_add_u32 m0, s35, 0
    s_add_u32 s36, s34, 0
    buffer_load_dwordx4 v4, s[12:15], s36 offen offset:0 lds
    buffer_load_dwordx4 v4, s[12:15], s36 offen offset:1024 lds
    buffer_load_dwordx4 v4, s[12:15], s36 offen offset:2048 lds
    buffer_load_dwordx4 v4, s[12:15], s36 offen offset:3072 lds
    s_add_u32 m0, s35, 4096
    s_add_u32 s36, s34, 4096
    buffer_load_dwordx4 v4, s[12:15], s36 offen offset:0 lds
    buffer_load_dwordx4 v4, s[12:15], s36 offen offset:1024 lds
    buffer_load_dwordx4 v4, s[12:15], s36 offen offset:2048 lds
    global_load_dwordx4 v[64:67], v8, s[64:65] offset:0
    global_load_dwordx4 v[68:71], v8, s[64:65] offset:16
    global_load_dwordx4 v[72:75], v8, s[64:65] offset:32
    global_load_dwordx4 v[76:79], v8, s[64:65] offset:48
    global_load_dwordx4 v[80:83], v8, s[64:65] offset:64
    global_load_dwordx4 v[84:87], v8, s[64:65] offset:80
    global_load_dwordx4 v[88:91], v8, s[64:65] offset:96
    global_load_dwordx4 v[92:95], v8, s[64:65] offset:112
    global_load_dwordx4 v[96:99], v8, s[64:65] offset:128
    global_load_dwordx4 v[100:103], v8, s[64:65] offset:144
    global_load_dwordx4 v[104:107], v8, s[64:65] offset:160
    global_load_dwordx4 v[108:111], v8, s[64:65] offset:176
    global_load_dwordx4 v[112:115], v8, s[64:65] offset:192
    global_load_dwordx4 v[116:119], v8, s[64:65] offset:208
    s_barrier
    s_cmp_lg_u32 s30, 0
    s_cbranch_scc1 L_flg35
    s_lshl_b32 s79, s28, 7
    s_add_u32 s79, s79, 14778368
    v_mov_b32 v18, s31
    s_mov_b64 exec, 1
    buffer_store_dword v18, v5, s[20:23], s79 offen sc1
    s_mov_b64 exec, -1
L_flg35:
    s_waitcnt vmcnt(0)
    s_barrier
    s_lshl_b32 s34, s30, 4
    v_add_u32 v14, s34, v2
    v_mul_u32_u24 v14, 896, v14
    v_add_u32 v14, v14, v8
    v_mov_b32 v15, 0
    v_mov_b32 v16, 0
    ds_read_b128 v[128:131], v14 offset:0
    ds_read_b128 v[132:135], v14 offset:16
    ds_read_b128 v[136:139], v14 offset:32
    ds_read_b128 v[140:143], v14 offset:48
    ds_read_b128 v[144:147], v14 offset:64
    ds_read_b128 v[148:151], v14 offset:80
    ds_read_b128 v[152:155], v14 offset:96
    ds_read_b128 v[156:159], v14 offset:112
    ds_read_b128 v[160:163], v14 offset:128
    ds_read_b128 v[164:167], v14 offset:144
    ds_read_b128 v[168:171], v14 offset:160
    ds_read_b128 v[172:175], v14 offset:176
    ds_read_b128 v[176:179], v14 offset:192
    ds_read_b128 v[180:183], v14 offset:208
    s_waitcnt lgkmcnt(0)
    v_lshlrev_b32 v44, 16, v128
    v_and_b32 v45, 0xffff0000, v128
    v_lshlrev_b32 v46, 16, v64
    v_and_b32 v47, 0xffff0000, v64
    v_mul_f32 v44, v44, v46
    v_mul_f32 v45, v45, v47
    v_cvt_pk_bf16_f32 v44, v44, v45
    v_lshlrev_b32 v46, 16, v44
    v_and_b32 v47, 0xffff0000, v44
    v_add_f32 v15, v15, v46
    v_add_f32 v16, v16, v47
    v_lshlrev_b32 v44, 16, v129
    v_and_b32 v45, 0xffff0000, v129
    v_lshlrev_b32 v46, 16, v65
    v_and_b32 v47, 0xffff0000, v65
    v_mul_f32 v44, v44, v46
    v_mul_f32 v45, v45, v47
    v_cvt_pk_bf16_f32 v44, v44, v45
    v_lshlrev_b32 v46, 16, v44
    v_and_b32 v47, 0xffff0000, v44
    v_add_f32 v15, v15, v46
    v_add_f32 v16, v16, v47
    v_lshlrev_b32 v44, 16, v130
    v_and_b32 v45, 0xffff0000, v130
    v_lshlrev_b32 v46, 16, v66
    v_and_b32 v47, 0xffff0000, v66
    v_mul_f32 v44, v44, v46
    v_mul_f32 v45, v45, v47
    v_cvt_pk_bf16_f32 v44, v44, v45
    v_lshlrev_b32 v46, 16, v44
    v_and_b32 v47, 0xffff0000, v44
    v_add_f32 v15, v15, v46
    v_add_f32 v16, v16, v47
    v_lshlrev_b32 v44, 16, v131
    v_and_b32 v45, 0xffff0000, v131
    v_lshlrev_b32 v46, 16, v67
    v_and_b32 v47, 0xffff0000, v67
    v_mul_f32 v44, v44, v46
    v_mul_f32 v45, v45, v47
    v_cvt_pk_bf16_f32 v44, v44, v45
    v_lshlrev_b32 v46, 16, v44
    v_and_b32 v47, 0xffff0000, v44
    v_add_f32 v15, v15, v46
    v_add_f32 v16, v16, v47
    v_lshlrev_b32 v44, 16, v132
    v_and_b32 v45, 0xffff0000, v132
    v_lshlrev_b32 v46, 16, v68
    v_and_b32 v47, 0xffff0000, v68
    v_pk_mul_f32 v[44:45], v[44:45], v[46:47]
    v_cvt_pk_bf16_f32 v44, v44, v45
    v_lshlrev_b32 v46, 16, v44
    v_and_b32 v47, 0xffff0000, v44
    v_add_f32 v15, v15, v46
    v_add_f32 v16, v16, v47
    v_lshlrev_b32 v44, 16, v133
    v_and_b32 v45, 0xffff0000, v133
    v_lshlrev_b32 v46, 16, v69
    v_and_b32 v47, 0xffff0000, v69
    v_pk_mul_f32 v[44:45], v[44:45], v[46:47]
    v_cvt_pk_bf16_f32 v44, v44, v45
    v_lshlrev_b32 v46, 16, v44
    v_and_b32 v47, 0xffff0000, v44
    v_add_f32 v15, v15, v46
    v_add_f32 v16, v16, v47
    v_lshlrev_b32 v44, 16, v134
    v_and_b32 v45, 0xffff0000, v134
    v_lshlrev_b32 v46, 16, v70
    v_and_b32 v47, 0xffff0000, v70
    v_pk_mul_f32 v[44:45], v[44:45], v[46:47]
    v_cvt_pk_bf16_f32 v44, v44, v45
    v_lshlrev_b32 v46, 16, v44
    v_and_b32 v47, 0xffff0000, v44
    v_add_f32 v15, v15, v46
    v_add_f32 v16, v16, v47
    v_lshlrev_b32 v44, 16, v135
    v_and_b32 v45, 0xffff0000, v135
    v_lshlrev_b32 v46, 16, v71
    v_and_b32 v47, 0xffff0000, v71
    v_pk_mul_f32 v[44:45], v[44:45], v[46:47]
    v_cvt_pk_bf16_f32 v44, v44, v45
    v_lshlrev_b32 v46, 16, v44
    v_and_b32 v47, 0xffff0000, v44
    v_add_f32 v15, v15, v46
    v_add_f32 v16, v16, v47
    v_lshlrev_b32 v44, 16, v136
    v_and_b32 v45, 0xffff0000, v136
    v_lshlrev_b32 v46, 16, v72
    v_and_b32 v47, 0xffff0000, v72
    v_pk_mul_f32 v[44:45], v[44:45], v[46:47]
    v_cvt_pk_bf16_f32 v44, v44, v45
    v_lshlrev_b32 v46, 16, v44
    v_and_b32 v47, 0xffff0000, v44
    v_add_f32 v15, v15, v46
    v_add_f32 v16, v16, v47
    v_lshlrev_b32 v44, 16, v137
    v_and_b32 v45, 0xffff0000, v137
    v_lshlrev_b32 v46, 16, v73
    v_and_b32 v47, 0xffff0000, v73
    v_pk_mul_f32 v[44:45], v[44:45], v[46:47]
    v_cvt_pk_bf16_f32 v44, v44, v45
    v_lshlrev_b32 v46, 16, v44
    v_and_b32 v47, 0xffff0000, v44
    v_add_f32 v15, v15, v46
    v_add_f32 v16, v16, v47
    v_lshlrev_b32 v44, 16, v138
    v_and_b32 v45, 0xffff0000, v138
    v_lshlrev_b32 v46, 16, v74
    v_and_b32 v47, 0xffff0000, v74
    v_pk_mul_f32 v[44:45], v[44:45], v[46:47]
    v_cvt_pk_bf16_f32 v44, v44, v45
    v_lshlrev_b32 v46, 16, v44
    v_and_b32 v47, 0xffff0000, v44
    v_add_f32 v15, v15, v46
    v_add_f32 v16, v16, v47
    v_lshlrev_b32 v44, 16, v139
    v_and_b32 v45, 0xffff0000, v139
    v_lshlrev_b32 v46, 16, v75
    v_and_b32 v47, 0xffff0000, v75
    v_pk_mul_f32 v[44:45], v[44:45], v[46:47]
    v_cvt_pk_bf16_f32 v44, v44, v45
    v_lshlrev_b32 v46, 16, v44
    v_and_b32 v47, 0xffff0000, v44
    v_add_f32 v15, v15, v46
    v_add_f32 v16, v16, v47
    v_lshlrev_b32 v44, 16, v140
    v_and_b32 v45, 0xffff0000, v140
    v_lshlrev_b32 v46, 16, v76
    v_and_b32 v47, 0xffff0000, v76
    v_pk_mul_f32 v[44:45], v[44:45], v[46:47]
    v_cvt_pk_bf16_f32 v44, v44, v45
    v_lshlrev_b32 v46, 16, v44
    v_and_b32 v47, 0xffff0000, v44
    v_add_f32 v15, v15, v46
    v_add_f32 v16, v16, v47
    v_lshlrev_b32 v44, 16, v141
    v_and_b32 v45, 0xffff0000, v141
    v_lshlrev_b32 v46, 16, v77
    v_and_b32 v47, 0xffff0000, v77
    v_pk_mul_f32 v[44:45], v[44:45], v[46:47]
    v_cvt_pk_bf16_f32 v44, v44, v45
    v_lshlrev_b32 v46, 16, v44
    v_and_b32 v47, 0xffff0000, v44
    v_add_f32 v15, v15, v46
    v_add_f32 v16, v16, v47
    v_lshlrev_b32 v44, 16, v142
    v_and_b32 v45, 0xffff0000, v142
    v_lshlrev_b32 v46, 16, v78
    v_and_b32 v47, 0xffff0000, v78
    v_pk_mul_f32 v[44:45], v[44:45], v[46:47]
    v_cvt_pk_bf16_f32 v44, v44, v45
    v_lshlrev_b32 v46, 16, v44
    v_and_b32 v47, 0xffff0000, v44
    v_add_f32 v15, v15, v46
    v_add_f32 v16, v16, v47
    v_lshlrev_b32 v44, 16, v143
    v_and_b32 v45, 0xffff0000, v143
    v_lshlrev_b32 v46, 16, v79
    v_and_b32 v47, 0xffff0000, v79
    v_pk_mul_f32 v[44:45], v[44:45], v[46:47]
    v_cvt_pk_bf16_f32 v44, v44, v45
    v_lshlrev_b32 v46, 16, v44
    v_and_b32 v47, 0xffff0000, v44
    v_add_f32 v15, v15, v46
    v_add_f32 v16, v16, v47
    v_lshlrev_b32 v44, 16, v144
    v_and_b32 v45, 0xffff0000, v144
    v_lshlrev_b32 v46, 16, v80
    v_and_b32 v47, 0xffff0000, v80
    v_pk_mul_f32 v[44:45], v[44:45], v[46:47]
    v_cvt_pk_bf16_f32 v44, v44, v45
    v_lshlrev_b32 v46, 16, v44
    v_and_b32 v47, 0xffff0000, v44
    v_add_f32 v15, v15, v46
    v_add_f32 v16, v16, v47
    v_lshlrev_b32 v44, 16, v145
    v_and_b32 v45, 0xffff0000, v145
    v_lshlrev_b32 v46, 16, v81
    v_and_b32 v47, 0xffff0000, v81
    v_pk_mul_f32 v[44:45], v[44:45], v[46:47]
    v_cvt_pk_bf16_f32 v44, v44, v45
    v_lshlrev_b32 v46, 16, v44
    v_and_b32 v47, 0xffff0000, v44
    v_add_f32 v15, v15, v46
    v_add_f32 v16, v16, v47
    v_lshlrev_b32 v44, 16, v146
    v_and_b32 v45, 0xffff0000, v146
    v_lshlrev_b32 v46, 16, v82
    v_and_b32 v47, 0xffff0000, v82
    v_pk_mul_f32 v[44:45], v[44:45], v[46:47]
    v_cvt_pk_bf16_f32 v44, v44, v45
    v_lshlrev_b32 v46, 16, v44
    v_and_b32 v47, 0xffff0000, v44
    v_add_f32 v15, v15, v46
    v_add_f32 v16, v16, v47
    v_lshlrev_b32 v44, 16, v147
    v_and_b32 v45, 0xffff0000, v147
    v_lshlrev_b32 v46, 16, v83
    v_and_b32 v47, 0xffff0000, v83
    v_pk_mul_f32 v[44:45], v[44:45], v[46:47]
    v_cvt_pk_bf16_f32 v44, v44, v45
    v_lshlrev_b32 v46, 16, v44
    v_and_b32 v47, 0xffff0000, v44
    v_add_f32 v15, v15, v46
    v_add_f32 v16, v16, v47
    v_lshlrev_b32 v44, 16, v148
    v_and_b32 v45, 0xffff0000, v148
    v_lshlrev_b32 v46, 16, v84
    v_and_b32 v47, 0xffff0000, v84
    v_pk_mul_f32 v[44:45], v[44:45], v[46:47]
    v_cvt_pk_bf16_f32 v44, v44, v45
    v_lshlrev_b32 v46, 16, v44
    v_and_b32 v47, 0xffff0000, v44
    v_add_f32 v15, v15, v46
    v_add_f32 v16, v16, v47
    v_lshlrev_b32 v44, 16, v149
    v_and_b32 v45, 0xffff0000, v149
    v_lshlrev_b32 v46, 16, v85
    v_and_b32 v47, 0xffff0000, v85
    v_pk_mul_f32 v[44:45], v[44:45], v[46:47]
    v_cvt_pk_bf16_f32 v44, v44, v45
    v_lshlrev_b32 v46, 16, v44
    v_and_b32 v47, 0xffff0000, v44
    v_add_f32 v15, v15, v46
    v_add_f32 v16, v16, v47
    v_lshlrev_b32 v44, 16, v150
    v_and_b32 v45, 0xffff0000, v150
    v_lshlrev_b32 v46, 16, v86
    v_and_b32 v47, 0xffff0000, v86
    v_pk_mul_f32 v[44:45], v[44:45], v[46:47]
    v_cvt_pk_bf16_f32 v44, v44, v45
    v_lshlrev_b32 v46, 16, v44
    v_and_b32 v47, 0xffff0000, v44
    v_add_f32 v15, v15, v46
    v_add_f32 v16, v16, v47
    v_lshlrev_b32 v44, 16, v151
    v_and_b32 v45, 0xffff0000, v151
    v_lshlrev_b32 v46, 16, v87
    v_and_b32 v47, 0xffff0000, v87
    v_pk_mul_f32 v[44:45], v[44:45], v[46:47]
    v_cvt_pk_bf16_f32 v44, v44, v45
    v_lshlrev_b32 v46, 16, v44
    v_and_b32 v47, 0xffff0000, v44
    v_add_f32 v15, v15, v46
    v_add_f32 v16, v16, v47
    v_lshlrev_b32 v44, 16, v152
    v_and_b32 v45, 0xffff0000, v152
    v_lshlrev_b32 v46, 16, v88
    v_and_b32 v47, 0xffff0000, v88
    v_pk_mul_f32 v[44:45], v[44:45], v[46:47]
    v_cvt_pk_bf16_f32 v44, v44, v45
    v_lshlrev_b32 v46, 16, v44
    v_and_b32 v47, 0xffff0000, v44
    v_add_f32 v15, v15, v46
    v_add_f32 v16, v16, v47
    v_lshlrev_b32 v44, 16, v153
    v_and_b32 v45, 0xffff0000, v153
    v_lshlrev_b32 v46, 16, v89
    v_and_b32 v47, 0xffff0000, v89
    v_pk_mul_f32 v[44:45], v[44:45], v[46:47]
    v_cvt_pk_bf16_f32 v44, v44, v45
    v_lshlrev_b32 v46, 16, v44
    v_and_b32 v47, 0xffff0000, v44
    v_add_f32 v15, v15, v46
    v_add_f32 v16, v16, v47
    v_lshlrev_b32 v44, 16, v154
    v_and_b32 v45, 0xffff0000, v154
    v_lshlrev_b32 v46, 16, v90
    v_and_b32 v47, 0xffff0000, v90
    v_pk_mul_f32 v[44:45], v[44:45], v[46:47]
    v_cvt_pk_bf16_f32 v44, v44, v45
    v_lshlrev_b32 v46, 16, v44
    v_and_b32 v47, 0xffff0000, v44
    v_add_f32 v15, v15, v46
    v_add_f32 v16, v16, v47
    v_lshlrev_b32 v44, 16, v155
    v_and_b32 v45, 0xffff0000, v155
    v_lshlrev_b32 v46, 16, v91
    v_and_b32 v47, 0xffff0000, v91
    v_pk_mul_f32 v[44:45], v[44:45], v[46:47]
    v_cvt_pk_bf16_f32 v44, v44, v45
    v_lshlrev_b32 v46, 16, v44
    v_and_b32 v47, 0xffff0000, v44
    v_add_f32 v15, v15, v46
    v_add_f32 v16, v16, v47
    v_lshlrev_b32 v44, 16, v156
    v_and_b32 v45, 0xffff0000, v156
    v_lshlrev_b32 v46, 16, v92
    v_and_b32 v47, 0xffff0000, v92
    v_pk_mul_f32 v[44:45], v[44:45], v[46:47]
    v_cvt_pk_bf16_f32 v44, v44, v45
    v_lshlrev_b32 v46, 16, v44
    v_and_b32 v47, 0xffff0000, v44
    v_add_f32 v15, v15, v46
    v_add_f32 v16, v16, v47
    v_lshlrev_b32 v44, 16, v157
    v_and_b32 v45, 0xffff0000, v157
    v_lshlrev_b32 v46, 16, v93
    v_and_b32 v47, 0xffff0000, v93
    v_pk_mul_f32 v[44:45], v[44:45], v[46:47]
    v_cvt_pk_bf16_f32 v44, v44, v45
    v_lshlrev_b32 v46, 16, v44
    v_and_b32 v47, 0xffff0000, v44
    v_add_f32 v15, v15, v46
    v_add_f32 v16, v16, v47
    v_lshlrev_b32 v44, 16, v158
    v_and_b32 v45, 0xffff0000, v158
    v_lshlrev_b32 v46, 16, v94
    v_and_b32 v47, 0xffff0000, v94
    v_pk_mul_f32 v[44:45], v[44:45], v[46:47]
    v_cvt_pk_bf16_f32 v44, v44, v45
    v_lshlrev_b32 v46, 16, v44
    v_and_b32 v47, 0xffff0000, v44
    v_add_f32 v15, v15, v46
    v_add_f32 v16, v16, v47
    v_lshlrev_b32 v44, 16, v159
    v_and_b32 v45, 0xffff0000, v159
    v_lshlrev_b32 v46, 16, v95
    v_and_b32 v47, 0xffff0000, v95
    v_pk_mul_f32 v[44:45], v[44:45], v[46:47]
    v_cvt_pk_bf16_f32 v44, v44, v45
    v_lshlrev_b32 v46, 16, v44
    v_and_b32 v47, 0xffff0000, v44
    v_add_f32 v15, v15, v46
    v_add_f32 v16, v16, v47
    v_lshlrev_b32 v44, 16, v160
    v_and_b32 v45, 0xffff0000, v160
    v_lshlrev_b32 v46, 16, v96
    v_and_b32 v47, 0xffff0000, v96
    v_pk_mul_f32 v[44:45], v[44:45], v[46:47]
    v_cvt_pk_bf16_f32 v44, v44, v45
    v_lshlrev_b32 v46, 16, v44
    v_and_b32 v47, 0xffff0000, v44
    v_add_f32 v15, v15, v46
    v_add_f32 v16, v16, v47
    v_lshlrev_b32 v44, 16, v161
    v_and_b32 v45, 0xffff0000, v161
    v_lshlrev_b32 v46, 16, v97
    v_and_b32 v47, 0xffff0000, v97
    v_pk_mul_f32 v[44:45], v[44:45], v[46:47]
    v_cvt_pk_bf16_f32 v44, v44, v45
    v_lshlrev_b32 v46, 16, v44
    v_and_b32 v47, 0xffff0000, v44
    v_add_f32 v15, v15, v46
    v_add_f32 v16, v16, v47
    v_lshlrev_b32 v44, 16, v162
    v_and_b32 v45, 0xffff0000, v162
    v_lshlrev_b32 v46, 16, v98
    v_and_b32 v47, 0xffff0000, v98
    v_pk_mul_f32 v[44:45], v[44:45], v[46:47]
    v_cvt_pk_bf16_f32 v44, v44, v45
    v_lshlrev_b32 v46, 16, v44
    v_and_b32 v47, 0xffff0000, v44
    v_add_f32 v15, v15, v46
    v_add_f32 v16, v16, v47
    v_lshlrev_b32 v44, 16, v163
    v_and_b32 v45, 0xffff0000, v163
    v_lshlrev_b32 v46, 16, v99
    v_and_b32 v47, 0xffff0000, v99
    v_pk_mul_f32 v[44:45], v[44:45], v[46:47]
    v_cvt_pk_bf16_f32 v44, v44, v45
    v_lshlrev_b32 v46, 16, v44
    v_and_b32 v47, 0xffff0000, v44
    v_add_f32 v15, v15, v46
    v_add_f32 v16, v16, v47
    v_lshlrev_b32 v44, 16, v164
    v_and_b32 v45, 0xffff0000, v164
    v_lshlrev_b32 v46, 16, v100
    v_and_b32 v47, 0xffff0000, v100
    v_pk_mul_f32 v[44:45], v[44:45], v[46:47]
    v_cvt_pk_bf16_f32 v44, v44, v45
    v_lshlrev_b32 v46, 16, v44
    v_and_b32 v47, 0xffff0000, v44
    v_add_f32 v15, v15, v46
    v_add_f32 v16, v16, v47
    v_lshlrev_b32 v44, 16, v165
    v_and_b32 v45, 0xffff0000, v165
    v_lshlrev_b32 v46, 16, v101
    v_and_b32 v47, 0xffff0000, v101
    v_pk_mul_f32 v[44:45], v[44:45], v[46:47]
    v_cvt_pk_bf16_f32 v44, v44, v45
    v_lshlrev_b32 v46, 16, v44
    v_and_b32 v47, 0xffff0000, v44
    v_add_f32 v15, v15, v46
    v_add_f32 v16, v16, v47
    v_lshlrev_b32 v44, 16, v166
    v_and_b32 v45, 0xffff0000, v166
    v_lshlrev_b32 v46, 16, v102
    v_and_b32 v47, 0xffff0000, v102
    v_pk_mul_f32 v[44:45], v[44:45], v[46:47]
    v_cvt_pk_bf16_f32 v44, v44, v45
    v_lshlrev_b32 v46, 16, v44
    v_and_b32 v47, 0xffff0000, v44
    v_add_f32 v15, v15, v46
    v_add_f32 v16, v16, v47
    v_lshlrev_b32 v44, 16, v167
    v_and_b32 v45, 0xffff0000, v167
    v_lshlrev_b32 v46, 16, v103
    v_and_b32 v47, 0xffff0000, v103
    v_pk_mul_f32 v[44:45], v[44:45], v[46:47]
    v_cvt_pk_bf16_f32 v44, v44, v45
    v_lshlrev_b32 v46, 16, v44
    v_and_b32 v47, 0xffff0000, v44
    v_add_f32 v15, v15, v46
    v_add_f32 v16, v16, v47
    v_lshlrev_b32 v44, 16, v168
    v_and_b32 v45, 0xffff0000, v168
    v_lshlrev_b32 v46, 16, v104
    v_and_b32 v47, 0xffff0000, v104
    v_pk_mul_f32 v[44:45], v[44:45], v[46:47]
    v_cvt_pk_bf16_f32 v44, v44, v45
    v_lshlrev_b32 v46, 16, v44
    v_and_b32 v47, 0xffff0000, v44
    v_add_f32 v15, v15, v46
    v_add_f32 v16, v16, v47
    v_lshlrev_b32 v44, 16, v169
    v_and_b32 v45, 0xffff0000, v169
    v_lshlrev_b32 v46, 16, v105
    v_and_b32 v47, 0xffff0000, v105
    v_pk_mul_f32 v[44:45], v[44:45], v[46:47]
    v_cvt_pk_bf16_f32 v44, v44, v45
    v_lshlrev_b32 v46, 16, v44
    v_and_b32 v47, 0xffff0000, v44
    v_add_f32 v15, v15, v46
    v_add_f32 v16, v16, v47
    v_lshlrev_b32 v44, 16, v170
    v_and_b32 v45, 0xffff0000, v170
    v_lshlrev_b32 v46, 16, v106
    v_and_b32 v47, 0xffff0000, v106
    v_pk_mul_f32 v[44:45], v[44:45], v[46:47]
    v_cvt_pk_bf16_f32 v44, v44, v45
    v_lshlrev_b32 v46, 16, v44
    v_and_b32 v47, 0xffff0000, v44
    v_add_f32 v15, v15, v46
    v_add_f32 v16, v16, v47
    v_lshlrev_b32 v44, 16, v171
    v_and_b32 v45, 0xffff0000, v171
    v_lshlrev_b32 v46, 16, v107
    v_and_b32 v47, 0xffff0000, v107
    v_pk_mul_f32 v[44:45], v[44:45], v[46:47]
    v_cvt_pk_bf16_f32 v44, v44, v45
    v_lshlrev_b32 v46, 16, v44
    v_and_b32 v47, 0xffff0000, v44
    v_add_f32 v15, v15, v46
    v_add_f32 v16, v16, v47
    v_lshlrev_b32 v44, 16, v172
    v_and_b32 v45, 0xffff0000, v172
    v_lshlrev_b32 v46, 16, v108
    v_and_b32 v47, 0xffff0000, v108
    v_pk_mul_f32 v[44:45], v[44:45], v[46:47]
    v_cvt_pk_bf16_f32 v44, v44, v45
    v_lshlrev_b32 v46, 16, v44
    v_and_b32 v47, 0xffff0000, v44
    v_add_f32 v15, v15, v46
    v_add_f32 v16, v16, v47
    v_lshlrev_b32 v44, 16, v173
    v_and_b32 v45, 0xffff0000, v173
    v_lshlrev_b32 v46, 16, v109
    v_and_b32 v47, 0xffff0000, v109
    v_pk_mul_f32 v[44:45], v[44:45], v[46:47]
    v_cvt_pk_bf16_f32 v44, v44, v45
    v_lshlrev_b32 v46, 16, v44
    v_and_b32 v47, 0xffff0000, v44
    v_add_f32 v15, v15, v46
    v_add_f32 v16, v16, v47
    v_lshlrev_b32 v44, 16, v174
    v_and_b32 v45, 0xffff0000, v174
    v_lshlrev_b32 v46, 16, v110
    v_and_b32 v47, 0xffff0000, v110
    v_pk_mul_f32 v[44:45], v[44:45], v[46:47]
    v_cvt_pk_bf16_f32 v44, v44, v45
    v_lshlrev_b32 v46, 16, v44
    v_and_b32 v47, 0xffff0000, v44
    v_add_f32 v15, v15, v46
    v_add_f32 v16, v16, v47
    v_lshlrev_b32 v44, 16, v175
    v_and_b32 v45, 0xffff0000, v175
    v_lshlrev_b32 v46, 16, v111
    v_and_b32 v47, 0xffff0000, v111
    v_pk_mul_f32 v[44:45], v[44:45], v[46:47]
    v_cvt_pk_bf16_f32 v44, v44, v45
    v_lshlrev_b32 v46, 16, v44
    v_and_b32 v47, 0xffff0000, v44
    v_add_f32 v15, v15, v46
    v_add_f32 v16, v16, v47
    v_lshlrev_b32 v44, 16, v176
    v_and_b32 v45, 0xffff0000, v176
    v_lshlrev_b32 v46, 16, v112
    v_and_b32 v47, 0xffff0000, v112
    v_pk_mul_f32 v[44:45], v[44:45], v[46:47]
    v_cvt_pk_bf16_f32 v44, v44, v45
    v_lshlrev_b32 v46, 16, v44
    v_and_b32 v47, 0xffff0000, v44
    v_add_f32 v15, v15, v46
    v_add_f32 v16, v16, v47
    v_lshlrev_b32 v44, 16, v177
    v_and_b32 v45, 0xffff0000, v177
    v_lshlrev_b32 v46, 16, v113
    v_and_b32 v47, 0xffff0000, v113
    v_pk_mul_f32 v[44:45], v[44:45], v[46:47]
    v_cvt_pk_bf16_f32 v44, v44, v45
    v_lshlrev_b32 v46, 16, v44
    v_and_b32 v47, 0xffff0000, v44
    v_add_f32 v15, v15, v46
    v_add_f32 v16, v16, v47
    v_lshlrev_b32 v44, 16, v178
    v_and_b32 v45, 0xffff0000, v178
    v_lshlrev_b32 v46, 16, v114
    v_and_b32 v47, 0xffff0000, v114
    v_pk_mul_f32 v[44:45], v[44:45], v[46:47]
    v_cvt_pk_bf16_f32 v44, v44, v45
    v_lshlrev_b32 v46, 16, v44
    v_and_b32 v47, 0xffff0000, v44
    v_add_f32 v15, v15, v46
    v_add_f32 v16, v16, v47
    v_lshlrev_b32 v44, 16, v179
    v_and_b32 v45, 0xffff0000, v179
    v_lshlrev_b32 v46, 16, v115
    v_and_b32 v47, 0xffff0000, v115
    v_pk_mul_f32 v[44:45], v[44:45], v[46:47]
    v_cvt_pk_bf16_f32 v44, v44, v45
    v_lshlrev_b32 v46, 16, v44
    v_and_b32 v47, 0xffff0000, v44
    v_add_f32 v15, v15, v46
    v_add_f32 v16, v16, v47
    v_lshlrev_b32 v44, 16, v180
    v_and_b32 v45, 0xffff0000, v180
    v_lshlrev_b32 v46, 16, v116
    v_and_b32 v47, 0xffff0000, v116
    v_pk_mul_f32 v[44:45], v[44:45], v[46:47]
    v_cvt_pk_bf16_f32 v44, v44, v45
    v_lshlrev_b32 v46, 16, v44
    v_and_b32 v47, 0xffff0000, v44
    v_add_f32 v15, v15, v46
    v_add_f32 v16, v16, v47
    v_lshlrev_b32 v44, 16, v181
    v_and_b32 v45, 0xffff0000, v181
    v_lshlrev_b32 v46, 16, v117
    v_and_b32 v47, 0xffff0000, v117
    v_pk_mul_f32 v[44:45], v[44:45], v[46:47]
    v_cvt_pk_bf16_f32 v44, v44, v45
    v_lshlrev_b32 v46, 16, v44
    v_and_b32 v47, 0xffff0000, v44
    v_add_f32 v15, v15, v46
    v_add_f32 v16, v16, v47
    v_lshlrev_b32 v44, 16, v182
    v_and_b32 v45, 0xffff0000, v182
    v_lshlrev_b32 v46, 16, v118
    v_and_b32 v47, 0xffff0000, v118
    v_pk_mul_f32 v[44:45], v[44:45], v[46:47]
    v_cvt_pk_bf16_f32 v44, v44, v45
    v_lshlrev_b32 v46, 16, v44
    v_and_b32 v47, 0xffff0000, v44
    v_add_f32 v15, v15, v46
    v_add_f32 v16, v16, v47
    v_lshlrev_b32 v44, 16, v183
    v_and_b32 v45, 0xffff0000, v183
    v_lshlrev_b32 v46, 16, v119
    v_and_b32 v47, 0xffff0000, v119
    v_pk_mul_f32 v[44:45], v[44:45], v[46:47]
    v_cvt_pk_bf16_f32 v44, v44, v45
    v_lshlrev_b32 v46, 16, v44
    v_and_b32 v47, 0xffff0000, v44
    v_add_f32 v15, v15, v46
    v_add_f32 v16, v16, v47
    v_add_f32 v15, v15, v16
    v_mov_b32 v16, v15
    s_nop 1
    v_permlane32_swap_b32 v15, v16
    v_add_f32 v15, v15, v16
    v_mov_b32 v16, v15
    s_nop 1
    v_permlane16_swap_b32 v15, v16
    v_add_f32 v15, v15, v16
    v_cvt_pk_bf16_f32 v15, v15, v15
    v_and_b32 v15, 0xffff0000, v15
    v_mul_f32 v15, 0xbfb8aa3b, v15
    v_exp_f32 v15, v15
    s_nop 0
    v_add_f32 v15, 1.0, v15
    v_rcp_f32 v15, v15
    s_nop 0
    v_cvt_pk_bf16_f32 v15, v15, v15
    v_and_b32 v15, 0xffff0000, v15
    s_lshl_b32 s34, s28, 8
    s_and_b32 s35, s30, 1
    s_lshl_b32 s35, s35, 7
    s_add_u32 s34, s34, s35
    s_lshr_b32 s35, s30, 1
    s_lshl_b32 s35, s35, 3
    s_add_u32 s34, s34, s35
    s_add_u32 s34, s34, 13631488
    v_lshrrev_b32 v16, 3, v2
    v_and_b32 v14, 3, v2
    v_lshl_add_u32 v16, v16, 2, v14
    v_lshlrev_b32 v16, 2, v16
    v_bfe_u32 v14, v2, 2, 1
    v_add_lshl_u32 v16, v16, v14, 2
    s_mov_b64 exec, 0xffff
    buffer_store_dword v15, v16, s[20:23], s34 offen sc1
    s_mov_b64 exec, -1
    s_waitcnt vmcnt(0) lgkmcnt(0)
    s_barrier
    s_cmp_lg_u32 s30, 0
    s_cbranch_scc1 L_pub36
    s_lshl_b32 s34, s28, 7
    s_add_u32 s34, s34, 14802944
    v_mov_b32 v18, s31
    s_mov_b64 exec, 1
    buffer_store_dword v18, v5, s[20:23], s34 offen sc1
    s_mov_b64 exec, -1
L_pub36:
    s_cmp_ge_u32 s28, 28
    s_cbranch_scc1 L_aux3
    s_mul_i32 s34, s30, 200704
    s_lshl_b32 s35, s28, 10
    s_add_u32 s34, s34, s35
    s_add_u32 s34, s34, 12582912
    ds_read_b64_tr_b16 v[36:37], v12 offset:0
    ds_read_b64_tr_b16 v[38:39], v12 offset:14336
    s_waitcnt lgkmcnt(0)
    buffer_store_dwordx4 v[36:39], v4, s[20:23], s34 offen sc1
    s_add_u32 s34, s34, 28672
    ds_read_b64_tr_b16 v[40:41], v12 offset:32
    ds_read_b64_tr_b16 v[42:43], v12 offset:14368
    s_waitcnt lgkmcnt(0)
    buffer_store_dwordx4 v[40:43], v4, s[20:23], s34 offen sc1
    s_add_u32 s34, s34, 28672
    ds_read_b64_tr_b16 v[36:37], v12 offset:64
    ds_read_b64_tr_b16 v[38:39], v12 offset:14400
    s_waitcnt lgkmcnt(0)
    buffer_store_dwordx4 v[36:39], v4, s[20:23], s34 offen sc1
    s_add_u32 s34, s34, 28672
    ds_read_b64_tr_b16 v[40:41], v12 offset:96
    ds_read_b64_tr_b16 v[42:43], v12 offset:14432
    s_waitcnt lgkmcnt(0)
    buffer_store_dwordx4 v[40:43], v4, s[20:23], s34 offen sc1
    s_add_u32 s34, s34, 28672
    ds_read_b64_tr_b16 v[36:37], v12 offset:128
    ds_read_b64_tr_b16 v[38:39], v12 offset:14464
    s_waitcnt lgkmcnt(0)
    buffer_store_dwordx4 v[36:39], v4, s[20:23], s34 offen sc1
    s_add_u32 s34, s34, 28672
    ds_read_b64_tr_b16 v[40:41], v12 offset:160
    ds_read_b64_tr_b16 v[42:43], v12 offset:14496
    s_waitcnt lgkmcnt(0)
    buffer_store_dwordx4 v[40:43], v4, s[20:23], s34 offen sc1
    s_add_u32 s34, s34, 28672
    ds_read_b64_tr_b16 v[36:37], v12 offset:192
    ds_read_b64_tr_b16 v[38:39], v12 offset:14528
    s_waitcnt lgkmcnt(0)
    buffer_store_dwordx4 v[36:39], v4, s[20:23], s34 offen sc1
    s_add_u32 s34, s34, 28672
L_aux3:
    s_waitcnt vmcnt(0) lgkmcnt(0)
    s_barrier
    s_cmp_lg_u32 s30, 0
    s_cbranch_scc1 L_pub37
    s_lshl_b32 s34, s2, 7
    s_add_u32 s34, s34, 14794752
    v_mov_b32 v18, s31
    s_mov_b64 exec, 1
    buffer_store_dword v18, v5, s[20:23], s34 offen sc1
    s_mov_b64 exec, -1
L_pub37:
    s_endpgm
L_codeend:
.section .rodata,"a"
.p2align 6
.amdhsa_kernel gated_mix__ssm_conv_s4d__mixer_gmlp__prompt_kernel
  .amdhsa_next_free_vgpr 512
  .amdhsa_next_free_sgpr 102
  .amdhsa_accum_offset 256
  .amdhsa_group_segment_fixed_size 0
  .amdhsa_kernarg_size 128
  .amdhsa_user_sgpr_count 2
  .amdhsa_user_sgpr_kernarg_segment_ptr 1
  .amdhsa_system_sgpr_workgroup_id_x 1
.end_amdhsa_kernel
```
